```python
import torch

def _softmax(x, axis=-1):
    return torch.softmax(x, dim=axis)

def _gelu(x):
    return torch.nn.functional.gelu(x, approximate='tanh')

def _silu(x):
    return torch.nn.functional.silu(x)

def _sigmoid(x):
    return torch.sigmoid(x)

def _layernorm(x, axis=-1, eps=1e-05):
    m = x.mean(dim=axis, keepdim=True)
    v = x.var(dim=axis, keepdim=True, unbiased=False)
    return (x - m) / torch.sqrt(v + eps)

def _scatter_add(tgt, idx, src, axis=0):
    return tgt.clone().index_add_(axis, idx, src)

def _segment_sum(src, seg, n):
    out = torch.zeros((n,) + src.shape[1:], dtype=src.dtype)
    return out.index_add_(0, seg, src)

def _pad(x, pw):
    flat = tuple((v for pair in reversed(pw) for v in pair))
    return torch.nn.functional.pad(x, flat)
kernel_name = 'adaLN_cond__grouped_kv_mqa__dense_activation_silu__prompt'

def setup_inputs():

    _w = lambda a: (lambda t: t.to(torch.bfloat16) if t.is_floating_point() else t)(torch.as_tensor(a))

    def _A_setup():
        B, S, D, H = (1, 2048, 640, 32)
        Dh = D // H
        return {'x': _w((lambda *s: torch.randn(*s, dtype=torch.bfloat16) * 0.05)(B, S, D)), 'wq': _w((lambda *s: torch.randn(*s, dtype=torch.bfloat16) * 0.05)(D, H * Dh)), 'wk': _w((lambda *s: torch.randn(*s, dtype=torch.bfloat16) * 0.05)(D, Dh)), 'wv': _w((lambda *s: torch.randn(*s, dtype=torch.bfloat16) * 0.05)(D, Dh)), 'wo': _w((lambda *s: torch.randn(*s, dtype=torch.bfloat16) * 0.05)(H * Dh, D))}
    _A_in = _A_setup()

    def _B_setup():
        B, S, D, F = (1, 2048, 640, 1536)
        return {'x': _w((lambda *s: torch.randn(*s, dtype=torch.bfloat16) * 0.05)(B, S, D)), 'w1': _w((lambda *s: torch.randn(*s, dtype=torch.bfloat16) * 3.2)(D, F) * D ** (-0.5)), 'w2': _w((lambda *s: torch.randn(*s, dtype=torch.bfloat16) * 0.4)(F, D) * F ** (-0.5))}
    _B_in = _B_setup()
    return {'A_x': _A_in['x'], 'A_wq': _A_in['wq'], 'A_wk': _A_in['wk'], 'A_wv': _A_in['wv'], 'A_wo': _A_in['wo'], 'B_x': _B_in['x'], 'B_w1': _B_in['w1'], 'B_w2': _B_in['w2'], 'c': _w((lambda *s: torch.randn(*s, dtype=torch.bfloat16) * 0.1)(1, 640) * 8.0), 'w_mod': _w((lambda *s: torch.randn(*s, dtype=torch.bfloat16) * 0.1)(640, 6 * 640) * 640 ** (-0.5) * 8.0)}

def reference(A_x, A_wq, A_wk, A_wv, A_wo, B_x, B_w1, B_w2, c, w_mod):

    def _A_ref(x, wq, wk, wv, wo):
        B, S, D = x.shape
        H = 32
        Dh = D // H
        q = (lambda x, *d: x.permute(*d))((x @ wq).reshape(B, S, H, Dh), 0, 2, 1, 3)
        k = x @ wk
        v = x @ wv
        scores = torch.einsum('bhqd,bkd->bhqk', q, k) * Dh ** (-0.5)
        p = _softmax(scores, axis=-1)
        o = torch.einsum('bhqk,bkd->bhqd', p, v)
        return (lambda x, *d: x.permute(*d))(o, 0, 2, 1, 3).reshape(B, S, H * Dh) @ wo

    def _B_ref(x, w1, w2):
        h = torch.einsum('bsd,df->bsf', x, w1)
        h = _silu(h)
        out = torch.einsum('bsf,fd->bsd', h, w2)
        return out
    x = A_x
    mod = (_silu(c) @ w_mod).reshape(c.shape[0], 6, 1, -1)
    sa, ca, ga, sb, cb, gb = (mod[:, 0].clone(), mod[:, 1].clone(), mod[:, 2].clone(), mod[:, 3].clone(), mod[:, 4].clone(), mod[:, 5].clone())
    h = _layernorm(x, axis=-1) * (1 + ca) + sa
    x = x + ga * _A_ref(h, A_wq, A_wk, A_wv, A_wo)
    h = _layernorm(x, axis=-1) * (1 + cb) + sb
    x = x + gb * _B_ref(h, B_w1, B_w2)
    return x
```

```asm
; @launch grid=(256,1,1) block=(256,1,1) lds=163840
.amdgcn_target "amdgcn-amd-amdhsa--gfx950"
.text
.globl adaLN_cond__grouped_kv_mqa__dense_activation_silu__prompt_kernel
.p2align 8
.type adaLN_cond__grouped_kv_mqa__dense_activation_silu__prompt_kernel,@function
adaLN_cond__grouped_kv_mqa__dense_activation_silu__prompt_kernel:
    s_cmp_ge_u32 s2, 256
    s_cbranch_scc1 L_end
    s_load_dwordx16 s[4:19], s[0:1], 0
    s_load_dwordx4 s[20:23], s[0:1], 64
    s_load_dwordx2 s[24:25], s[0:1], 80
    s_load_dwordx2 s[26:27], s[0:1], 96
    v_and_b32 v1, 63, v0
    v_lshrrev_b32 v3, 6, v0
    v_and_b32 v2, 15, v0
    v_readfirstlane_b32 s30, v3
    v_lshrrev_b32 v3, 4, v1
    v_lshlrev_b32 v4, 4, v1
    s_and_b32 s56, s2, 7
    s_lshl_b32 s28, s56, 2
    s_lshr_b32 s57, s2, 3
    s_and_b32 s3, s57, 3
    s_add_u32 s28, s28, s3
    s_lshr_b32 s29, s57, 2
    s_getpc_b64 s[52:53]
    s_lshl_b32 s57, s57, 2
    s_add_u32 s57, s57, s30
    s_lshl_b32 s54, s57, 9
    v_lshl_add_u32 v5, v1, 7, s54
    v_min_u32 v5, CODE_LAST, v5
    s_mov_b64 exec, 15
    global_load_dword v14, v5, s[52:53]
    s_mov_b64 exec, -1
    s_waitcnt lgkmcnt(0)
    s_load_dword s32, s[26:27], 0
    s_mov_b32 s36, s26
    s_mov_b32 s37, s27
    s_mov_b32 s38, 0x1400000
    s_mov_b32 s39, 0x00020000
    s_mov_b32 s40, s4
    s_mov_b32 s41, s5
    s_mov_b32 s42, 0x280000
    s_mov_b32 s43, 0x00020000
    s_add_u32 s35, s2, 128
    s_and_b32 s35, s35, 255
    s_lshr_b32 s54, s35, 3
    s_mul_i32 s55, s56, 10
    s_add_u32 s55, s55, s54
    s_mul_i32 s53, s56, 20
    s_add_u32 s53, s53, s54
    s_add_u32 s53, s53, 70
    s_cmp_lt_u32 s35, 80
    s_cselect_b32 s34, s55, s53
    s_mov_b32 s91, 0xffff0000
    s_mov_b32 s84, s22
    s_mov_b32 s85, s23
    s_mov_b32 s86, 0x4b0000
    s_mov_b32 s87, 0x00020000
    v_mul_u32_u24 v5, 21846, v1
    v_lshrrev_b32 v5, 16, v5
    v_mul_u32_u24 v6, 3, v5
    v_sub_u32 v6, v1, v6
    v_mul_u32_u24 v5, 7680, v5
    v_lshl_add_u32 v5, v6, 7, v5
    s_and_b32 s52, s2, 7
    s_mul_i32 s52, s52, 320
    s_andn2_b32 s52, s52, 127
    s_lshr_b32 s53, s2, 3
    s_lshl_b32 s53, s53, 2
    s_add_u32 s53, s53, s30
    s_mul_i32 s53, s53, 38400
    s_add_u32 s52, s52, s53
    s_mov_b64 exec, 0x7fff
    buffer_load_dword v14, v5, s[84:87], s52 offen
    s_mov_b64 exec, -1
    s_cmp_lt_u32 s35, 80
    s_cbranch_scc0 L_pathB
    s_mov_b32 s48, s20
    s_mov_b32 s49, s21
    s_mov_b32 s50, 0x500
    s_mov_b32 s51, 0x00020000
    s_mul_i32 s52, s30, 320
    v_lshlrev_b32 v8, 3, v1
    buffer_load_dwordx2 v[148:149], v8, s[48:51], s52 offen
    s_mov_b32 s48, s22
    s_mov_b32 s49, s23
    s_mov_b32 s50, 0x4b0000
    s_mov_b32 s51, 0x00020000
    v_lshrrev_b32 v5, 1, v1
    v_and_b32 v6, 0x13, v5
    v_lshlrev_b32 v8, 1, v5
    v_and_or_b32 v6, v8, 8, v6
    v_lshrrev_b32 v8, 1, v5
    v_and_or_b32 v6, v8, 4, v6
    v_mul_u32_u24 v6, 7680, v6
    v_and_b32 v5, 1, v1
    v_lshl_add_u32 v6, v5, 4, v6
    s_mul_i32 s54, s30, 1228800
    s_lshl_b32 s55, s34, 5
    s_add_u32 s54, s54, s55
    s_mul_i32 s55, s30, 30720
    s_add_u32 m0, s55, 18432
    s_add_u32 s52, s54, 0
    buffer_load_dwordx4 v6, s[48:51], s52 offen lds
    s_add_u32 m0, s55, 19456
    s_add_u32 s52, s54, 245760
    buffer_load_dwordx4 v6, s[48:51], s52 offen lds
    s_add_u32 m0, s55, 20480
    s_add_u32 s52, s54, 491520
    buffer_load_dwordx4 v6, s[48:51], s52 offen lds
    s_add_u32 m0, s55, 21504
    s_add_u32 s52, s54, 737280
    buffer_load_dwordx4 v6, s[48:51], s52 offen lds
    s_add_u32 m0, s55, 22528
    s_add_u32 s52, s54, 983040
    buffer_load_dwordx4 v6, s[48:51], s52 offen lds
    s_mov_b32 s44, s6
    s_mov_b32 s45, s7
    s_mov_b32 s46, 0xc8000
    s_mov_b32 s47, 0x00020000
    v_lshrrev_b32 v5, 2, v1
    v_mul_u32_u24 v7, 1280, v5
    v_lshrrev_b32 v5, 4, v1
    v_and_b32 v5, 2, v5
    v_and_b32 v6, 3, v1
    v_xor_b32 v5, v5, v6
    v_lshl_add_u32 v7, v5, 4, v7
    s_mul_i32 s76, s29, 160
    s_and_b32 s77, s76, 32
    s_sub_u32 s76, s76, s77
    s_mul_i32 s77, s30, 204800
    s_add_u32 s76, s76, s77
    s_mul_i32 s77, s30, 30720
    s_lshr_b32 s53, s29, 1
    s_add_u32 s80, s53, 0
    s_and_b32 s80, s80, 3
    s_add_u32 s81, s53, 1
    s_and_b32 s81, s81, 3
    s_add_u32 s82, s53, 2
    s_and_b32 s82, s82, 3
    s_add_u32 s83, s53, 3
    s_and_b32 s83, s83, 3
    s_waitcnt lgkmcnt(0)
    s_mul_i32 s32, s32, 0x9e3779b1
    s_add_u32 s32, s32, 0x7f4a7c15
    s_xor_b32 s33, s32, 0xa5a5a5a5
    v_lshlrev_b32 v10, 3, v3
    v_bfe_u32 v11, v1, 2, 2
    v_add_u32 v10, v10, v11
    v_mul_u32_u24 v12, 40, v10
    v_lshlrev_b32 v10, 6, v10
    v_and_b32 v11, 3, v1
    v_lshl_add_u32 v10, v11, 3, v10
    v_lshl_add_u32 v12, v11, 3, v12
    v_and_b32 v11, 1, v3
    v_lshl_add_u32 v10, v11, 5, v10
    s_mul_i32 s52, s30, 6400
    s_add_u32 s52, s52, 122880
    v_add_u32 v233, s52, v12
    s_and_b32 s53, s29, 1
    s_add_u32 s52, s53, 0
    s_and_b32 s54, s52, 1
    s_lshl_b32 s54, s54, 5
    s_lshr_b32 s52, s52, 1
    s_lshl_b32 s52, s52, 11
    s_add_u32 s52, s52, s77
    v_xor_b32 v11, s54, v10
    v_add_u32 v252, s52, v11
    s_add_u32 s52, s53, 1
    s_and_b32 s54, s52, 1
    s_lshl_b32 s54, s54, 5
    s_lshr_b32 s52, s52, 1
    s_lshl_b32 s52, s52, 11
    s_add_u32 s52, s52, s77
    v_xor_b32 v11, s54, v10
    v_add_u32 v253, s52, v11
    s_add_u32 s52, s53, 2
    s_and_b32 s54, s52, 1
    s_lshl_b32 s54, s54, 5
    s_lshr_b32 s52, s52, 1
    s_lshl_b32 s52, s52, 11
    s_add_u32 s52, s52, s77
    v_xor_b32 v11, s54, v10
    v_add_u32 v254, s52, v11
    s_add_u32 s52, s53, 3
    s_and_b32 s54, s52, 1
    s_lshl_b32 s54, s54, 5
    s_lshr_b32 s52, s52, 1
    s_lshl_b32 s52, s52, 11
    s_add_u32 s52, s52, s77
    v_xor_b32 v11, s54, v10
    v_add_u32 v255, s52, v11
    s_add_u32 s52, s53, 4
    s_and_b32 s54, s52, 1
    s_lshl_b32 s54, s54, 5
    s_lshr_b32 s52, s52, 1
    s_lshl_b32 s52, s52, 11
    s_add_u32 s52, s52, s77
    v_xor_b32 v11, s54, v10
    v_add_u32 v234, s52, v11
    s_lshr_b32 s53, s29, 1
    s_add_u32 s53, s53, s30
    s_and_b32 s53, s53, 3
    s_lshr_b32 s52, s53, 1
    s_mul_i32 s52, s52, 5120
    s_add_u32 s52, s52, 153600
    s_and_b32 s53, s53, 1
    s_lshl_b32 s53, s53, 4
    v_add_u32 v8, s53, v2
    v_add_u32 v12, 0, v3
    v_mul_u32_u24 v10, 13108, v12
    v_lshrrev_b32 v10, 16, v10
    v_mul_u32_u24 v9, 5, v10
    v_sub_u32 v9, v12, v9
    v_mul_u32_u24 v10, 1280, v10
    v_add_u32 v10, s52, v10
    v_lshrrev_b32 v11, 1, v9
    v_lshl_add_u32 v11, v11, 9, v10
    v_lshl_add_u32 v11, v8, 4, v11
    v_and_b32 v12, 1, v9
    v_cmp_eq_u32 vcc, 4, v9
    v_lshl_add_u32 v11, v12, 3, v11
    v_lshl_add_u32 v10, v8, 3, v10
    v_add_u32 v10, 1024, v10
    v_cndmask_b32 v228, v11, v10, vcc
    v_add_u32 v12, 4, v3
    v_mul_u32_u24 v10, 13108, v12
    v_lshrrev_b32 v10, 16, v10
    v_mul_u32_u24 v9, 5, v10
    v_sub_u32 v9, v12, v9
    v_mul_u32_u24 v10, 1280, v10
    v_add_u32 v10, s52, v10
    v_lshrrev_b32 v11, 1, v9
    v_lshl_add_u32 v11, v11, 9, v10
    v_lshl_add_u32 v11, v8, 4, v11
    v_and_b32 v12, 1, v9
    v_cmp_eq_u32 vcc, 4, v9
    v_lshl_add_u32 v11, v12, 3, v11
    v_lshl_add_u32 v10, v8, 3, v10
    v_add_u32 v10, 1024, v10
    v_cndmask_b32 v229, v11, v10, vcc
    v_add_u32 v12, 8, v3
    v_mul_u32_u24 v10, 13108, v12
    v_lshrrev_b32 v10, 16, v10
    v_mul_u32_u24 v9, 5, v10
    v_sub_u32 v9, v12, v9
    v_mul_u32_u24 v10, 1280, v10
    v_add_u32 v10, s52, v10
    v_lshrrev_b32 v11, 1, v9
    v_lshl_add_u32 v11, v11, 9, v10
    v_lshl_add_u32 v11, v8, 4, v11
    v_and_b32 v12, 1, v9
    v_cmp_eq_u32 vcc, 4, v9
    v_lshl_add_u32 v11, v12, 3, v11
    v_lshl_add_u32 v10, v8, 3, v10
    v_add_u32 v10, 1024, v10
    v_cndmask_b32 v230, v11, v10, vcc
    v_add_u32 v12, 12, v3
    v_mul_u32_u24 v10, 13108, v12
    v_lshrrev_b32 v10, 16, v10
    v_mul_u32_u24 v9, 5, v10
    v_sub_u32 v9, v12, v9
    v_mul_u32_u24 v10, 1280, v10
    v_add_u32 v10, s52, v10
    v_lshrrev_b32 v11, 1, v9
    v_lshl_add_u32 v11, v11, 9, v10
    v_lshl_add_u32 v11, v8, 4, v11
    v_and_b32 v12, 1, v9
    v_cmp_eq_u32 vcc, 4, v9
    v_lshl_add_u32 v11, v12, 3, v11
    v_lshl_add_u32 v10, v8, 3, v10
    v_add_u32 v10, 1024, v10
    v_cndmask_b32 v231, v11, v10, vcc
    v_add_u32 v12, 16, v3
    v_mul_u32_u24 v10, 13108, v12
    v_lshrrev_b32 v10, 16, v10
    v_mul_u32_u24 v9, 5, v10
    v_sub_u32 v9, v12, v9
    v_mul_u32_u24 v10, 1280, v10
    v_add_u32 v10, s52, v10
    v_lshrrev_b32 v11, 1, v9
    v_lshl_add_u32 v11, v11, 9, v10
    v_lshl_add_u32 v11, v8, 4, v11
    v_and_b32 v12, 1, v9
    v_cmp_eq_u32 vcc, 4, v9
    v_lshl_add_u32 v11, v12, 3, v11
    v_lshl_add_u32 v10, v8, 3, v10
    v_add_u32 v10, 1024, v10
    v_cndmask_b32 v232, v11, v10, vcc
    v_cmp_eq_u32 vcc, 20, v1
    v_mov_b32 v10, 0x3f803f80
    v_mov_b32 v11, 0
    v_mov_b32 v12, 0x3afe3f80
    v_mov_b32 v13, 0
    v_cndmask_b32 v12, 0, v12, vcc
    s_nop 1
    v_mfma_f32_32x32x8_bf16 a[80:95], v[10:11], v[12:13], 0
    v_mfma_f32_32x32x8_bf16 a[96:111], v[10:11], v[12:13], 0
    v_mfma_f32_32x32x8_bf16 a[112:127], v[10:11], v[12:13], 0
    v_mfma_f32_32x32x8_bf16 a[128:143], v[10:11], v[12:13], 0
    v_mfma_f32_32x32x8_bf16 a[144:159], v[10:11], v[12:13], 0
    v_mfma_f32_32x32x8_bf16 a[160:175], v[10:11], v[12:13], 0
    v_mfma_f32_32x32x8_bf16 a[176:191], v[10:11], v[12:13], 0
    v_mfma_f32_32x32x8_bf16 a[192:207], v[10:11], v[12:13], 0
    s_lshl_b32 s52, s2, 2
    s_add_u32 s52, s52, s30
    s_cmp_ge_u32 s52, 960
    s_cselect_b32 s53, 960, 0
    s_sub_u32 s53, s52, s53
    v_lshrrev_b32 v5, 2, v1
    v_and_b32 v6, 3, v1
    v_lshlrev_b32 v6, 4, v6
    s_mul_i32 s54, s53, 21846
    s_lshr_b32 s54, s54, 20
    s_mul_i32 s55, s54, 48
    s_sub_u32 s55, s53, s55
    v_mul_u32_u24 v96, 3072, v5
    v_add_u32 v96, v96, v6
    s_mul_i32 s88, s54, 98304
    s_lshl_b32 s57, s55, 6
    s_add_u32 s88, s88, s57
    s_lshl_b32 s55, s55, 1
    s_mul_i32 s56, s55, 349526
    s_lshr_b32 s56, s56, 20
    s_mul_i32 s57, s56, 3
    s_sub_u32 s57, s55, s57
    s_mul_i32 s56, s56, 60
    s_mul_i32 s60, s54, 3
    s_add_u32 s56, s56, s57
    s_add_u32 s56, s56, s60
    s_lshl_b32 s56, s56, 10
    s_add_u32 s60, s56, 14680064
    s_add_u32 s55, s55, 1
    s_mul_i32 s56, s55, 349526
    s_lshr_b32 s56, s56, 20
    s_mul_i32 s57, s56, 3
    s_sub_u32 s57, s55, s57
    s_mul_i32 s56, s56, 60
    s_mul_i32 s61, s54, 3
    s_add_u32 s56, s56, s57
    s_add_u32 s56, s56, s61
    s_lshl_b32 s56, s56, 10
    s_add_u32 s61, s56, 14680064
    s_mul_i32 s54, s53, 52429
    s_lshr_b32 s54, s54, 20
    s_mul_i32 s55, s54, 20
    s_sub_u32 s55, s53, s55
    v_mul_u32_u24 v97, 1280, v5
    v_add_u32 v97, v97, v6
    s_mul_i32 s89, s54, 40960
    s_lshl_b32 s57, s55, 6
    s_add_u32 s89, s89, s57
    s_lshl_b32 s55, s55, 1
    s_mul_i32 s56, s55, 209716
    s_lshr_b32 s56, s56, 20
    s_mul_i32 s57, s56, 5
    s_sub_u32 s57, s55, s57
    s_mul_i32 s56, s56, 240
    s_mul_i32 s62, s54, 5
    s_add_u32 s56, s56, s57
    s_add_u32 s56, s56, s62
    s_lshl_b32 s56, s56, 10
    s_add_u32 s62, s56, 16777216
    s_add_u32 s55, s55, 1
    s_mul_i32 s56, s55, 209716
    s_lshr_b32 s56, s56, 20
    s_mul_i32 s57, s56, 5
    s_sub_u32 s57, s55, s57
    s_mul_i32 s56, s56, 240
    s_mul_i32 s63, s54, 5
    s_add_u32 s56, s56, s57
    s_add_u32 s56, s56, s63
    s_lshl_b32 s56, s56, 10
    s_add_u32 s63, s56, 16777216
    s_mul_i32 s54, s52, 2622
    s_lshr_b32 s54, s54, 20
    s_mul_i32 s53, s54, 400
    s_sub_u32 s53, s52, s53
    s_mul_i32 s54, s53, 52429
    s_lshr_b32 s54, s54, 20
    s_mul_i32 s55, s54, 20
    s_sub_u32 s55, s53, s55
    s_lshl_b32 s56, s54, 2
    s_lshl_b32 s90, s55, 6
    v_lshrrev_b32 v11, 5, v1
    v_add_u32 v11, 0, v11
    v_add_u32 v11, s56, v11
    v_mul_u32_u24 v12, 6554, v11
    v_lshrrev_b32 v12, 16, v12
    v_mul_u32_u24 v13, 10, v12
    v_sub_u32 v13, v11, v13
    v_mul_u32_u24 v12, 80, v12
    v_and_b32 v11, 3, v5
    v_add_u32 v12, v12, v11
    v_bfe_u32 v11, v1, 4, 1
    v_lshrrev_b32 v8, 1, v13
    v_mul_u32_u24 v8, 20, v8
    v_and_b32 v10, 1, v13
    v_lshl_add_u32 v8, v10, 2, v8
    v_lshl_add_u32 v8, v11, 3, v8
    v_mul_u32_u24 v10, 40, v10
    v_mul_u32_u24 v11, 20, v11
    v_cmp_le_u32 vcc, 8, v13
    v_add3_u32 v10, v10, v11, 16
    s_nop 0
    v_cndmask_b32 v8, v8, v10, vcc
    v_add_u32 v12, v12, v8
    v_mul_u32_u24 v12, 1280, v12
    v_add_u32 v98, v12, v6
    v_lshrrev_b32 v11, 5, v1
    v_add_u32 v11, 2, v11
    v_add_u32 v11, s56, v11
    v_mul_u32_u24 v12, 6554, v11
    v_lshrrev_b32 v12, 16, v12
    v_mul_u32_u24 v13, 10, v12
    v_sub_u32 v13, v11, v13
    v_mul_u32_u24 v12, 80, v12
    v_and_b32 v11, 3, v5
    v_add_u32 v12, v12, v11
    v_bfe_u32 v11, v1, 4, 1
    v_lshrrev_b32 v8, 1, v13
    v_mul_u32_u24 v8, 20, v8
    v_and_b32 v10, 1, v13
    v_lshl_add_u32 v8, v10, 2, v8
    v_lshl_add_u32 v8, v11, 3, v8
    v_mul_u32_u24 v10, 40, v10
    v_mul_u32_u24 v11, 20, v11
    v_cmp_le_u32 vcc, 8, v13
    v_add3_u32 v10, v10, v11, 16
    s_nop 0
    v_cndmask_b32 v8, v8, v10, vcc
    v_add_u32 v12, v12, v8
    v_mul_u32_u24 v12, 1280, v12
    v_add_u32 v99, v12, v6
    s_lshl_b32 s55, s55, 1
    s_mul_i32 s56, s55, 209716
    s_lshr_b32 s56, s56, 20
    s_mul_i32 s57, s56, 5
    s_sub_u32 s57, s55, s57
    s_mul_i32 s56, s56, 100
    s_mul_i32 s64, s54, 5
    s_add_u32 s56, s56, s57
    s_add_u32 s56, s56, s64
    s_lshl_b32 s56, s56, 10
    s_add_u32 s64, s56, 13631488
    s_add_u32 s55, s55, 1
    s_mul_i32 s56, s55, 209716
    s_lshr_b32 s56, s56, 20
    s_mul_i32 s57, s56, 5
    s_sub_u32 s57, s55, s57
    s_mul_i32 s56, s56, 100
    s_mul_i32 s65, s54, 5
    s_add_u32 s56, s56, s57
    s_add_u32 s56, s56, s65
    s_lshl_b32 s56, s56, 10
    s_add_u32 s65, s56, 13631488
    s_mov_b32 s79, 0
    s_mul_i32 s68, s28, 81920
    s_mul_i32 s52, s29, 2560
    s_add_u32 s68, s68, s52
    s_add_u32 s68, s68, 1048576
    s_lshr_b32 s52, s30, 1
    s_lshl_b32 s52, s52, 8
    s_and_b32 s53, s30, 1
    s_lshl_b32 s53, s53, 3
    s_add_u32 s52, s52, s53
    s_add_u32 s69, s68, s52
    s_add_u32 s69, s69, 2048
    s_lshl_b32 s52, s30, 9
    s_add_u32 s68, s68, s52
    s_mul_i32 s70, s29, 102400
    s_mul_i32 s71, s30, 25600
    s_add_u32 s70, s70, s71
    s_add_u32 s70, s70, 13631488
    s_lshl_b32 s72, s29, 2
    s_add_u32 s72, s72, s30
    s_mul_i32 s72, s72, 61440
    s_add_u32 s73, s72, 16777216
    s_add_u32 s72, s72, 14680064
    s_mul_i32 s74, s30, 15360
    s_mul_i32 s75, s30, 40960
    s_add_u32 s75, s75, 196608
    s_mul_i32 s67, s29, 160
    s_lshl_b32 s52, s29, 2
    s_add_u32 s52, s52, s30
    s_mul_i32 s78, s52, 2560
    s_mul_i32 s53, s28, 81920
    s_add_u32 s78, s78, s53
    s_mul_i32 s93, s52, 1536
    s_mul_i32 s53, s28, 49152
    s_add_u32 s93, s93, s53
    s_waitcnt vmcnt(5)
    v_lshlrev_b32 v100, 16, v148
    v_and_b32 v101, s91, v148
    v_lshlrev_b32 v102, 16, v149
    v_and_b32 v103, s91, v149
    v_mul_f32 v104, 0xbfb8aa3b, v100
    v_mul_f32 v105, 0xbfb8aa3b, v101
    v_mul_f32 v106, 0xbfb8aa3b, v102
    v_mul_f32 v107, 0xbfb8aa3b, v103
    v_exp_f32 v104, v104
    v_exp_f32 v105, v105
    v_exp_f32 v106, v106
    v_exp_f32 v107, v107
    s_nop 0
    v_add_f32 v104, 1.0, v104
    v_add_f32 v105, 1.0, v105
    v_add_f32 v106, 1.0, v106
    v_add_f32 v107, 1.0, v107
    v_rcp_f32 v104, v104
    v_rcp_f32 v105, v105
    v_rcp_f32 v106, v106
    v_rcp_f32 v107, v107
    s_nop 0
    v_mul_f32 v100, v100, v104
    v_mul_f32 v101, v101, v105
    v_mul_f32 v102, v102, v106
    v_mul_f32 v103, v103, v107
    v_cvt_pk_bf16_f32 v148, v100, v101
    v_cvt_pk_bf16_f32 v149, v102, v103
    v_accvgpr_write_b32 a254, v148
    v_accvgpr_write_b32 a255, v149
    s_mul_i32 s52, s30, 30720
    s_add_u32 s52, s52, 23552
    v_lshlrev_b32 v8, 3, v1
    v_add_u32 v8, s52, v8
    s_mov_b32 exec_hi, 0xff
    ds_write_b64 v8, a[254:255]
    s_mov_b32 exec_hi, -1
    s_mul_i32 s52, s30, 30720
    s_add_u32 s52, s52, 23552
    v_lshlrev_b32 v145, 4, v3
    v_add_u32 v144, s52, v145
    ds_read_b128 v[100:103], v144 offset:0
    ds_read_b128 v[104:107], v144 offset:64
    ds_read_b128 v[108:111], v144 offset:128
    ds_read_b128 v[112:115], v144 offset:192
    ds_read_b128 v[116:119], v144 offset:256
    v_lshrrev_b32 v146, 1, v3
    v_lshlrev_b32 v146, 4, v146
    v_and_b32 v147, 1, v3
    v_lshl_add_u32 v146, v147, 2, v146
    v_bfe_u32 v147, v1, 2, 2
    v_add_u32 v146, v146, v147
    v_lshlrev_b32 v146, 5, v146
    v_and_b32 v147, 3, v1
    v_lshl_add_u32 v144, v147, 3, v146
    s_mul_i32 s52, s30, 30720
    s_add_u32 s52, s52, 18432
    v_add_u32 v144, s52, v144
    s_lshl_b32 s52, s30, 6
    s_add_u32 s52, s52, 23872
    v_add_u32 v147, s52, v145
    s_lshl_b32 s31, s28, 6
    v_lshrrev_b32 v5, 2, v1
    v_add_u32 v5, s31, v5
    v_mul_u32_u24 v5, 1280, v5
    v_and_b32 v6, 3, v1
    v_lshl_add_u32 v5, v6, 4, v5
    s_mul_i32 s52, s30, 320
    v_add_u32 v5, s52, v5
    s_lshl_b32 s52, s30, 4
    s_add_u32 s31, s31, s52
    v_mov_b32 v235, v5
    s_mul_i32 s52, s80, 20480
    buffer_load_dwordx4 v[16:19], v235, s[40:43], s52 offen offset:0
    buffer_load_dwordx4 v[20:23], v235, s[40:43], s52 offen offset:64
    buffer_load_dwordx4 v[24:27], v235, s[40:43], s52 offen offset:128
    buffer_load_dwordx4 v[28:31], v235, s[40:43], s52 offen offset:192
    buffer_load_dwordx4 v[32:35], v235, s[40:43], s52 offen offset:256
    s_mul_i32 s52, s81, 20480
    buffer_load_dwordx4 v[36:39], v235, s[40:43], s52 offen offset:0
    buffer_load_dwordx4 v[40:43], v235, s[40:43], s52 offen offset:64
    buffer_load_dwordx4 v[44:47], v235, s[40:43], s52 offen offset:128
    buffer_load_dwordx4 v[48:51], v235, s[40:43], s52 offen offset:192
    buffer_load_dwordx4 v[52:55], v235, s[40:43], s52 offen offset:256
    s_waitcnt vmcnt(10)
    s_waitcnt lgkmcnt(0)
    ds_read_b64_tr_b16 v[120:121], v144 offset:0
    ds_read_b64_tr_b16 v[122:123], v144 offset:256
    ds_read_b64_tr_b16 v[124:125], v144 offset:1024
    ds_read_b64_tr_b16 v[126:127], v144 offset:1280
    ds_read_b64_tr_b16 v[128:129], v144 offset:2048
    ds_read_b64_tr_b16 v[130:131], v144 offset:2304
    ds_read_b64_tr_b16 v[132:133], v144 offset:3072
    ds_read_b64_tr_b16 v[134:135], v144 offset:3328
    ds_read_b64_tr_b16 v[136:137], v144 offset:4096
    ds_read_b64_tr_b16 v[138:139], v144 offset:4352
    s_waitcnt lgkmcnt(8)
    v_mfma_f32_16x16x32_bf16 v[140:143], v[120:123], v[100:103], 0
    s_waitcnt lgkmcnt(6)
    v_mfma_f32_16x16x32_bf16 v[140:143], v[124:127], v[104:107], v[140:143]
    s_waitcnt lgkmcnt(4)
    v_mfma_f32_16x16x32_bf16 v[140:143], v[128:131], v[108:111], v[140:143]
    s_waitcnt lgkmcnt(2)
    v_mfma_f32_16x16x32_bf16 v[140:143], v[132:135], v[112:115], v[140:143]
    s_waitcnt lgkmcnt(0)
    v_mfma_f32_16x16x32_bf16 v[140:143], v[136:139], v[116:119], v[140:143]
    s_nop 5
    s_mov_b32 exec_lo, 65537
    s_mov_b32 exec_hi, 65537
    ds_write_b128 v147, v[140:143]
    s_mov_b64 exec, -1
    s_waitcnt lgkmcnt(0)
    s_barrier
    s_cmp_lg_u32 s30, 0
    s_cbranch_scc1 L_modw
    v_lshlrev_b32 v145, 4, v3
    v_add_u32 v146, 23872, v145
    ds_read_b128 v[100:103], v146 offset:0
    ds_read_b128 v[104:107], v146 offset:64
    ds_read_b128 v[108:111], v146 offset:128
    ds_read_b128 v[112:115], v146 offset:192
    s_lshl_b32 s52, s34, 6
    s_add_u32 s52, s52, 4096
    v_mov_b32 v118, s32
    v_mov_b32 v119, s33
    s_waitcnt lgkmcnt(0)
    v_add_f32 v100, v100, v104
    v_add_f32 v108, v108, v112
    v_add_f32 v101, v101, v105
    v_add_f32 v109, v109, v113
    v_add_f32 v102, v102, v106
    v_add_f32 v110, v110, v114
    v_add_f32 v103, v103, v107
    v_add_f32 v111, v111, v115
    v_add_f32 v100, v100, v108
    v_add_f32 v101, v101, v109
    v_add_f32 v102, v102, v110
    v_add_f32 v103, v103, v111
    v_cvt_pk_bf16_f32 v116, v100, v101
    v_cvt_pk_bf16_f32 v117, v102, v103
    s_mov_b32 exec_lo, 65537
    s_mov_b32 exec_hi, 65537
    buffer_store_dwordx4 v[116:119], v145, s[36:39], s52 offen sc1
    s_mov_b64 exec, -1
L_modw:
    s_add_u32 s53, s77, 24576
    v_and_b32 v5, 3, v1
    v_lshrrev_b32 v6, 2, v1
    v_lshlrev_b32 v8, 1, v5
    v_xor_b32 v6, v6, v8
    v_lshlrev_b32 v6, 4, v6
    v_lshl_add_u32 v5, v5, 8, v6
    v_add_u32 v5, s53, v5
    v_lshlrev_b32 v8, 1, v3
    v_xor_b32 v6, v2, v8
    v_lshlrev_b32 v6, 4, v6
    v_lshl_add_u32 v6, v3, 8, v6
    v_add_u32 v6, s53, v6
    v_and_b32 v8, 3, v2
    s_lshl_b32 s53, s30, 3
    s_add_u32 s53, s53, 153600
    v_lshlrev_b32 v9, 5, v2
    v_add_u32 v10, s53, v9
    v_add_u32 v9, 153600, v9
    v_mov_b32 v132, 0x3f803f80
    v_mov_b32 v133, 0x3f803f80
    v_mov_b32 v134, 0x3f803f80
    v_mov_b32 v135, 0x3f803f80
    v_cmp_eq_u32 s[54:55], 1, v8
    v_cmp_eq_u32 s[56:57], 2, v8
    v_cmp_eq_u32 vcc, 3, v8
    v_min_u32 v11, 39, v1
    v_lshlrev_b32 v11, 4, v11
    s_mul_i32 s59, s30, 640
    s_add_u32 s59, s59, 4096
    s_waitcnt vmcnt(5)
    ds_write_b128 v5, v[16:19] offset:0
    ds_write_b128 v5, v[20:23] offset:1024
    ds_write_b128 v5, v[24:27] offset:2048
    ds_write_b128 v5, v[28:31] offset:3072
    ds_write_b128 v5, v[32:35] offset:4096
    s_bitcmp1_b32 s29, 0
    s_cselect_b32 s48, s10, s8
    s_cselect_b32 s49, s11, s9
    s_mov_b32 s50, 25600
    s_mov_b32 s51, 0x00020000
    s_mul_i32 s53, s30, 6400
    s_add_u32 m0, s53, 122880
    s_nop 0
    buffer_load_dwordx4 v4, s[48:51], s53 offen offset:0 lds
    buffer_load_dwordx4 v4, s[48:51], s53 offen offset:1024 lds
    buffer_load_dwordx4 v4, s[48:51], s53 offen offset:2048 lds
    buffer_load_dwordx4 v4, s[48:51], s53 offen offset:3072 lds
    s_add_u32 m0, m0, 4096
    s_add_u32 s53, s53, 4096
    buffer_load_dwordx4 v4, s[48:51], s53 offen offset:0 lds
    buffer_load_dwordx4 v4, s[48:51], s53 offen offset:1024 lds
    s_mov_b64 exec, 0xffff
    buffer_load_dwordx4 v4, s[48:51], s53 offen offset:2048 lds
    s_mov_b64 exec, -1
    s_mul_i32 s52, s82, 20480
    buffer_load_dwordx4 v[56:59], v235, s[40:43], s52 offen offset:0
    buffer_load_dwordx4 v[60:63], v235, s[40:43], s52 offen offset:64
    buffer_load_dwordx4 v[64:67], v235, s[40:43], s52 offen offset:128
    buffer_load_dwordx4 v[68:71], v235, s[40:43], s52 offen offset:192
    buffer_load_dwordx4 v[72:75], v235, s[40:43], s52 offen offset:256
    ds_read_b128 v[16:19], v6 offset:0
    ds_read_b128 v[20:23], v6 offset:1024
    ds_read_b128 v[24:27], v6 offset:2048
    ds_read_b128 v[28:31], v6 offset:3072
    ds_read_b128 v[32:35], v6 offset:4096
    s_waitcnt vmcnt(12)
    ds_write_b128 v5, v[36:39] offset:0
    ds_write_b128 v5, v[40:43] offset:1024
    ds_write_b128 v5, v[44:47] offset:2048
    ds_write_b128 v5, v[48:51] offset:3072
    ds_write_b128 v5, v[52:55] offset:4096
    s_mul_i32 s52, s83, 20480
    buffer_load_dwordx4 v[76:79], v235, s[40:43], s52 offen offset:0
    buffer_load_dwordx4 v[80:83], v235, s[40:43], s52 offen offset:64
    buffer_load_dwordx4 v[84:87], v235, s[40:43], s52 offen offset:128
    buffer_load_dwordx4 v[88:91], v235, s[40:43], s52 offen offset:192
    buffer_load_dwordx4 v[92:95], v235, s[40:43], s52 offen offset:256
    s_waitcnt lgkmcnt(9)
    v_mfma_f32_16x16x32_bf16 v[100:103], v[132:135], v[16:19], 0
    v_mfma_f32_16x16x32_bf16 v[116:119], v[16:19], v[16:19], 0
    s_waitcnt lgkmcnt(8)
    v_mfma_f32_16x16x32_bf16 v[100:103], v[132:135], v[20:23], v[100:103]
    v_mfma_f32_16x16x32_bf16 v[116:119], v[20:23], v[20:23], v[116:119]
    s_waitcnt lgkmcnt(7)
    v_mfma_f32_16x16x32_bf16 v[100:103], v[132:135], v[24:27], v[100:103]
    v_mfma_f32_16x16x32_bf16 v[116:119], v[24:27], v[24:27], v[116:119]
    s_waitcnt lgkmcnt(6)
    v_mfma_f32_16x16x32_bf16 v[100:103], v[132:135], v[28:31], v[100:103]
    v_mfma_f32_16x16x32_bf16 v[116:119], v[28:31], v[28:31], v[116:119]
    s_waitcnt lgkmcnt(5)
    v_mfma_f32_16x16x32_bf16 v[100:103], v[132:135], v[32:35], v[100:103]
    v_mfma_f32_16x16x32_bf16 v[116:119], v[32:35], v[32:35], v[116:119]
    ds_read_b128 v[36:39], v6 offset:0
    ds_read_b128 v[40:43], v6 offset:1024
    ds_read_b128 v[44:47], v6 offset:2048
    ds_read_b128 v[48:51], v6 offset:3072
    ds_read_b128 v[52:55], v6 offset:4096
    s_waitcnt vmcnt(5)
    ds_write_b128 v5, v[56:59] offset:0
    ds_write_b128 v5, v[60:63] offset:1024
    ds_write_b128 v5, v[64:67] offset:2048
    ds_write_b128 v5, v[68:71] offset:3072
    ds_write_b128 v5, v[72:75] offset:4096
    v_lshlrev_b32 v13, 7, v1
    s_lshr_b32 s52, s2, 3
    s_lshl_b32 s52, s52, 2
    s_add_u32 s52, s52, s30
    s_mul_i32 s52, s52, 6400
    s_mov_b32 exec_lo, 0xffffffff
    s_mov_b32 exec_hi, 0x3ffff
    buffer_load_dword v14, v13, s[44:47], s52 offen
    s_mov_b64 exec, -1
    v_cndmask_b32 v116, v116, v117, s[54:55]
    v_cndmask_b32 v116, v116, v118, s[56:57]
    v_cndmask_b32 v101, v116, v119, vcc
    s_mov_b32 exec_lo, 15728655
    s_mov_b32 exec_hi, 4026535680
    ds_write_b64 v10, v[100:101] offset:0
    s_mov_b64 exec, -1
    s_waitcnt lgkmcnt(10)
    v_mfma_f32_16x16x32_bf16 v[104:107], v[132:135], v[36:39], 0
    v_mfma_f32_16x16x32_bf16 v[120:123], v[36:39], v[36:39], 0
    s_waitcnt lgkmcnt(9)
    v_mfma_f32_16x16x32_bf16 v[104:107], v[132:135], v[40:43], v[104:107]
    v_mfma_f32_16x16x32_bf16 v[120:123], v[40:43], v[40:43], v[120:123]
    s_waitcnt lgkmcnt(8)
    v_mfma_f32_16x16x32_bf16 v[104:107], v[132:135], v[44:47], v[104:107]
    v_mfma_f32_16x16x32_bf16 v[120:123], v[44:47], v[44:47], v[120:123]
    s_waitcnt lgkmcnt(7)
    v_mfma_f32_16x16x32_bf16 v[104:107], v[132:135], v[48:51], v[104:107]
    v_mfma_f32_16x16x32_bf16 v[120:123], v[48:51], v[48:51], v[120:123]
    s_waitcnt lgkmcnt(6)
    v_mfma_f32_16x16x32_bf16 v[104:107], v[132:135], v[52:55], v[104:107]
    v_mfma_f32_16x16x32_bf16 v[120:123], v[52:55], v[52:55], v[120:123]
    ds_read_b128 v[56:59], v6 offset:0
    ds_read_b128 v[60:63], v6 offset:1024
    ds_read_b128 v[64:67], v6 offset:2048
    ds_read_b128 v[68:71], v6 offset:3072
    ds_read_b128 v[72:75], v6 offset:4096
    s_waitcnt lgkmcnt(0)
    ds_read_b64_tr_b16 v[180:181], v233 offset:0
    ds_read_b64_tr_b16 v[182:183], v233 offset:160
    ds_read_b64_tr_b16 v[184:185], v233 offset:32
    ds_read_b64_tr_b16 v[186:187], v233 offset:192
    ds_read_b64_tr_b16 v[188:189], v233 offset:1280
    ds_read_b64_tr_b16 v[190:191], v233 offset:1440
    ds_read_b64_tr_b16 v[192:193], v233 offset:1312
    ds_read_b64_tr_b16 v[194:195], v233 offset:1472
    ds_read_b64_tr_b16 v[196:197], v233 offset:2560
    ds_read_b64_tr_b16 v[198:199], v233 offset:2720
    ds_read_b64_tr_b16 v[200:201], v233 offset:2592
    ds_read_b64_tr_b16 v[202:203], v233 offset:2752
    s_waitcnt lgkmcnt(4)
    ds_read_b64_tr_b16 v[204:205], v233 offset:3840
    ds_read_b64_tr_b16 v[206:207], v233 offset:4000
    ds_read_b64_tr_b16 v[208:209], v233 offset:3872
    ds_read_b64_tr_b16 v[210:211], v233 offset:4032
    ds_read_b64_tr_b16 v[212:213], v233 offset:5120
    ds_read_b64_tr_b16 v[214:215], v233 offset:5280
    ds_read_b64_tr_b16 v[216:217], v233 offset:5152
    ds_read_b64_tr_b16 v[218:219], v233 offset:5312
    s_waitcnt lgkmcnt(8)
    s_waitcnt vmcnt(1)
    s_barrier
    buffer_load_dwordx4 v[140:143], v11, s[36:39], s59 offen offset:0 sc1
    buffer_load_dwordx4 v[144:147], v11, s[36:39], s59 offen offset:2560 sc1
    ds_read_b128 v[136:139], v9
    ds_read_b128 v[156:159], v9 offset:16
    ds_write_b128 v5, v[76:79] offset:0
    ds_write_b128 v5, v[80:83] offset:1024
    ds_write_b128 v5, v[84:87] offset:2048
    ds_write_b128 v5, v[88:91] offset:3072
    ds_write_b128 v5, v[92:95] offset:4096
    s_waitcnt lgkmcnt(15)
    v_mfma_f32_16x16x32_bf16 v[108:111], v[132:135], v[56:59], 0
    v_mfma_f32_16x16x32_bf16 v[124:127], v[56:59], v[56:59], 0
    s_waitcnt lgkmcnt(15)
    v_mfma_f32_16x16x32_bf16 v[108:111], v[132:135], v[60:63], v[108:111]
    v_mfma_f32_16x16x32_bf16 v[124:127], v[60:63], v[60:63], v[124:127]
    s_waitcnt lgkmcnt(15)
    v_mfma_f32_16x16x32_bf16 v[108:111], v[132:135], v[64:67], v[108:111]
    v_mfma_f32_16x16x32_bf16 v[124:127], v[64:67], v[64:67], v[124:127]
    s_waitcnt lgkmcnt(15)
    v_mfma_f32_16x16x32_bf16 v[108:111], v[132:135], v[68:71], v[108:111]
    v_mfma_f32_16x16x32_bf16 v[124:127], v[68:71], v[68:71], v[124:127]
    s_waitcnt lgkmcnt(15)
    v_mfma_f32_16x16x32_bf16 v[108:111], v[132:135], v[72:75], v[108:111]
    v_mfma_f32_16x16x32_bf16 v[124:127], v[72:75], v[72:75], v[124:127]
    ds_read_b128 v[76:79], v6 offset:0
    ds_read_b128 v[80:83], v6 offset:1024
    ds_read_b128 v[84:87], v6 offset:2048
    ds_read_b128 v[88:91], v6 offset:3072
    ds_read_b128 v[92:95], v6 offset:4096
    s_waitcnt lgkmcnt(10)
    v_pk_add_f32 v[136:137], v[136:137], v[138:139]
    v_pk_add_f32 v[156:157], v[156:157], v[158:159]
    v_pk_add_f32 v[136:137], v[136:137], v[156:157]
    v_mul_f32 v136, 0x3acccccd, v136
    v_mul_f32 v137, 0x3acccccd, v137
    v_fma_f32 v137, -v136, v136, v137
    v_max_f32 v137, 0, v137
    v_add_f32 v137, 0x3727c5ac, v137
    v_rsq_f32 v236, v137
    s_nop 0
    v_mul_f32 v237, -v136, v236
    s_waitcnt lgkmcnt(4)
    v_mfma_f32_16x16x32_bf16 v[112:115], v[132:135], v[76:79], 0
    v_mfma_f32_16x16x32_bf16 v[128:131], v[76:79], v[76:79], 0
    s_waitcnt lgkmcnt(3)
    v_mfma_f32_16x16x32_bf16 v[112:115], v[132:135], v[80:83], v[112:115]
    v_mfma_f32_16x16x32_bf16 v[128:131], v[80:83], v[80:83], v[128:131]
    s_waitcnt lgkmcnt(2)
    v_mfma_f32_16x16x32_bf16 v[112:115], v[132:135], v[84:87], v[112:115]
    v_mfma_f32_16x16x32_bf16 v[128:131], v[84:87], v[84:87], v[128:131]
    s_waitcnt lgkmcnt(1)
    v_mfma_f32_16x16x32_bf16 v[112:115], v[132:135], v[88:91], v[112:115]
    v_mfma_f32_16x16x32_bf16 v[128:131], v[88:91], v[88:91], v[128:131]
    s_waitcnt lgkmcnt(0)
    v_mfma_f32_16x16x32_bf16 v[112:115], v[132:135], v[92:95], v[112:115]
    v_mfma_f32_16x16x32_bf16 v[128:131], v[92:95], v[92:95], v[128:131]
    s_nop 4
    v_cndmask_b32 v120, v120, v121, s[54:55]
    v_cndmask_b32 v120, v120, v122, s[56:57]
    v_cndmask_b32 v105, v120, v123, vcc
    v_cndmask_b32 v124, v124, v125, s[54:55]
    v_cndmask_b32 v124, v124, v126, s[56:57]
    v_cndmask_b32 v109, v124, v127, vcc
    v_cndmask_b32 v128, v128, v129, s[54:55]
    v_cndmask_b32 v128, v128, v130, s[56:57]
    v_cndmask_b32 v113, v128, v131, vcc
    s_mov_b32 exec_lo, 15728655
    s_mov_b32 exec_hi, 4026535680
    ds_write_b64 v10, v[104:105] offset:512
    ds_write_b64 v10, v[108:109] offset:1024
    ds_write_b64 v10, v[112:113] offset:1536
    s_mov_b64 exec, -1
    v_mov_b32 v13, v9
    s_branch L_join
L_pathB:
    s_lshr_b32 s3, s2, 3
    s_cmp_ge_u32 s3, 16
    s_cselect_b32 s52, 10, 0
    s_sub_u32 s3, s3, s52
    s_lshl_b32 s3, s3, 2
    s_add_u32 s3, s3, s30
    v_lshlrev_b32 v13, 7, v1
    s_cmp_ge_u32 s29, 4
    s_cbranch_scc1 L_adaLN_cond__grouped_kv_mqa__dense_activation_silu__prompt_kernel_nowarm_3
    s_lshl_b32 s53, s28, 4
    s_lshl_b32 s52, s29, 2
    s_add_u32 s52, s52, s30
    s_add_u32 s52, s52, s53
    s_mul_i32 s52, s52, 5120
    s_mov_b32 exec_lo, 0xffffffff
    s_mov_b32 exec_hi, 0xff
    buffer_load_dword v14, v13, s[40:43], s52 offen
    s_bitcmp1_b32 s3, 0
    s_cselect_b32 s48, s10, s8
    s_cselect_b32 s49, s11, s9
    s_mov_b32 s50, 25600
    s_mov_b32 s51, 0x00020000
    s_lshr_b32 s52, s3, 1
    s_mul_i32 s52, s52, 896
    s_mov_b64 exec, 0x7f
    buffer_load_dword v14, v13, s[48:51], s52 offen
    s_mov_b64 exec, -1
L_adaLN_cond__grouped_kv_mqa__dense_activation_silu__prompt_kernel_nowarm_3:
    s_mov_b32 s48, s20
    s_mov_b32 s49, s21
    s_mov_b32 s50, 0x500
    s_mov_b32 s51, 0x00020000
    s_mul_i32 s52, s30, 320
    v_lshlrev_b32 v8, 3, v1
    buffer_load_dwordx2 v[148:149], v8, s[48:51], s52 offen
    s_mov_b32 s44, s6
    s_mov_b32 s45, s7
    s_mov_b32 s46, 0xc8000
    s_mov_b32 s47, 0x00020000
    v_lshrrev_b32 v5, 2, v1
    v_mul_u32_u24 v7, 1280, v5
    v_lshrrev_b32 v5, 4, v1
    v_and_b32 v5, 2, v5
    v_and_b32 v6, 3, v1
    v_xor_b32 v5, v5, v6
    v_lshl_add_u32 v7, v5, 4, v7
    s_mul_i32 s76, s29, 160
    s_and_b32 s77, s76, 32
    s_sub_u32 s76, s76, s77
    s_mul_i32 s77, s30, 204800
    s_add_u32 s76, s76, s77
    s_mul_i32 s77, s30, 30720
    s_lshr_b32 s53, s29, 1
    s_add_u32 s80, s53, 0
    s_and_b32 s80, s80, 3
    s_add_u32 s81, s53, 1
    s_and_b32 s81, s81, 3
    s_add_u32 s82, s53, 2
    s_and_b32 s82, s82, 3
    s_add_u32 s83, s53, 3
    s_and_b32 s83, s83, 3
    v_lshlrev_b32 v10, 3, v3
    v_bfe_u32 v11, v1, 2, 2
    v_add_u32 v10, v10, v11
    v_mul_u32_u24 v12, 40, v10
    v_lshlrev_b32 v10, 6, v10
    v_and_b32 v11, 3, v1
    v_lshl_add_u32 v10, v11, 3, v10
    v_lshl_add_u32 v12, v11, 3, v12
    v_and_b32 v11, 1, v3
    v_lshl_add_u32 v10, v11, 5, v10
    s_mul_i32 s52, s30, 6400
    s_add_u32 s52, s52, 122880
    v_add_u32 v233, s52, v12
    s_and_b32 s53, s29, 1
    s_add_u32 s52, s53, 0
    s_and_b32 s54, s52, 1
    s_lshl_b32 s54, s54, 5
    s_lshr_b32 s52, s52, 1
    s_lshl_b32 s52, s52, 11
    s_add_u32 s52, s52, s77
    v_xor_b32 v11, s54, v10
    v_add_u32 v252, s52, v11
    s_add_u32 s52, s53, 1
    s_and_b32 s54, s52, 1
    s_lshl_b32 s54, s54, 5
    s_lshr_b32 s52, s52, 1
    s_lshl_b32 s52, s52, 11
    s_add_u32 s52, s52, s77
    v_xor_b32 v11, s54, v10
    v_add_u32 v253, s52, v11
    s_add_u32 s52, s53, 2
    s_and_b32 s54, s52, 1
    s_lshl_b32 s54, s54, 5
    s_lshr_b32 s52, s52, 1
    s_lshl_b32 s52, s52, 11
    s_add_u32 s52, s52, s77
    v_xor_b32 v11, s54, v10
    v_add_u32 v254, s52, v11
    s_add_u32 s52, s53, 3
    s_and_b32 s54, s52, 1
    s_lshl_b32 s54, s54, 5
    s_lshr_b32 s52, s52, 1
    s_lshl_b32 s52, s52, 11
    s_add_u32 s52, s52, s77
    v_xor_b32 v11, s54, v10
    v_add_u32 v255, s52, v11
    s_add_u32 s52, s53, 4
    s_and_b32 s54, s52, 1
    s_lshl_b32 s54, s54, 5
    s_lshr_b32 s52, s52, 1
    s_lshl_b32 s52, s52, 11
    s_add_u32 s52, s52, s77
    v_xor_b32 v11, s54, v10
    v_add_u32 v234, s52, v11
    s_lshr_b32 s53, s29, 1
    s_add_u32 s53, s53, s30
    s_and_b32 s53, s53, 3
    s_lshr_b32 s52, s53, 1
    s_mul_i32 s52, s52, 5120
    s_add_u32 s52, s52, 153600
    s_and_b32 s53, s53, 1
    s_lshl_b32 s53, s53, 4
    v_add_u32 v8, s53, v2
    v_add_u32 v12, 0, v3
    v_mul_u32_u24 v10, 13108, v12
    v_lshrrev_b32 v10, 16, v10
    v_mul_u32_u24 v9, 5, v10
    v_sub_u32 v9, v12, v9
    v_mul_u32_u24 v10, 1280, v10
    v_add_u32 v10, s52, v10
    v_lshrrev_b32 v11, 1, v9
    v_lshl_add_u32 v11, v11, 9, v10
    v_lshl_add_u32 v11, v8, 4, v11
    v_and_b32 v12, 1, v9
    v_cmp_eq_u32 vcc, 4, v9
    v_lshl_add_u32 v11, v12, 3, v11
    v_lshl_add_u32 v10, v8, 3, v10
    v_add_u32 v10, 1024, v10
    v_cndmask_b32 v228, v11, v10, vcc
    v_add_u32 v12, 4, v3
    v_mul_u32_u24 v10, 13108, v12
    v_lshrrev_b32 v10, 16, v10
    v_mul_u32_u24 v9, 5, v10
    v_sub_u32 v9, v12, v9
    v_mul_u32_u24 v10, 1280, v10
    v_add_u32 v10, s52, v10
    v_lshrrev_b32 v11, 1, v9
    v_lshl_add_u32 v11, v11, 9, v10
    v_lshl_add_u32 v11, v8, 4, v11
    v_and_b32 v12, 1, v9
    v_cmp_eq_u32 vcc, 4, v9
    v_lshl_add_u32 v11, v12, 3, v11
    v_lshl_add_u32 v10, v8, 3, v10
    v_add_u32 v10, 1024, v10
    v_cndmask_b32 v229, v11, v10, vcc
    v_add_u32 v12, 8, v3
    v_mul_u32_u24 v10, 13108, v12
    v_lshrrev_b32 v10, 16, v10
    v_mul_u32_u24 v9, 5, v10
    v_sub_u32 v9, v12, v9
    v_mul_u32_u24 v10, 1280, v10
    v_add_u32 v10, s52, v10
    v_lshrrev_b32 v11, 1, v9
    v_lshl_add_u32 v11, v11, 9, v10
    v_lshl_add_u32 v11, v8, 4, v11
    v_and_b32 v12, 1, v9
    v_cmp_eq_u32 vcc, 4, v9
    v_lshl_add_u32 v11, v12, 3, v11
    v_lshl_add_u32 v10, v8, 3, v10
    v_add_u32 v10, 1024, v10
    v_cndmask_b32 v230, v11, v10, vcc
    v_add_u32 v12, 12, v3
    v_mul_u32_u24 v10, 13108, v12
    v_lshrrev_b32 v10, 16, v10
    v_mul_u32_u24 v9, 5, v10
    v_sub_u32 v9, v12, v9
    v_mul_u32_u24 v10, 1280, v10
    v_add_u32 v10, s52, v10
    v_lshrrev_b32 v11, 1, v9
    v_lshl_add_u32 v11, v11, 9, v10
    v_lshl_add_u32 v11, v8, 4, v11
    v_and_b32 v12, 1, v9
    v_cmp_eq_u32 vcc, 4, v9
    v_lshl_add_u32 v11, v12, 3, v11
    v_lshl_add_u32 v10, v8, 3, v10
    v_add_u32 v10, 1024, v10
    v_cndmask_b32 v231, v11, v10, vcc
    v_add_u32 v12, 16, v3
    v_mul_u32_u24 v10, 13108, v12
    v_lshrrev_b32 v10, 16, v10
    v_mul_u32_u24 v9, 5, v10
    v_sub_u32 v9, v12, v9
    v_mul_u32_u24 v10, 1280, v10
    v_add_u32 v10, s52, v10
    v_lshrrev_b32 v11, 1, v9
    v_lshl_add_u32 v11, v11, 9, v10
    v_lshl_add_u32 v11, v8, 4, v11
    v_and_b32 v12, 1, v9
    v_cmp_eq_u32 vcc, 4, v9
    v_lshl_add_u32 v11, v12, 3, v11
    v_lshl_add_u32 v10, v8, 3, v10
    v_add_u32 v10, 1024, v10
    v_cndmask_b32 v232, v11, v10, vcc
    s_lshl_b32 s31, s28, 6
    v_lshrrev_b32 v5, 2, v1
    v_add_u32 v5, s31, v5
    v_mul_u32_u24 v5, 1280, v5
    v_and_b32 v6, 3, v1
    v_lshl_add_u32 v5, v6, 4, v5
    s_mul_i32 s52, s30, 320
    v_add_u32 v5, s52, v5
    s_lshl_b32 s52, s30, 4
    s_add_u32 s31, s31, s52
    v_mov_b32 v235, v5
    s_mul_i32 s52, s80, 20480
    buffer_load_dwordx4 v[16:19], v235, s[40:43], s52 offen offset:0
    buffer_load_dwordx4 v[20:23], v235, s[40:43], s52 offen offset:64
    buffer_load_dwordx4 v[24:27], v235, s[40:43], s52 offen offset:128
    buffer_load_dwordx4 v[28:31], v235, s[40:43], s52 offen offset:192
    buffer_load_dwordx4 v[32:35], v235, s[40:43], s52 offen offset:256
    s_mul_i32 s52, s81, 20480
    buffer_load_dwordx4 v[36:39], v235, s[40:43], s52 offen offset:0
    buffer_load_dwordx4 v[40:43], v235, s[40:43], s52 offen offset:64
    buffer_load_dwordx4 v[44:47], v235, s[40:43], s52 offen offset:128
    buffer_load_dwordx4 v[48:51], v235, s[40:43], s52 offen offset:192
    buffer_load_dwordx4 v[52:55], v235, s[40:43], s52 offen offset:256
    s_lshl_b32 s52, s2, 2
    s_add_u32 s52, s52, s30
    s_cmp_ge_u32 s52, 960
    s_cselect_b32 s53, 960, 0
    s_sub_u32 s53, s52, s53
    v_lshrrev_b32 v5, 2, v1
    v_and_b32 v6, 3, v1
    v_lshlrev_b32 v6, 4, v6
    s_mul_i32 s54, s53, 21846
    s_lshr_b32 s54, s54, 20
    s_mul_i32 s55, s54, 48
    s_sub_u32 s55, s53, s55
    v_mul_u32_u24 v96, 3072, v5
    v_add_u32 v96, v96, v6
    s_mul_i32 s88, s54, 98304
    s_lshl_b32 s57, s55, 6
    s_add_u32 s88, s88, s57
    s_lshl_b32 s55, s55, 1
    s_mul_i32 s56, s55, 349526
    s_lshr_b32 s56, s56, 20
    s_mul_i32 s57, s56, 3
    s_sub_u32 s57, s55, s57
    s_mul_i32 s56, s56, 60
    s_mul_i32 s60, s54, 3
    s_add_u32 s56, s56, s57
    s_add_u32 s56, s56, s60
    s_lshl_b32 s56, s56, 10
    s_add_u32 s60, s56, 14680064
    s_add_u32 s55, s55, 1
    s_mul_i32 s56, s55, 349526
    s_lshr_b32 s56, s56, 20
    s_mul_i32 s57, s56, 3
    s_sub_u32 s57, s55, s57
    s_mul_i32 s56, s56, 60
    s_mul_i32 s61, s54, 3
    s_add_u32 s56, s56, s57
    s_add_u32 s56, s56, s61
    s_lshl_b32 s56, s56, 10
    s_add_u32 s61, s56, 14680064
    s_mul_i32 s54, s53, 52429
    s_lshr_b32 s54, s54, 20
    s_mul_i32 s55, s54, 20
    s_sub_u32 s55, s53, s55
    v_mul_u32_u24 v97, 1280, v5
    v_add_u32 v97, v97, v6
    s_mul_i32 s89, s54, 40960
    s_lshl_b32 s57, s55, 6
    s_add_u32 s89, s89, s57
    s_lshl_b32 s55, s55, 1
    s_mul_i32 s56, s55, 209716
    s_lshr_b32 s56, s56, 20
    s_mul_i32 s57, s56, 5
    s_sub_u32 s57, s55, s57
    s_mul_i32 s56, s56, 240
    s_mul_i32 s62, s54, 5
    s_add_u32 s56, s56, s57
    s_add_u32 s56, s56, s62
    s_lshl_b32 s56, s56, 10
    s_add_u32 s62, s56, 16777216
    s_add_u32 s55, s55, 1
    s_mul_i32 s56, s55, 209716
    s_lshr_b32 s56, s56, 20
    s_mul_i32 s57, s56, 5
    s_sub_u32 s57, s55, s57
    s_mul_i32 s56, s56, 240
    s_mul_i32 s63, s54, 5
    s_add_u32 s56, s56, s57
    s_add_u32 s56, s56, s63
    s_lshl_b32 s56, s56, 10
    s_add_u32 s63, s56, 16777216
    s_mul_i32 s54, s52, 2622
    s_lshr_b32 s54, s54, 20
    s_mul_i32 s53, s54, 400
    s_sub_u32 s53, s52, s53
    s_mul_i32 s54, s53, 52429
    s_lshr_b32 s54, s54, 20
    s_mul_i32 s55, s54, 20
    s_sub_u32 s55, s53, s55
    s_lshl_b32 s56, s54, 2
    s_lshl_b32 s90, s55, 6
    v_lshrrev_b32 v11, 5, v1
    v_add_u32 v11, 0, v11
    v_add_u32 v11, s56, v11
    v_mul_u32_u24 v12, 6554, v11
    v_lshrrev_b32 v12, 16, v12
    v_mul_u32_u24 v13, 10, v12
    v_sub_u32 v13, v11, v13
    v_mul_u32_u24 v12, 80, v12
    v_and_b32 v11, 3, v5
    v_add_u32 v12, v12, v11
    v_bfe_u32 v11, v1, 4, 1
    v_lshrrev_b32 v8, 1, v13
    v_mul_u32_u24 v8, 20, v8
    v_and_b32 v10, 1, v13
    v_lshl_add_u32 v8, v10, 2, v8
    v_lshl_add_u32 v8, v11, 3, v8
    v_mul_u32_u24 v10, 40, v10
    v_mul_u32_u24 v11, 20, v11
    v_cmp_le_u32 vcc, 8, v13
    v_add3_u32 v10, v10, v11, 16
    s_nop 0
    v_cndmask_b32 v8, v8, v10, vcc
    v_add_u32 v12, v12, v8
    v_mul_u32_u24 v12, 1280, v12
    v_add_u32 v98, v12, v6
    v_lshrrev_b32 v11, 5, v1
    v_add_u32 v11, 2, v11
    v_add_u32 v11, s56, v11
    v_mul_u32_u24 v12, 6554, v11
    v_lshrrev_b32 v12, 16, v12
    v_mul_u32_u24 v13, 10, v12
    v_sub_u32 v13, v11, v13
    v_mul_u32_u24 v12, 80, v12
    v_and_b32 v11, 3, v5
    v_add_u32 v12, v12, v11
    v_bfe_u32 v11, v1, 4, 1
    v_lshrrev_b32 v8, 1, v13
    v_mul_u32_u24 v8, 20, v8
    v_and_b32 v10, 1, v13
    v_lshl_add_u32 v8, v10, 2, v8
    v_lshl_add_u32 v8, v11, 3, v8
    v_mul_u32_u24 v10, 40, v10
    v_mul_u32_u24 v11, 20, v11
    v_cmp_le_u32 vcc, 8, v13
    v_add3_u32 v10, v10, v11, 16
    s_nop 0
    v_cndmask_b32 v8, v8, v10, vcc
    v_add_u32 v12, v12, v8
    v_mul_u32_u24 v12, 1280, v12
    v_add_u32 v99, v12, v6
    s_lshl_b32 s55, s55, 1
    s_mul_i32 s56, s55, 209716
    s_lshr_b32 s56, s56, 20
    s_mul_i32 s57, s56, 5
    s_sub_u32 s57, s55, s57
    s_mul_i32 s56, s56, 100
    s_mul_i32 s64, s54, 5
    s_add_u32 s56, s56, s57
    s_add_u32 s56, s56, s64
    s_lshl_b32 s56, s56, 10
    s_add_u32 s64, s56, 13631488
    s_add_u32 s55, s55, 1
    s_mul_i32 s56, s55, 209716
    s_lshr_b32 s56, s56, 20
    s_mul_i32 s57, s56, 5
    s_sub_u32 s57, s55, s57
    s_mul_i32 s56, s56, 100
    s_mul_i32 s65, s54, 5
    s_add_u32 s56, s56, s57
    s_add_u32 s56, s56, s65
    s_lshl_b32 s56, s56, 10
    s_add_u32 s65, s56, 13631488
    s_mov_b32 s79, 0
    s_mul_i32 s68, s28, 81920
    s_mul_i32 s52, s29, 2560
    s_add_u32 s68, s68, s52
    s_add_u32 s68, s68, 1048576
    s_lshr_b32 s52, s30, 1
    s_lshl_b32 s52, s52, 8
    s_and_b32 s53, s30, 1
    s_lshl_b32 s53, s53, 3
    s_add_u32 s52, s52, s53
    s_add_u32 s69, s68, s52
    s_add_u32 s69, s69, 2048
    s_lshl_b32 s52, s30, 9
    s_add_u32 s68, s68, s52
    s_mul_i32 s70, s29, 102400
    s_mul_i32 s71, s30, 25600
    s_add_u32 s70, s70, s71
    s_add_u32 s70, s70, 13631488
    s_lshl_b32 s72, s29, 2
    s_add_u32 s72, s72, s30
    s_mul_i32 s72, s72, 61440
    s_add_u32 s73, s72, 16777216
    s_add_u32 s72, s72, 14680064
    s_mul_i32 s74, s30, 15360
    s_mul_i32 s75, s30, 40960
    s_add_u32 s75, s75, 196608
    s_mul_i32 s67, s29, 160
    s_lshl_b32 s52, s29, 2
    s_add_u32 s52, s52, s30
    s_mul_i32 s78, s52, 2560
    s_mul_i32 s53, s28, 81920
    s_add_u32 s78, s78, s53
    s_mul_i32 s93, s52, 1536
    s_mul_i32 s53, s28, 49152
    s_add_u32 s93, s93, s53
    v_cmp_eq_u32 vcc, 20, v1
    v_mov_b32 v10, 0x3f803f80
    v_mov_b32 v11, 0
    v_mov_b32 v12, 0x3afe3f80
    v_mov_b32 v13, 0
    v_cndmask_b32 v12, 0, v12, vcc
    s_nop 1
    v_mfma_f32_32x32x8_bf16 a[80:95], v[10:11], v[12:13], 0
    v_mfma_f32_32x32x8_bf16 a[96:111], v[10:11], v[12:13], 0
    v_mfma_f32_32x32x8_bf16 a[112:127], v[10:11], v[12:13], 0
    v_mfma_f32_32x32x8_bf16 a[128:143], v[10:11], v[12:13], 0
    v_mfma_f32_32x32x8_bf16 a[144:159], v[10:11], v[12:13], 0
    v_mfma_f32_32x32x8_bf16 a[160:175], v[10:11], v[12:13], 0
    v_mfma_f32_32x32x8_bf16 a[176:191], v[10:11], v[12:13], 0
    v_mfma_f32_32x32x8_bf16 a[192:207], v[10:11], v[12:13], 0
    s_waitcnt lgkmcnt(0)
    s_mul_i32 s32, s32, 0x9e3779b1
    s_add_u32 s32, s32, 0x7f4a7c15
    s_xor_b32 s33, s32, 0xa5a5a5a5
    s_waitcnt vmcnt(10)
    v_lshlrev_b32 v100, 16, v148
    v_and_b32 v101, s91, v148
    v_lshlrev_b32 v102, 16, v149
    v_and_b32 v103, s91, v149
    v_mul_f32 v104, 0xbfb8aa3b, v100
    v_mul_f32 v105, 0xbfb8aa3b, v101
    v_mul_f32 v106, 0xbfb8aa3b, v102
    v_mul_f32 v107, 0xbfb8aa3b, v103
    v_exp_f32 v104, v104
    v_exp_f32 v105, v105
    v_exp_f32 v106, v106
    v_exp_f32 v107, v107
    s_nop 0
    v_add_f32 v104, 1.0, v104
    v_add_f32 v105, 1.0, v105
    v_add_f32 v106, 1.0, v106
    v_add_f32 v107, 1.0, v107
    v_rcp_f32 v104, v104
    v_rcp_f32 v105, v105
    v_rcp_f32 v106, v106
    v_rcp_f32 v107, v107
    s_nop 0
    v_mul_f32 v100, v100, v104
    v_mul_f32 v101, v101, v105
    v_mul_f32 v102, v102, v106
    v_mul_f32 v103, v103, v107
    v_cvt_pk_bf16_f32 v148, v100, v101
    v_cvt_pk_bf16_f32 v149, v102, v103
    v_accvgpr_write_b32 a254, v148
    v_accvgpr_write_b32 a255, v149
    s_add_u32 s53, s77, 24576
    v_and_b32 v5, 3, v1
    v_lshrrev_b32 v6, 2, v1
    v_lshlrev_b32 v8, 1, v5
    v_xor_b32 v6, v6, v8
    v_lshlrev_b32 v6, 4, v6
    v_lshl_add_u32 v5, v5, 8, v6
    v_add_u32 v5, s53, v5
    v_lshlrev_b32 v8, 1, v3
    v_xor_b32 v6, v2, v8
    v_lshlrev_b32 v6, 4, v6
    v_lshl_add_u32 v6, v3, 8, v6
    v_add_u32 v6, s53, v6
    v_and_b32 v8, 3, v2
    s_lshl_b32 s53, s30, 3
    s_add_u32 s53, s53, 153600
    v_lshlrev_b32 v9, 5, v2
    v_add_u32 v10, s53, v9
    v_add_u32 v9, 153600, v9
    v_mov_b32 v132, 0x3f803f80
    v_mov_b32 v133, 0x3f803f80
    v_mov_b32 v134, 0x3f803f80
    v_mov_b32 v135, 0x3f803f80
    v_cmp_eq_u32 s[54:55], 1, v8
    v_cmp_eq_u32 s[56:57], 2, v8
    v_cmp_eq_u32 vcc, 3, v8
    v_min_u32 v11, 39, v1
    v_lshlrev_b32 v11, 4, v11
    s_mul_i32 s59, s30, 640
    s_add_u32 s59, s59, 4096
    s_waitcnt vmcnt(5)
    ds_write_b128 v5, v[16:19] offset:0
    ds_write_b128 v5, v[20:23] offset:1024
    ds_write_b128 v5, v[24:27] offset:2048
    ds_write_b128 v5, v[28:31] offset:3072
    ds_write_b128 v5, v[32:35] offset:4096
    s_bitcmp1_b32 s29, 0
    s_cselect_b32 s48, s10, s8
    s_cselect_b32 s49, s11, s9
    s_mov_b32 s50, 25600
    s_mov_b32 s51, 0x00020000
    s_mul_i32 s53, s30, 6400
    s_add_u32 m0, s53, 122880
    s_nop 0
    buffer_load_dwordx4 v4, s[48:51], s53 offen offset:0 lds
    buffer_load_dwordx4 v4, s[48:51], s53 offen offset:1024 lds
    buffer_load_dwordx4 v4, s[48:51], s53 offen offset:2048 lds
    buffer_load_dwordx4 v4, s[48:51], s53 offen offset:3072 lds
    s_add_u32 m0, m0, 4096
    s_add_u32 s53, s53, 4096
    buffer_load_dwordx4 v4, s[48:51], s53 offen offset:0 lds
    buffer_load_dwordx4 v4, s[48:51], s53 offen offset:1024 lds
    s_mov_b64 exec, 0xffff
    buffer_load_dwordx4 v4, s[48:51], s53 offen offset:2048 lds
    s_mov_b64 exec, -1
    s_mul_i32 s52, s82, 20480
    buffer_load_dwordx4 v[56:59], v235, s[40:43], s52 offen offset:0
    buffer_load_dwordx4 v[60:63], v235, s[40:43], s52 offen offset:64
    buffer_load_dwordx4 v[64:67], v235, s[40:43], s52 offen offset:128
    buffer_load_dwordx4 v[68:71], v235, s[40:43], s52 offen offset:192
    buffer_load_dwordx4 v[72:75], v235, s[40:43], s52 offen offset:256
    ds_read_b128 v[16:19], v6 offset:0
    ds_read_b128 v[20:23], v6 offset:1024
    ds_read_b128 v[24:27], v6 offset:2048
    ds_read_b128 v[28:31], v6 offset:3072
    ds_read_b128 v[32:35], v6 offset:4096
    s_waitcnt vmcnt(12)
    ds_write_b128 v5, v[36:39] offset:0
    ds_write_b128 v5, v[40:43] offset:1024
    ds_write_b128 v5, v[44:47] offset:2048
    ds_write_b128 v5, v[48:51] offset:3072
    ds_write_b128 v5, v[52:55] offset:4096
    s_mul_i32 s52, s83, 20480
    buffer_load_dwordx4 v[76:79], v235, s[40:43], s52 offen offset:0
    buffer_load_dwordx4 v[80:83], v235, s[40:43], s52 offen offset:64
    buffer_load_dwordx4 v[84:87], v235, s[40:43], s52 offen offset:128
    buffer_load_dwordx4 v[88:91], v235, s[40:43], s52 offen offset:192
    buffer_load_dwordx4 v[92:95], v235, s[40:43], s52 offen offset:256
    s_waitcnt lgkmcnt(9)
    v_mfma_f32_16x16x32_bf16 v[100:103], v[132:135], v[16:19], 0
    v_mfma_f32_16x16x32_bf16 v[116:119], v[16:19], v[16:19], 0
    s_waitcnt lgkmcnt(8)
    v_mfma_f32_16x16x32_bf16 v[100:103], v[132:135], v[20:23], v[100:103]
    v_mfma_f32_16x16x32_bf16 v[116:119], v[20:23], v[20:23], v[116:119]
    s_waitcnt lgkmcnt(7)
    v_mfma_f32_16x16x32_bf16 v[100:103], v[132:135], v[24:27], v[100:103]
    v_mfma_f32_16x16x32_bf16 v[116:119], v[24:27], v[24:27], v[116:119]
    s_waitcnt lgkmcnt(6)
    v_mfma_f32_16x16x32_bf16 v[100:103], v[132:135], v[28:31], v[100:103]
    v_mfma_f32_16x16x32_bf16 v[116:119], v[28:31], v[28:31], v[116:119]
    s_waitcnt lgkmcnt(5)
    v_mfma_f32_16x16x32_bf16 v[100:103], v[132:135], v[32:35], v[100:103]
    v_mfma_f32_16x16x32_bf16 v[116:119], v[32:35], v[32:35], v[116:119]
    ds_read_b128 v[36:39], v6 offset:0
    ds_read_b128 v[40:43], v6 offset:1024
    ds_read_b128 v[44:47], v6 offset:2048
    ds_read_b128 v[48:51], v6 offset:3072
    ds_read_b128 v[52:55], v6 offset:4096
    s_waitcnt vmcnt(5)
    ds_write_b128 v5, v[56:59] offset:0
    ds_write_b128 v5, v[60:63] offset:1024
    ds_write_b128 v5, v[64:67] offset:2048
    ds_write_b128 v5, v[68:71] offset:3072
    ds_write_b128 v5, v[72:75] offset:4096
    v_lshlrev_b32 v13, 7, v1
    s_lshr_b32 s52, s2, 3
    s_lshl_b32 s52, s52, 2
    s_add_u32 s52, s52, s30
    s_mul_i32 s52, s52, 6400
    s_mov_b32 exec_lo, 0xffffffff
    s_mov_b32 exec_hi, 0x3ffff
    buffer_load_dword v14, v13, s[44:47], s52 offen
    s_mov_b64 exec, -1
    v_cndmask_b32 v116, v116, v117, s[54:55]
    v_cndmask_b32 v116, v116, v118, s[56:57]
    v_cndmask_b32 v101, v116, v119, vcc
    s_mov_b32 exec_lo, 15728655
    s_mov_b32 exec_hi, 4026535680
    ds_write_b64 v10, v[100:101] offset:0
    s_mov_b64 exec, -1
    s_waitcnt lgkmcnt(10)
    v_mfma_f32_16x16x32_bf16 v[104:107], v[132:135], v[36:39], 0
    v_mfma_f32_16x16x32_bf16 v[120:123], v[36:39], v[36:39], 0
    s_waitcnt lgkmcnt(9)
    v_mfma_f32_16x16x32_bf16 v[104:107], v[132:135], v[40:43], v[104:107]
    v_mfma_f32_16x16x32_bf16 v[120:123], v[40:43], v[40:43], v[120:123]
    s_waitcnt lgkmcnt(8)
    v_mfma_f32_16x16x32_bf16 v[104:107], v[132:135], v[44:47], v[104:107]
    v_mfma_f32_16x16x32_bf16 v[120:123], v[44:47], v[44:47], v[120:123]
    s_waitcnt lgkmcnt(7)
    v_mfma_f32_16x16x32_bf16 v[104:107], v[132:135], v[48:51], v[104:107]
    v_mfma_f32_16x16x32_bf16 v[120:123], v[48:51], v[48:51], v[120:123]
    s_waitcnt lgkmcnt(6)
    v_mfma_f32_16x16x32_bf16 v[104:107], v[132:135], v[52:55], v[104:107]
    v_mfma_f32_16x16x32_bf16 v[120:123], v[52:55], v[52:55], v[120:123]
    ds_read_b128 v[56:59], v6 offset:0
    ds_read_b128 v[60:63], v6 offset:1024
    ds_read_b128 v[64:67], v6 offset:2048
    ds_read_b128 v[68:71], v6 offset:3072
    ds_read_b128 v[72:75], v6 offset:4096
    s_waitcnt lgkmcnt(0)
    ds_read_b64_tr_b16 v[180:181], v233 offset:0
    ds_read_b64_tr_b16 v[182:183], v233 offset:160
    ds_read_b64_tr_b16 v[184:185], v233 offset:32
    ds_read_b64_tr_b16 v[186:187], v233 offset:192
    ds_read_b64_tr_b16 v[188:189], v233 offset:1280
    ds_read_b64_tr_b16 v[190:191], v233 offset:1440
    ds_read_b64_tr_b16 v[192:193], v233 offset:1312
    ds_read_b64_tr_b16 v[194:195], v233 offset:1472
    ds_read_b64_tr_b16 v[196:197], v233 offset:2560
    ds_read_b64_tr_b16 v[198:199], v233 offset:2720
    ds_read_b64_tr_b16 v[200:201], v233 offset:2592
    ds_read_b64_tr_b16 v[202:203], v233 offset:2752
    s_waitcnt lgkmcnt(4)
    ds_read_b64_tr_b16 v[204:205], v233 offset:3840
    ds_read_b64_tr_b16 v[206:207], v233 offset:4000
    ds_read_b64_tr_b16 v[208:209], v233 offset:3872
    ds_read_b64_tr_b16 v[210:211], v233 offset:4032
    ds_read_b64_tr_b16 v[212:213], v233 offset:5120
    ds_read_b64_tr_b16 v[214:215], v233 offset:5280
    ds_read_b64_tr_b16 v[216:217], v233 offset:5152
    ds_read_b64_tr_b16 v[218:219], v233 offset:5312
    s_waitcnt lgkmcnt(8)
    s_waitcnt vmcnt(1)
    s_barrier
    buffer_load_dwordx4 v[140:143], v11, s[36:39], s59 offen offset:0 sc1
    buffer_load_dwordx4 v[144:147], v11, s[36:39], s59 offen offset:2560 sc1
    ds_read_b128 v[136:139], v9
    ds_read_b128 v[156:159], v9 offset:16
    ds_write_b128 v5, v[76:79] offset:0
    ds_write_b128 v5, v[80:83] offset:1024
    ds_write_b128 v5, v[84:87] offset:2048
    ds_write_b128 v5, v[88:91] offset:3072
    ds_write_b128 v5, v[92:95] offset:4096
    s_waitcnt lgkmcnt(15)
    v_mfma_f32_16x16x32_bf16 v[108:111], v[132:135], v[56:59], 0
    v_mfma_f32_16x16x32_bf16 v[124:127], v[56:59], v[56:59], 0
    s_waitcnt lgkmcnt(15)
    v_mfma_f32_16x16x32_bf16 v[108:111], v[132:135], v[60:63], v[108:111]
    v_mfma_f32_16x16x32_bf16 v[124:127], v[60:63], v[60:63], v[124:127]
    s_waitcnt lgkmcnt(15)
    v_mfma_f32_16x16x32_bf16 v[108:111], v[132:135], v[64:67], v[108:111]
    v_mfma_f32_16x16x32_bf16 v[124:127], v[64:67], v[64:67], v[124:127]
    s_waitcnt lgkmcnt(15)
    v_mfma_f32_16x16x32_bf16 v[108:111], v[132:135], v[68:71], v[108:111]
    v_mfma_f32_16x16x32_bf16 v[124:127], v[68:71], v[68:71], v[124:127]
    s_waitcnt lgkmcnt(15)
    v_mfma_f32_16x16x32_bf16 v[108:111], v[132:135], v[72:75], v[108:111]
    v_mfma_f32_16x16x32_bf16 v[124:127], v[72:75], v[72:75], v[124:127]
    ds_read_b128 v[76:79], v6 offset:0
    ds_read_b128 v[80:83], v6 offset:1024
    ds_read_b128 v[84:87], v6 offset:2048
    ds_read_b128 v[88:91], v6 offset:3072
    ds_read_b128 v[92:95], v6 offset:4096
    s_waitcnt lgkmcnt(10)
    v_pk_add_f32 v[136:137], v[136:137], v[138:139]
    v_pk_add_f32 v[156:157], v[156:157], v[158:159]
    v_pk_add_f32 v[136:137], v[136:137], v[156:157]
    v_mul_f32 v136, 0x3acccccd, v136
    v_mul_f32 v137, 0x3acccccd, v137
    v_fma_f32 v137, -v136, v136, v137
    v_max_f32 v137, 0, v137
    v_add_f32 v137, 0x3727c5ac, v137
    v_rsq_f32 v236, v137
    s_nop 0
    v_mul_f32 v237, -v136, v236
    s_waitcnt lgkmcnt(4)
    v_mfma_f32_16x16x32_bf16 v[112:115], v[132:135], v[76:79], 0
    v_mfma_f32_16x16x32_bf16 v[128:131], v[76:79], v[76:79], 0
    s_waitcnt lgkmcnt(3)
    v_mfma_f32_16x16x32_bf16 v[112:115], v[132:135], v[80:83], v[112:115]
    v_mfma_f32_16x16x32_bf16 v[128:131], v[80:83], v[80:83], v[128:131]
    s_waitcnt lgkmcnt(2)
    v_mfma_f32_16x16x32_bf16 v[112:115], v[132:135], v[84:87], v[112:115]
    v_mfma_f32_16x16x32_bf16 v[128:131], v[84:87], v[84:87], v[128:131]
    s_waitcnt lgkmcnt(1)
    v_mfma_f32_16x16x32_bf16 v[112:115], v[132:135], v[88:91], v[112:115]
    v_mfma_f32_16x16x32_bf16 v[128:131], v[88:91], v[88:91], v[128:131]
    s_waitcnt lgkmcnt(0)
    v_mfma_f32_16x16x32_bf16 v[112:115], v[132:135], v[92:95], v[112:115]
    v_mfma_f32_16x16x32_bf16 v[128:131], v[92:95], v[92:95], v[128:131]
    s_nop 4
    v_cndmask_b32 v120, v120, v121, s[54:55]
    v_cndmask_b32 v120, v120, v122, s[56:57]
    v_cndmask_b32 v105, v120, v123, vcc
    v_cndmask_b32 v124, v124, v125, s[54:55]
    v_cndmask_b32 v124, v124, v126, s[56:57]
    v_cndmask_b32 v109, v124, v127, vcc
    v_cndmask_b32 v128, v128, v129, s[54:55]
    v_cndmask_b32 v128, v128, v130, s[56:57]
    v_cndmask_b32 v113, v128, v131, vcc
    s_mov_b32 exec_lo, 15728655
    s_mov_b32 exec_hi, 4026535680
    ds_write_b64 v10, v[104:105] offset:512
    ds_write_b64 v10, v[108:109] offset:1024
    ds_write_b64 v10, v[112:113] offset:1536
    s_mov_b64 exec, -1
    v_mov_b32 v13, v9
L_join:
    s_mul_i32 s52, s30, 1280
    s_add_u32 s52, s52, 148480
    v_lshlrev_b32 v9, 5, v3
    v_add_u32 v9, s52, v9
    v_add_u32 v5, s52, v11
    s_lshl_b32 s52, s30, 11
    s_add_u32 s52, s52, 155648
    v_add_u32 v10, s52, v4
    s_add_u32 m0, s77, 0
    s_add_u32 s52, s76, 0
    buffer_load_dwordx4 v7, s[44:47], s52 offen lds
    s_add_u32 m0, s77, 1024
    s_add_u32 s52, s76, 20480
    buffer_load_dwordx4 v7, s[44:47], s52 offen lds
    s_waitcnt lgkmcnt(3)
    s_mov_b32 s58, 8388608
    s_waitcnt vmcnt(2)
    s_branch L_adaLN_cond__grouped_kv_mqa__dense_activation_silu__prompt_kernel_pmodc_6
L_adaLN_cond__grouped_kv_mqa__dense_activation_silu__prompt_kernel_pmod_5:
    buffer_load_dwordx4 v[140:143], v11, s[36:39], s59 offen offset:0 sc1
    buffer_load_dwordx4 v[144:147], v11, s[36:39], s59 offen offset:2560 sc1
    s_sub_u32 s58, s58, 1
    s_cbranch_scc1 L_adaLN_cond__grouped_kv_mqa__dense_activation_silu__prompt_kernel_pmodd_7
    s_waitcnt vmcnt(0)
L_adaLN_cond__grouped_kv_mqa__dense_activation_silu__prompt_kernel_pmodc_6:
    v_cmp_ne_u64 vcc, s[32:33], v[142:143]
    v_cmp_ne_u64 s[56:57], s[32:33], v[146:147]
    s_or_b64 vcc, vcc, s[56:57]
    s_cbranch_vccz L_adaLN_cond__grouped_kv_mqa__dense_activation_silu__prompt_kernel_pmodd_7
    s_sleep 1
    s_branch L_adaLN_cond__grouped_kv_mqa__dense_activation_silu__prompt_kernel_pmod_5
L_adaLN_cond__grouped_kv_mqa__dense_activation_silu__prompt_kernel_pmodd_7:
    v_lshlrev_b32 v152, 16, v144
    v_and_b32 v153, s91, v144
    v_lshlrev_b32 v154, 16, v145
    v_and_b32 v155, s91, v145
    v_lshlrev_b32 v148, 16, v140
    v_and_b32 v149, s91, v140
    v_lshlrev_b32 v150, 16, v141
    v_and_b32 v151, s91, v141
    v_add_f32 v152, 1.0, v152
    v_add_f32 v153, 1.0, v153
    v_add_f32 v154, 1.0, v154
    v_add_f32 v155, 1.0, v155
    ds_write_b128 v5, v[148:151]
    v_cvt_pk_bf16_f32 v144, v152, v153
    v_cvt_pk_bf16_f32 v145, v154, v155
    v_lshlrev_b32 v152, 16, v144
    v_and_b32 v153, s91, v144
    v_lshlrev_b32 v154, 16, v145
    v_and_b32 v155, s91, v145
    ds_write_b128 v5, v[152:155] offset:640
    v_add_u32 v11, s77, v4
    ds_read_b128 v[108:111], v9 offset:640
    ds_read_b128 v[100:103], v9 offset:0
    ds_read_b128 v[112:115], v9 offset:656
    ds_read_b128 v[104:107], v9 offset:16
    ds_read_b128 v[124:127], v9 offset:768
    ds_read_b128 v[116:119], v9 offset:128
    ds_read_b128 v[128:131], v9 offset:784
    ds_read_b128 v[120:123], v9 offset:144
    s_waitcnt lgkmcnt(3)
    ds_read_b128 v[140:143], v9 offset:896
    ds_read_b128 v[132:135], v9 offset:256
    ds_read_b128 v[144:147], v9 offset:912
    ds_read_b128 v[136:139], v9 offset:272
    ds_read_b128 v[156:159], v9 offset:1024
    ds_read_b128 v[148:151], v9 offset:384
    ds_read_b128 v[160:163], v9 offset:1040
    ds_read_b128 v[152:155], v9 offset:400
    ds_read_b128 v[172:175], v9 offset:1152
    ds_read_b128 v[164:167], v9 offset:512
    ds_read_b128 v[176:179], v9 offset:1168
    ds_read_b128 v[168:171], v9 offset:528
    v_lshlrev_b32 v244, 16, v16
    v_and_b32 v245, s91, v16
    v_lshlrev_b32 v246, 16, v17
    v_and_b32 v247, s91, v17
    v_lshlrev_b32 v248, 16, v18
    v_and_b32 v249, s91, v18
    v_lshlrev_b32 v250, 16, v19
    v_and_b32 v251, s91, v19
    v_pk_fma_f32 v[244:245], v[244:245], v[236:237], v[236:237] op_sel:[0,0,1] op_sel_hi:[1,0,1]
    v_pk_fma_f32 v[246:247], v[246:247], v[236:237], v[236:237] op_sel:[0,0,1] op_sel_hi:[1,0,1]
    v_pk_fma_f32 v[248:249], v[248:249], v[236:237], v[236:237] op_sel:[0,0,1] op_sel_hi:[1,0,1]
    v_pk_fma_f32 v[250:251], v[250:251], v[236:237], v[236:237] op_sel:[0,0,1] op_sel_hi:[1,0,1]
    s_waitcnt lgkmcnt(15)
    v_pk_fma_f32 v[244:245], v[244:245], v[108:109], v[100:101]
    v_pk_fma_f32 v[246:247], v[246:247], v[110:111], v[102:103]
    v_pk_fma_f32 v[248:249], v[248:249], v[112:113], v[104:105]
    v_pk_fma_f32 v[250:251], v[250:251], v[114:115], v[106:107]
    v_cvt_pk_bf16_f32 v16, v244, v245
    v_cvt_pk_bf16_f32 v17, v246, v247
    v_cvt_pk_bf16_f32 v18, v248, v249
    v_cvt_pk_bf16_f32 v19, v250, v251
    s_add_u32 m0, s77, 2048
    s_add_u32 s52, s76, 64
    buffer_load_dwordx4 v7, s[44:47], s52 offen lds
    v_lshlrev_b32 v244, 16, v20
    v_and_b32 v245, s91, v20
    v_lshlrev_b32 v246, 16, v21
    v_and_b32 v247, s91, v21
    v_lshlrev_b32 v248, 16, v22
    v_and_b32 v249, s91, v22
    v_lshlrev_b32 v250, 16, v23
    v_and_b32 v251, s91, v23
    v_pk_fma_f32 v[244:245], v[244:245], v[236:237], v[236:237] op_sel:[0,0,1] op_sel_hi:[1,0,1]
    v_pk_fma_f32 v[246:247], v[246:247], v[236:237], v[236:237] op_sel:[0,0,1] op_sel_hi:[1,0,1]
    v_pk_fma_f32 v[248:249], v[248:249], v[236:237], v[236:237] op_sel:[0,0,1] op_sel_hi:[1,0,1]
    v_pk_fma_f32 v[250:251], v[250:251], v[236:237], v[236:237] op_sel:[0,0,1] op_sel_hi:[1,0,1]
    s_waitcnt lgkmcnt(12)
    v_pk_fma_f32 v[244:245], v[244:245], v[124:125], v[116:117]
    v_pk_fma_f32 v[246:247], v[246:247], v[126:127], v[118:119]
    v_pk_fma_f32 v[248:249], v[248:249], v[128:129], v[120:121]
    v_pk_fma_f32 v[250:251], v[250:251], v[130:131], v[122:123]
    v_cvt_pk_bf16_f32 v20, v244, v245
    v_cvt_pk_bf16_f32 v21, v246, v247
    v_cvt_pk_bf16_f32 v22, v248, v249
    v_cvt_pk_bf16_f32 v23, v250, v251
    s_add_u32 m0, s77, 3072
    s_add_u32 s52, s76, 20544
    buffer_load_dwordx4 v7, s[44:47], s52 offen lds
    v_lshlrev_b32 v244, 16, v24
    v_and_b32 v245, s91, v24
    v_lshlrev_b32 v246, 16, v25
    v_and_b32 v247, s91, v25
    v_lshlrev_b32 v248, 16, v26
    v_and_b32 v249, s91, v26
    v_lshlrev_b32 v250, 16, v27
    v_and_b32 v251, s91, v27
    v_pk_fma_f32 v[244:245], v[244:245], v[236:237], v[236:237] op_sel:[0,0,1] op_sel_hi:[1,0,1]
    v_pk_fma_f32 v[246:247], v[246:247], v[236:237], v[236:237] op_sel:[0,0,1] op_sel_hi:[1,0,1]
    v_pk_fma_f32 v[248:249], v[248:249], v[236:237], v[236:237] op_sel:[0,0,1] op_sel_hi:[1,0,1]
    v_pk_fma_f32 v[250:251], v[250:251], v[236:237], v[236:237] op_sel:[0,0,1] op_sel_hi:[1,0,1]
    s_waitcnt lgkmcnt(8)
    v_pk_fma_f32 v[244:245], v[244:245], v[140:141], v[132:133]
    v_pk_fma_f32 v[246:247], v[246:247], v[142:143], v[134:135]
    v_pk_fma_f32 v[248:249], v[248:249], v[144:145], v[136:137]
    v_pk_fma_f32 v[250:251], v[250:251], v[146:147], v[138:139]
    v_cvt_pk_bf16_f32 v24, v244, v245
    v_cvt_pk_bf16_f32 v25, v246, v247
    v_cvt_pk_bf16_f32 v26, v248, v249
    v_cvt_pk_bf16_f32 v27, v250, v251
    s_add_u32 m0, s77, 4096
    s_add_u32 s52, s76, 128
    buffer_load_dwordx4 v7, s[44:47], s52 offen lds
    v_lshlrev_b32 v244, 16, v28
    v_and_b32 v245, s91, v28
    v_lshlrev_b32 v246, 16, v29
    v_and_b32 v247, s91, v29
    v_lshlrev_b32 v248, 16, v30
    v_and_b32 v249, s91, v30
    v_lshlrev_b32 v250, 16, v31
    v_and_b32 v251, s91, v31
    v_pk_fma_f32 v[244:245], v[244:245], v[236:237], v[236:237] op_sel:[0,0,1] op_sel_hi:[1,0,1]
    v_pk_fma_f32 v[246:247], v[246:247], v[236:237], v[236:237] op_sel:[0,0,1] op_sel_hi:[1,0,1]
    v_pk_fma_f32 v[248:249], v[248:249], v[236:237], v[236:237] op_sel:[0,0,1] op_sel_hi:[1,0,1]
    v_pk_fma_f32 v[250:251], v[250:251], v[236:237], v[236:237] op_sel:[0,0,1] op_sel_hi:[1,0,1]
    s_waitcnt lgkmcnt(4)
    v_pk_fma_f32 v[244:245], v[244:245], v[156:157], v[148:149]
    v_pk_fma_f32 v[246:247], v[246:247], v[158:159], v[150:151]
    v_pk_fma_f32 v[248:249], v[248:249], v[160:161], v[152:153]
    v_pk_fma_f32 v[250:251], v[250:251], v[162:163], v[154:155]
    v_cvt_pk_bf16_f32 v28, v244, v245
    v_cvt_pk_bf16_f32 v29, v246, v247
    v_cvt_pk_bf16_f32 v30, v248, v249
    v_cvt_pk_bf16_f32 v31, v250, v251
    s_add_u32 m0, s77, 5120
    s_add_u32 s52, s76, 20608
    buffer_load_dwordx4 v7, s[44:47], s52 offen lds
    v_lshlrev_b32 v244, 16, v32
    v_and_b32 v245, s91, v32
    v_lshlrev_b32 v246, 16, v33
    v_and_b32 v247, s91, v33
    v_lshlrev_b32 v248, 16, v34
    v_and_b32 v249, s91, v34
    v_lshlrev_b32 v250, 16, v35
    v_and_b32 v251, s91, v35
    v_pk_fma_f32 v[244:245], v[244:245], v[236:237], v[236:237] op_sel:[0,0,1] op_sel_hi:[1,0,1]
    v_pk_fma_f32 v[246:247], v[246:247], v[236:237], v[236:237] op_sel:[0,0,1] op_sel_hi:[1,0,1]
    v_pk_fma_f32 v[248:249], v[248:249], v[236:237], v[236:237] op_sel:[0,0,1] op_sel_hi:[1,0,1]
    v_pk_fma_f32 v[250:251], v[250:251], v[236:237], v[236:237] op_sel:[0,0,1] op_sel_hi:[1,0,1]
    s_waitcnt lgkmcnt(0)
    v_pk_fma_f32 v[244:245], v[244:245], v[172:173], v[164:165]
    v_pk_fma_f32 v[246:247], v[246:247], v[174:175], v[166:167]
    v_pk_fma_f32 v[248:249], v[248:249], v[176:177], v[168:169]
    v_pk_fma_f32 v[250:251], v[250:251], v[178:179], v[170:171]
    v_cvt_pk_bf16_f32 v32, v244, v245
    v_cvt_pk_bf16_f32 v33, v246, v247
    v_cvt_pk_bf16_f32 v34, v248, v249
    v_cvt_pk_bf16_f32 v35, v250, v251
    s_add_u32 m0, s77, 6144
    s_add_u32 s52, s76, 40960
    buffer_load_dwordx4 v7, s[44:47], s52 offen lds
    s_bitcmp1_b32 s29, 0
    s_cbranch_scc1 L_vori
    v_mfma_f32_16x16x32_bf16 v[220:223], v[180:183], v[16:19], 0
    v_mfma_f32_16x16x32_bf16 v[224:227], v[184:187], v[16:19], 0
    v_mfma_f32_16x16x32_bf16 v[220:223], v[188:191], v[20:23], v[220:223]
    v_mfma_f32_16x16x32_bf16 v[224:227], v[192:195], v[20:23], v[224:227]
    v_mfma_f32_16x16x32_bf16 v[220:223], v[196:199], v[24:27], v[220:223]
    v_mfma_f32_16x16x32_bf16 v[224:227], v[200:203], v[24:27], v[224:227]
    v_mfma_f32_16x16x32_bf16 v[220:223], v[204:207], v[28:31], v[220:223]
    v_mfma_f32_16x16x32_bf16 v[224:227], v[208:211], v[28:31], v[224:227]
    v_mfma_f32_16x16x32_bf16 v[220:223], v[212:215], v[32:35], v[220:223]
    v_mfma_f32_16x16x32_bf16 v[224:227], v[216:219], v[32:35], v[224:227]
    s_branch L_oridone
L_vori:
    v_mfma_f32_16x16x32_bf16 v[220:223], v[16:19], v[180:183], 0
    v_mfma_f32_16x16x32_bf16 v[224:227], v[16:19], v[184:187], 0
    v_mfma_f32_16x16x32_bf16 v[220:223], v[20:23], v[188:191], v[220:223]
    v_mfma_f32_16x16x32_bf16 v[224:227], v[20:23], v[192:195], v[224:227]
    v_mfma_f32_16x16x32_bf16 v[220:223], v[24:27], v[196:199], v[220:223]
    v_mfma_f32_16x16x32_bf16 v[224:227], v[24:27], v[200:203], v[224:227]
    v_mfma_f32_16x16x32_bf16 v[220:223], v[28:31], v[204:207], v[220:223]
    v_mfma_f32_16x16x32_bf16 v[224:227], v[28:31], v[208:211], v[224:227]
    v_mfma_f32_16x16x32_bf16 v[220:223], v[32:35], v[212:215], v[220:223]
    v_mfma_f32_16x16x32_bf16 v[224:227], v[32:35], v[216:219], v[224:227]
L_oridone:
    s_add_u32 m0, s77, 7168
    s_add_u32 s52, s76, 61440
    buffer_load_dwordx4 v7, s[44:47], s52 offen lds
    s_add_u32 m0, s77, 8192
    s_add_u32 s52, s76, 41024
    buffer_load_dwordx4 v7, s[44:47], s52 offen lds
    s_add_u32 m0, s77, 9216
    s_add_u32 s52, s76, 61504
    buffer_load_dwordx4 v7, s[44:47], s52 offen lds
    ds_write_b128 v10, v[220:223]
    ds_write_b128 v10, v[224:227] offset:1024
    s_add_u32 m0, s77, 10240
    s_add_u32 s52, s76, 41088
    buffer_load_dwordx4 v7, s[44:47], s52 offen lds
    s_add_u32 m0, s77, 11264
    s_add_u32 s52, s76, 61568
    buffer_load_dwordx4 v7, s[44:47], s52 offen lds
    s_waitcnt lgkmcnt(0)
    s_barrier
    ds_read_b128 v[180:183], v13 offset:512
    ds_read_b128 v[184:187], v13 offset:528
    ds_read_b128 v[188:191], v13 offset:1024
    ds_read_b128 v[192:195], v13 offset:1040
    ds_read_b128 v[244:247], v13 offset:1536
    ds_read_b128 v[248:251], v13 offset:1552
    s_cmp_ge_u32 s30, 2
    s_cbranch_scc1 L_nokv
    s_lshl_b32 s52, s30, 10
    s_add_u32 s52, s52, 155648
    v_add_u32 v10, s52, v4
    ds_read_b128 v[200:203], v10 offset:0
    ds_read_b128 v[204:207], v10 offset:2048
    ds_read_b128 v[208:211], v10 offset:4096
    ds_read_b128 v[212:215], v10 offset:6144
    s_mul_i32 s54, s28, 5120
    s_add_u32 s54, s54, 196608
    s_and_b32 s55, s29, 1
    s_cselect_b32 s56, 1.0, 0x3ea52b5c
    s_lshl_b32 s55, s55, 1
    s_add_u32 s55, s55, s30
    v_lshrrev_b32 v10, 1, v3
    s_waitcnt lgkmcnt(0)
    v_pk_add_f32 v[200:201], v[200:201], v[204:205]
    v_pk_add_f32 v[208:209], v[208:209], v[212:213]
    v_pk_add_f32 v[202:203], v[202:203], v[206:207]
    v_pk_add_f32 v[210:211], v[210:211], v[214:215]
    v_pk_add_f32 v[200:201], v[200:201], v[208:209]
    v_pk_add_f32 v[202:203], v[202:203], v[210:211]
    v_mul_f32 v200, s56, v200
    v_mul_f32 v201, s56, v201
    v_mul_f32 v202, s56, v202
    v_mul_f32 v203, s56, v203
    v_cvt_pk_bf16_f32 v200, v200, v201
    v_cvt_pk_bf16_f32 v201, v202, v203
    s_cmp_eq_u32 s55, 1
    s_cbranch_scc1 L_ktail
    v_mov_b32 v202, v200
    v_mov_b32 v203, v201
    s_nop 1
    v_permlane16_swap_b32 v200, v202
    v_permlane16_swap_b32 v201, v203
    s_cmp_eq_u32 s55, 0
    s_cbranch_scc0 L_vtile
    s_lshr_b32 s52, s80, 1
    s_lshl_b32 s52, s52, 10
    s_and_b32 s53, s80, 1
    s_lshl_b32 s53, s53, 8
    s_add_u32 s52, s52, s53
    s_add_u32 s54, s54, s52
    v_lshlrev_b32 v10, 9, v10
    v_lshl_add_u32 v10, v2, 4, v10
    s_mov_b32 exec_lo, 65535
    s_mov_b32 exec_hi, 65535
    s_branch L_kv4
L_vtile:
    s_mul_i32 s52, s80, 640
    s_add_u32 s54, s54, s52
    s_lshl_b32 s52, s30, 8
    s_add_u32 s54, s54, s52
    s_add_u32 s54, s54, 2560
    v_mul_u32_u24 v10, 320, v10
    v_lshl_add_u32 v10, v2, 4, v10
    s_cmp_eq_u32 s30, 1
    s_cselect_b32 exec_lo, 0xf, 0xffff
    s_mov_b32 exec_hi, exec_lo
L_kv4:
    buffer_store_dwordx4 v[200:203], v10, s[36:39], s54 offen sc1
    s_branch L_kvdone
L_ktail:
    s_lshl_b32 s52, s80, 7
    s_add_u32 s54, s54, s52
    v_lshlrev_b32 v10, 3, v2
    s_mov_b64 exec, 0xffff
    buffer_store_dwordx2 v[200:201], v10, s[36:39], s54 offen offset:2048 sc1
L_kvdone:
    s_mov_b64 exec, -1
L_nokv:
    s_add_u32 m0, s77, 12288
    s_add_u32 s52, s76, 81920
    buffer_load_dwordx4 v7, s[44:47], s52 offen lds
    s_add_u32 m0, s77, 13312
    s_add_u32 s52, s76, 102400
    buffer_load_dwordx4 v7, s[44:47], s52 offen lds
    s_waitcnt lgkmcnt(0)
    v_pk_add_f32 v[180:181], v[180:181], v[182:183]
    v_pk_add_f32 v[184:185], v[184:185], v[186:187]
    v_pk_add_f32 v[188:189], v[188:189], v[190:191]
    v_pk_add_f32 v[192:193], v[192:193], v[194:195]
    v_pk_add_f32 v[244:245], v[244:245], v[246:247]
    v_pk_add_f32 v[248:249], v[248:249], v[250:251]
    v_pk_add_f32 v[180:181], v[180:181], v[184:185]
    v_pk_add_f32 v[188:189], v[188:189], v[192:193]
    v_pk_add_f32 v[244:245], v[244:245], v[248:249]
    v_mul_f32 v180, 0x3acccccd, v180
    v_mul_f32 v181, 0x3acccccd, v181
    v_mul_f32 v188, 0x3acccccd, v188
    v_mul_f32 v189, 0x3acccccd, v189
    v_mul_f32 v244, 0x3acccccd, v244
    v_mul_f32 v245, 0x3acccccd, v245
    v_fma_f32 v181, -v180, v180, v181
    v_fma_f32 v189, -v188, v188, v189
    v_fma_f32 v245, -v244, v244, v245
    v_max_f32 v181, 0, v181
    v_max_f32 v189, 0, v189
    v_max_f32 v245, 0, v245
    v_add_f32 v181, 0x3727c5ac, v181
    v_add_f32 v189, 0x3727c5ac, v189
    v_add_f32 v245, 0x3727c5ac, v245
    v_rsq_f32 v238, v181
    v_rsq_f32 v240, v189
    v_rsq_f32 v242, v245
    s_nop 0
    v_mul_f32 v239, -v180, v238
    v_mul_f32 v241, -v188, v240
    v_mul_f32 v243, -v244, v242
    v_lshlrev_b32 v244, 16, v36
    v_and_b32 v245, s91, v36
    v_lshlrev_b32 v246, 16, v37
    v_and_b32 v247, s91, v37
    v_lshlrev_b32 v248, 16, v38
    v_and_b32 v249, s91, v38
    v_lshlrev_b32 v250, 16, v39
    v_and_b32 v251, s91, v39
    v_pk_fma_f32 v[244:245], v[244:245], v[238:239], v[238:239] op_sel:[0,0,1] op_sel_hi:[1,0,1]
    v_pk_fma_f32 v[246:247], v[246:247], v[238:239], v[238:239] op_sel:[0,0,1] op_sel_hi:[1,0,1]
    v_pk_fma_f32 v[248:249], v[248:249], v[238:239], v[238:239] op_sel:[0,0,1] op_sel_hi:[1,0,1]
    v_pk_fma_f32 v[250:251], v[250:251], v[238:239], v[238:239] op_sel:[0,0,1] op_sel_hi:[1,0,1]
    v_pk_fma_f32 v[244:245], v[244:245], v[108:109], v[100:101]
    v_pk_fma_f32 v[246:247], v[246:247], v[110:111], v[102:103]
    v_pk_fma_f32 v[248:249], v[248:249], v[112:113], v[104:105]
    v_pk_fma_f32 v[250:251], v[250:251], v[114:115], v[106:107]
    v_cvt_pk_bf16_f32 v36, v244, v245
    v_cvt_pk_bf16_f32 v37, v246, v247
    v_cvt_pk_bf16_f32 v38, v248, v249
    v_cvt_pk_bf16_f32 v39, v250, v251
    s_add_u32 m0, s77, 14336
    s_add_u32 s52, s76, 81984
    buffer_load_dwordx4 v7, s[44:47], s52 offen lds
    s_add_u32 m0, s77, 15360
    s_add_u32 s52, s76, 102464
    buffer_load_dwordx4 v7, s[44:47], s52 offen lds
    v_lshlrev_b32 v244, 16, v40
    v_and_b32 v245, s91, v40
    v_lshlrev_b32 v246, 16, v41
    v_and_b32 v247, s91, v41
    v_lshlrev_b32 v248, 16, v42
    v_and_b32 v249, s91, v42
    v_lshlrev_b32 v250, 16, v43
    v_and_b32 v251, s91, v43
    v_pk_fma_f32 v[244:245], v[244:245], v[238:239], v[238:239] op_sel:[0,0,1] op_sel_hi:[1,0,1]
    v_pk_fma_f32 v[246:247], v[246:247], v[238:239], v[238:239] op_sel:[0,0,1] op_sel_hi:[1,0,1]
    v_pk_fma_f32 v[248:249], v[248:249], v[238:239], v[238:239] op_sel:[0,0,1] op_sel_hi:[1,0,1]
    v_pk_fma_f32 v[250:251], v[250:251], v[238:239], v[238:239] op_sel:[0,0,1] op_sel_hi:[1,0,1]
    v_pk_fma_f32 v[244:245], v[244:245], v[124:125], v[116:117]
    v_pk_fma_f32 v[246:247], v[246:247], v[126:127], v[118:119]
    v_pk_fma_f32 v[248:249], v[248:249], v[128:129], v[120:121]
    v_pk_fma_f32 v[250:251], v[250:251], v[130:131], v[122:123]
    v_cvt_pk_bf16_f32 v40, v244, v245
    v_cvt_pk_bf16_f32 v41, v246, v247
    v_cvt_pk_bf16_f32 v42, v248, v249
    v_cvt_pk_bf16_f32 v43, v250, v251
    s_add_u32 m0, s77, 16384
    s_add_u32 s52, s76, 82048
    buffer_load_dwordx4 v7, s[44:47], s52 offen lds
    s_add_u32 m0, s77, 17408
    s_add_u32 s52, s76, 102528
    buffer_load_dwordx4 v7, s[44:47], s52 offen lds
    v_lshlrev_b32 v244, 16, v44
    v_and_b32 v245, s91, v44
    v_lshlrev_b32 v246, 16, v45
    v_and_b32 v247, s91, v45
    v_lshlrev_b32 v248, 16, v46
    v_and_b32 v249, s91, v46
    v_lshlrev_b32 v250, 16, v47
    v_and_b32 v251, s91, v47
    v_pk_fma_f32 v[244:245], v[244:245], v[238:239], v[238:239] op_sel:[0,0,1] op_sel_hi:[1,0,1]
    v_pk_fma_f32 v[246:247], v[246:247], v[238:239], v[238:239] op_sel:[0,0,1] op_sel_hi:[1,0,1]
    v_pk_fma_f32 v[248:249], v[248:249], v[238:239], v[238:239] op_sel:[0,0,1] op_sel_hi:[1,0,1]
    v_pk_fma_f32 v[250:251], v[250:251], v[238:239], v[238:239] op_sel:[0,0,1] op_sel_hi:[1,0,1]
    v_pk_fma_f32 v[244:245], v[244:245], v[140:141], v[132:133]
    v_pk_fma_f32 v[246:247], v[246:247], v[142:143], v[134:135]
    v_pk_fma_f32 v[248:249], v[248:249], v[144:145], v[136:137]
    v_pk_fma_f32 v[250:251], v[250:251], v[146:147], v[138:139]
    v_cvt_pk_bf16_f32 v44, v244, v245
    v_cvt_pk_bf16_f32 v45, v246, v247
    v_cvt_pk_bf16_f32 v46, v248, v249
    v_cvt_pk_bf16_f32 v47, v250, v251
    s_add_u32 m0, s77, 18432
    s_add_u32 s52, s76, 122880
    buffer_load_dwordx4 v7, s[44:47], s52 offen lds
    s_add_u32 m0, s77, 19456
    s_add_u32 s52, s76, 143360
    buffer_load_dwordx4 v7, s[44:47], s52 offen lds
    s_waitcnt vmcnt(14)
    ds_read_b64_tr_b16 a[0:1], v252 offset:0
    ds_read_b64_tr_b16 a[2:3], v252 offset:256
    ds_read_b64_tr_b16 a[4:5], v253 offset:0
    ds_read_b64_tr_b16 a[6:7], v253 offset:256
    ds_read_b64_tr_b16 a[8:9], v254 offset:0
    ds_read_b64_tr_b16 a[10:11], v254 offset:256
    ds_read_b64_tr_b16 a[12:13], v255 offset:0
    ds_read_b64_tr_b16 a[14:15], v255 offset:256
    ds_read_b64_tr_b16 a[16:17], v234 offset:0
    ds_read_b64_tr_b16 a[18:19], v234 offset:256
    s_waitcnt lgkmcnt(5)
    v_lshlrev_b32 v244, 16, v48
    v_and_b32 v245, s91, v48
    v_lshlrev_b32 v246, 16, v49
    v_and_b32 v247, s91, v49
    v_lshlrev_b32 v248, 16, v50
    v_and_b32 v249, s91, v50
    v_lshlrev_b32 v250, 16, v51
    v_and_b32 v251, s91, v51
    v_pk_fma_f32 v[244:245], v[244:245], v[238:239], v[238:239] op_sel:[0,0,1] op_sel_hi:[1,0,1]
    v_pk_fma_f32 v[246:247], v[246:247], v[238:239], v[238:239] op_sel:[0,0,1] op_sel_hi:[1,0,1]
    v_pk_fma_f32 v[248:249], v[248:249], v[238:239], v[238:239] op_sel:[0,0,1] op_sel_hi:[1,0,1]
    v_pk_fma_f32 v[250:251], v[250:251], v[238:239], v[238:239] op_sel:[0,0,1] op_sel_hi:[1,0,1]
    v_pk_fma_f32 v[244:245], v[244:245], v[156:157], v[148:149]
    v_pk_fma_f32 v[246:247], v[246:247], v[158:159], v[150:151]
    v_pk_fma_f32 v[248:249], v[248:249], v[160:161], v[152:153]
    v_pk_fma_f32 v[250:251], v[250:251], v[162:163], v[154:155]
    v_cvt_pk_bf16_f32 v48, v244, v245
    v_cvt_pk_bf16_f32 v49, v246, v247
    v_cvt_pk_bf16_f32 v50, v248, v249
    v_cvt_pk_bf16_f32 v51, v250, v251
    s_add_u32 m0, s77, 20480
    s_add_u32 s52, s76, 122944
    buffer_load_dwordx4 v7, s[44:47], s52 offen lds
    s_add_u32 m0, s77, 21504
    s_add_u32 s52, s76, 143424
    buffer_load_dwordx4 v7, s[44:47], s52 offen lds
    v_lshlrev_b32 v244, 16, v52
    v_and_b32 v245, s91, v52
    v_lshlrev_b32 v246, 16, v53
    v_and_b32 v247, s91, v53
    v_lshlrev_b32 v248, 16, v54
    v_and_b32 v249, s91, v54
    v_lshlrev_b32 v250, 16, v55
    v_and_b32 v251, s91, v55
    v_pk_fma_f32 v[244:245], v[244:245], v[238:239], v[238:239] op_sel:[0,0,1] op_sel_hi:[1,0,1]
    v_pk_fma_f32 v[246:247], v[246:247], v[238:239], v[238:239] op_sel:[0,0,1] op_sel_hi:[1,0,1]
    v_pk_fma_f32 v[248:249], v[248:249], v[238:239], v[238:239] op_sel:[0,0,1] op_sel_hi:[1,0,1]
    v_pk_fma_f32 v[250:251], v[250:251], v[238:239], v[238:239] op_sel:[0,0,1] op_sel_hi:[1,0,1]
    v_pk_fma_f32 v[244:245], v[244:245], v[172:173], v[164:165]
    v_pk_fma_f32 v[246:247], v[246:247], v[174:175], v[166:167]
    v_pk_fma_f32 v[248:249], v[248:249], v[176:177], v[168:169]
    v_pk_fma_f32 v[250:251], v[250:251], v[178:179], v[170:171]
    v_cvt_pk_bf16_f32 v52, v244, v245
    v_cvt_pk_bf16_f32 v53, v246, v247
    v_cvt_pk_bf16_f32 v54, v248, v249
    v_cvt_pk_bf16_f32 v55, v250, v251
    s_add_u32 m0, s77, 22528
    s_add_u32 s52, s76, 123008
    buffer_load_dwordx4 v7, s[44:47], s52 offen lds
    s_add_u32 m0, s77, 23552
    s_add_u32 s52, s76, 143488
    buffer_load_dwordx4 v7, s[44:47], s52 offen lds
    s_waitcnt vmcnt(12)
    ds_read_b64_tr_b16 a[20:21], v252 offset:6144
    ds_read_b64_tr_b16 a[22:23], v252 offset:6400
    ds_read_b64_tr_b16 a[24:25], v253 offset:6144
    ds_read_b64_tr_b16 a[26:27], v253 offset:6400
    ds_read_b64_tr_b16 a[28:29], v254 offset:6144
    ds_read_b64_tr_b16 a[30:31], v254 offset:6400
    ds_read_b64_tr_b16 a[32:33], v255 offset:6144
    ds_read_b64_tr_b16 a[34:35], v255 offset:6400
    ds_read_b64_tr_b16 a[36:37], v234 offset:6144
    ds_read_b64_tr_b16 a[38:39], v234 offset:6400
    s_waitcnt lgkmcnt(5)
    v_lshlrev_b32 v244, 16, v56
    v_and_b32 v245, s91, v56
    v_lshlrev_b32 v246, 16, v57
    v_and_b32 v247, s91, v57
    v_lshlrev_b32 v248, 16, v58
    v_and_b32 v249, s91, v58
    v_lshlrev_b32 v250, 16, v59
    v_and_b32 v251, s91, v59
    v_pk_fma_f32 v[244:245], v[244:245], v[240:241], v[240:241] op_sel:[0,0,1] op_sel_hi:[1,0,1]
    v_pk_fma_f32 v[246:247], v[246:247], v[240:241], v[240:241] op_sel:[0,0,1] op_sel_hi:[1,0,1]
    v_pk_fma_f32 v[248:249], v[248:249], v[240:241], v[240:241] op_sel:[0,0,1] op_sel_hi:[1,0,1]
    v_pk_fma_f32 v[250:251], v[250:251], v[240:241], v[240:241] op_sel:[0,0,1] op_sel_hi:[1,0,1]
    v_pk_fma_f32 v[244:245], v[244:245], v[108:109], v[100:101]
    v_pk_fma_f32 v[246:247], v[246:247], v[110:111], v[102:103]
    v_pk_fma_f32 v[248:249], v[248:249], v[112:113], v[104:105]
    v_pk_fma_f32 v[250:251], v[250:251], v[114:115], v[106:107]
    v_cvt_pk_bf16_f32 v56, v244, v245
    v_cvt_pk_bf16_f32 v57, v246, v247
    v_cvt_pk_bf16_f32 v58, v248, v249
    v_cvt_pk_bf16_f32 v59, v250, v251
    s_add_u32 m0, s77, 24576
    s_add_u32 s52, s76, 163840
    buffer_load_dwordx4 v7, s[44:47], s52 offen lds
    s_add_u32 m0, s77, 25600
    s_add_u32 s52, s76, 184320
    buffer_load_dwordx4 v7, s[44:47], s52 offen lds
    s_cmp_ge_u32 s30, 2
    s_cbranch_scc1 L_nokvflag
    s_lshl_b32 s52, s28, 3
    s_add_u32 s52, s52, s29
    s_lshl_b32 s52, s52, 6
    s_lshl_b32 s53, s30, 3
    s_add_u32 s52, s52, s53
    s_add_u32 s52, s52, 393216
    s_waitcnt vmcnt(14)
    v_mov_b32 v244, s32
    v_mov_b32 v245, s33
    v_mov_b32 v246, 0
    s_mov_b64 exec, 1
    buffer_store_dwordx2 v[244:245], v246, s[36:39], s52 offen sc1
    s_mov_b64 exec, -1
L_nokvflag:
    v_lshlrev_b32 v244, 16, v60
    v_and_b32 v245, s91, v60
    v_lshlrev_b32 v246, 16, v61
    v_and_b32 v247, s91, v61
    v_lshlrev_b32 v248, 16, v62
    v_and_b32 v249, s91, v62
    v_lshlrev_b32 v250, 16, v63
    v_and_b32 v251, s91, v63
    v_pk_fma_f32 v[244:245], v[244:245], v[240:241], v[240:241] op_sel:[0,0,1] op_sel_hi:[1,0,1]
    v_pk_fma_f32 v[246:247], v[246:247], v[240:241], v[240:241] op_sel:[0,0,1] op_sel_hi:[1,0,1]
    v_pk_fma_f32 v[248:249], v[248:249], v[240:241], v[240:241] op_sel:[0,0,1] op_sel_hi:[1,0,1]
    v_pk_fma_f32 v[250:251], v[250:251], v[240:241], v[240:241] op_sel:[0,0,1] op_sel_hi:[1,0,1]
    v_pk_fma_f32 v[244:245], v[244:245], v[124:125], v[116:117]
    v_pk_fma_f32 v[246:247], v[246:247], v[126:127], v[118:119]
    v_pk_fma_f32 v[248:249], v[248:249], v[128:129], v[120:121]
    v_pk_fma_f32 v[250:251], v[250:251], v[130:131], v[122:123]
    v_cvt_pk_bf16_f32 v60, v244, v245
    v_cvt_pk_bf16_f32 v61, v246, v247
    v_cvt_pk_bf16_f32 v62, v248, v249
    v_cvt_pk_bf16_f32 v63, v250, v251
    s_add_u32 m0, s77, 26624
    s_add_u32 s52, s76, 163904
    buffer_load_dwordx4 v7, s[44:47], s52 offen lds
    s_add_u32 m0, s77, 27648
    s_add_u32 s52, s76, 184384
    buffer_load_dwordx4 v7, s[44:47], s52 offen lds
    s_waitcnt vmcnt(10)
    ds_read_b64_tr_b16 a[40:41], v252 offset:12288
    ds_read_b64_tr_b16 a[42:43], v252 offset:12544
    ds_read_b64_tr_b16 a[44:45], v253 offset:12288
    ds_read_b64_tr_b16 a[46:47], v253 offset:12544
    ds_read_b64_tr_b16 a[48:49], v254 offset:12288
    ds_read_b64_tr_b16 a[50:51], v254 offset:12544
    ds_read_b64_tr_b16 a[52:53], v255 offset:12288
    ds_read_b64_tr_b16 a[54:55], v255 offset:12544
    ds_read_b64_tr_b16 a[56:57], v234 offset:12288
    ds_read_b64_tr_b16 a[58:59], v234 offset:12544
    s_waitcnt lgkmcnt(5)
    v_lshlrev_b32 v244, 16, v64
    v_and_b32 v245, s91, v64
    v_lshlrev_b32 v246, 16, v65
    v_and_b32 v247, s91, v65
    v_lshlrev_b32 v248, 16, v66
    v_and_b32 v249, s91, v66
    v_lshlrev_b32 v250, 16, v67
    v_and_b32 v251, s91, v67
    v_pk_fma_f32 v[244:245], v[244:245], v[240:241], v[240:241] op_sel:[0,0,1] op_sel_hi:[1,0,1]
    v_pk_fma_f32 v[246:247], v[246:247], v[240:241], v[240:241] op_sel:[0,0,1] op_sel_hi:[1,0,1]
    v_pk_fma_f32 v[248:249], v[248:249], v[240:241], v[240:241] op_sel:[0,0,1] op_sel_hi:[1,0,1]
    v_pk_fma_f32 v[250:251], v[250:251], v[240:241], v[240:241] op_sel:[0,0,1] op_sel_hi:[1,0,1]
    v_pk_fma_f32 v[244:245], v[244:245], v[140:141], v[132:133]
    v_pk_fma_f32 v[246:247], v[246:247], v[142:143], v[134:135]
    v_pk_fma_f32 v[248:249], v[248:249], v[144:145], v[136:137]
    v_pk_fma_f32 v[250:251], v[250:251], v[146:147], v[138:139]
    v_cvt_pk_bf16_f32 v64, v244, v245
    v_cvt_pk_bf16_f32 v65, v246, v247
    v_cvt_pk_bf16_f32 v66, v248, v249
    v_cvt_pk_bf16_f32 v67, v250, v251
    s_add_u32 m0, s77, 28672
    s_add_u32 s52, s76, 163968
    buffer_load_dwordx4 v7, s[44:47], s52 offen lds
    s_add_u32 m0, s77, 29696
    s_add_u32 s52, s76, 184448
    buffer_load_dwordx4 v7, s[44:47], s52 offen lds
    v_lshlrev_b32 v244, 16, v68
    v_and_b32 v245, s91, v68
    v_lshlrev_b32 v246, 16, v69
    v_and_b32 v247, s91, v69
    v_lshlrev_b32 v248, 16, v70
    v_and_b32 v249, s91, v70
    v_lshlrev_b32 v250, 16, v71
    v_and_b32 v251, s91, v71
    v_pk_fma_f32 v[244:245], v[244:245], v[240:241], v[240:241] op_sel:[0,0,1] op_sel_hi:[1,0,1]
    v_pk_fma_f32 v[246:247], v[246:247], v[240:241], v[240:241] op_sel:[0,0,1] op_sel_hi:[1,0,1]
    v_pk_fma_f32 v[248:249], v[248:249], v[240:241], v[240:241] op_sel:[0,0,1] op_sel_hi:[1,0,1]
    v_pk_fma_f32 v[250:251], v[250:251], v[240:241], v[240:241] op_sel:[0,0,1] op_sel_hi:[1,0,1]
    v_pk_fma_f32 v[244:245], v[244:245], v[156:157], v[148:149]
    v_pk_fma_f32 v[246:247], v[246:247], v[158:159], v[150:151]
    v_pk_fma_f32 v[248:249], v[248:249], v[160:161], v[152:153]
    v_pk_fma_f32 v[250:251], v[250:251], v[162:163], v[154:155]
    v_cvt_pk_bf16_f32 v68, v244, v245
    v_cvt_pk_bf16_f32 v69, v246, v247
    v_cvt_pk_bf16_f32 v70, v248, v249
    v_cvt_pk_bf16_f32 v71, v250, v251
    s_waitcnt vmcnt(6)
    ds_read_b64_tr_b16 a[60:61], v252 offset:18432
    ds_read_b64_tr_b16 a[62:63], v252 offset:18688
    ds_read_b64_tr_b16 a[64:65], v253 offset:18432
    ds_read_b64_tr_b16 a[66:67], v253 offset:18688
    ds_read_b64_tr_b16 a[68:69], v254 offset:18432
    ds_read_b64_tr_b16 a[70:71], v254 offset:18688
    ds_read_b64_tr_b16 a[72:73], v255 offset:18432
    ds_read_b64_tr_b16 a[74:75], v255 offset:18688
    ds_read_b64_tr_b16 a[76:77], v234 offset:18432
    ds_read_b64_tr_b16 a[78:79], v234 offset:18688
    s_waitcnt lgkmcnt(5)
    s_waitcnt vmcnt(0)
    ds_read_b64_tr_b16 a[208:209], v252 offset:24576
    ds_read_b64_tr_b16 a[210:211], v252 offset:24832
    ds_read_b64_tr_b16 a[212:213], v253 offset:24576
    ds_read_b64_tr_b16 a[214:215], v253 offset:24832
    ds_read_b64_tr_b16 a[216:217], v254 offset:24576
    ds_read_b64_tr_b16 a[218:219], v254 offset:24832
    ds_read_b64_tr_b16 a[220:221], v255 offset:24576
    ds_read_b64_tr_b16 a[222:223], v255 offset:24832
    ds_read_b64_tr_b16 a[224:225], v234 offset:24576
    ds_read_b64_tr_b16 a[226:227], v234 offset:24832
    s_waitcnt lgkmcnt(5)
    s_mov_b32 s48, s16
    s_mov_b32 s49, s17
    s_mov_b32 s50, 0x1e0000
    s_mov_b32 s51, 0x00020000
    s_mov_b32 s84, s12
    s_mov_b32 s85, s13
    s_mov_b32 s86, 0xc8000
    s_mov_b32 s87, 0x00020000
    s_add_u32 s52, s88, 49152
    s_add_u32 s53, s89, 20480
    buffer_load_dwordx4 a[228:231], v96, s[48:51], s88 offen
    buffer_load_dwordx4 a[232:235], v96, s[48:51], s52 offen
    s_mov_b32 s48, s18
    s_mov_b32 s49, s19
    s_mov_b32 s50, 1966080
    buffer_load_dwordx4 a[236:239], v97, s[48:51], s89 offen
    buffer_load_dwordx4 a[240:243], v97, s[48:51], s53 offen
    buffer_load_dwordx4 a[244:247], v98, s[84:87], s90 offen
    buffer_load_dwordx4 a[248:251], v99, s[84:87], s90 offen
    s_waitcnt lgkmcnt(0)
    s_lshl_b32 s59, s30, 12
    s_add_u32 s59, s59, 393216
    v_lshlrev_b32 v12, 6, v1
    v_lshlrev_b32 v244, 16, v72
    v_and_b32 v245, s91, v72
    v_lshlrev_b32 v246, 16, v73
    v_mfma_f32_16x16x32_bf16 v[180:183], a[0:3], v[16:19], 0
    v_and_b32 v247, s91, v73
    v_lshlrev_b32 v248, 16, v74
    v_and_b32 v249, s91, v74
    v_mfma_f32_16x16x32_bf16 v[184:187], a[4:7], v[16:19], 0
    v_lshlrev_b32 v250, 16, v75
    v_and_b32 v251, s91, v75
    v_fma_f32 v244, v244, v240, v241
    v_fma_f32 v245, v245, v240, v241
    v_mfma_f32_16x16x32_bf16 v[188:191], a[8:11], v[16:19], 0
    v_fma_f32 v246, v246, v240, v241
    v_fma_f32 v247, v247, v240, v241
    v_fma_f32 v248, v248, v240, v241
    v_mfma_f32_16x16x32_bf16 v[192:195], a[12:15], v[16:19], 0
    v_fma_f32 v249, v249, v240, v241
    v_fma_f32 v250, v250, v240, v241
    v_fma_f32 v251, v251, v240, v241
    v_mfma_f32_16x16x32_bf16 v[196:199], a[16:19], v[16:19], 0
    v_fma_f32 v244, v244, v172, v164
    v_fma_f32 v245, v245, v173, v165
    v_fma_f32 v246, v246, v174, v166
    v_mfma_f32_16x16x32_bf16 v[180:183], a[20:23], v[20:23], v[180:183]
    v_fma_f32 v247, v247, v175, v167
    v_fma_f32 v248, v248, v176, v168
    v_fma_f32 v249, v249, v177, v169
    v_fma_f32 v250, v250, v178, v170
    v_mfma_f32_16x16x32_bf16 v[184:187], a[24:27], v[20:23], v[184:187]
    v_fma_f32 v251, v251, v179, v171
    v_cvt_pk_bf16_f32 v72, v244, v245
    v_cvt_pk_bf16_f32 v73, v246, v247
    v_cvt_pk_bf16_f32 v74, v248, v249
    v_mfma_f32_16x16x32_bf16 v[188:191], a[28:31], v[20:23], v[188:191]
    v_cvt_pk_bf16_f32 v75, v250, v251
    v_lshlrev_b32 v244, 16, v76
    v_and_b32 v245, s91, v76
    v_lshlrev_b32 v246, 16, v77
    v_mfma_f32_16x16x32_bf16 v[192:195], a[32:35], v[20:23], v[192:195]
    v_and_b32 v247, s91, v77
    v_lshlrev_b32 v248, 16, v78
    v_and_b32 v249, s91, v78
    v_mfma_f32_16x16x32_bf16 v[196:199], a[36:39], v[20:23], v[196:199]
    v_lshlrev_b32 v250, 16, v79
    v_and_b32 v251, s91, v79
    v_fma_f32 v244, v244, v242, v243
    v_fma_f32 v245, v245, v242, v243
    v_mfma_f32_16x16x32_bf16 v[180:183], a[40:43], v[24:27], v[180:183]
    v_fma_f32 v246, v246, v242, v243
    v_fma_f32 v247, v247, v242, v243
    v_fma_f32 v248, v248, v242, v243
    v_mfma_f32_16x16x32_bf16 v[184:187], a[44:47], v[24:27], v[184:187]
    v_fma_f32 v249, v249, v242, v243
    v_fma_f32 v250, v250, v242, v243
    v_fma_f32 v251, v251, v242, v243
    v_mfma_f32_16x16x32_bf16 v[188:191], a[48:51], v[24:27], v[188:191]
    v_fma_f32 v244, v244, v108, v100
    v_fma_f32 v245, v245, v109, v101
    v_fma_f32 v246, v246, v110, v102
    v_mfma_f32_16x16x32_bf16 v[192:195], a[52:55], v[24:27], v[192:195]
    v_fma_f32 v247, v247, v111, v103
    v_fma_f32 v248, v248, v112, v104
    v_fma_f32 v249, v249, v113, v105
    v_fma_f32 v250, v250, v114, v106
    v_mfma_f32_16x16x32_bf16 v[196:199], a[56:59], v[24:27], v[196:199]
    v_fma_f32 v251, v251, v115, v107
    v_cvt_pk_bf16_f32 v76, v244, v245
    v_cvt_pk_bf16_f32 v77, v246, v247
    v_cvt_pk_bf16_f32 v78, v248, v249
    v_mfma_f32_16x16x32_bf16 v[180:183], a[60:63], v[28:31], v[180:183]
    v_cvt_pk_bf16_f32 v79, v250, v251
    v_lshlrev_b32 v244, 16, v80
    v_and_b32 v245, s91, v80
    v_lshlrev_b32 v246, 16, v81
    v_mfma_f32_16x16x32_bf16 v[184:187], a[64:67], v[28:31], v[184:187]
    v_and_b32 v247, s91, v81
    v_lshlrev_b32 v248, 16, v82
    v_and_b32 v249, s91, v82
    v_mfma_f32_16x16x32_bf16 v[188:191], a[68:71], v[28:31], v[188:191]
    v_lshlrev_b32 v250, 16, v83
    v_and_b32 v251, s91, v83
    v_fma_f32 v244, v244, v242, v243
    v_fma_f32 v245, v245, v242, v243
    v_mfma_f32_16x16x32_bf16 v[192:195], a[72:75], v[28:31], v[192:195]
    v_fma_f32 v246, v246, v242, v243
    v_fma_f32 v247, v247, v242, v243
    v_fma_f32 v248, v248, v242, v243
    v_mfma_f32_16x16x32_bf16 v[196:199], a[76:79], v[28:31], v[196:199]
    v_fma_f32 v249, v249, v242, v243
    v_fma_f32 v250, v250, v242, v243
    v_fma_f32 v251, v251, v242, v243
    v_mfma_f32_16x16x32_bf16 v[180:183], a[208:211], v[32:35], v[180:183]
    v_fma_f32 v244, v244, v124, v116
    v_fma_f32 v245, v245, v125, v117
    v_fma_f32 v246, v246, v126, v118
    v_mfma_f32_16x16x32_bf16 v[184:187], a[212:215], v[32:35], v[184:187]
    v_fma_f32 v247, v247, v127, v119
    v_fma_f32 v248, v248, v128, v120
    v_fma_f32 v249, v249, v129, v121
    v_fma_f32 v250, v250, v130, v122
    v_mfma_f32_16x16x32_bf16 v[188:191], a[216:219], v[32:35], v[188:191]
    v_fma_f32 v251, v251, v131, v123
    v_cvt_pk_bf16_f32 v80, v244, v245
    v_cvt_pk_bf16_f32 v81, v246, v247
    v_cvt_pk_bf16_f32 v82, v248, v249
    v_mfma_f32_16x16x32_bf16 v[192:195], a[220:223], v[32:35], v[192:195]
    v_cvt_pk_bf16_f32 v83, v250, v251
    v_lshlrev_b32 v244, 16, v84
    v_and_b32 v245, s91, v84
    v_lshlrev_b32 v246, 16, v85
    v_mfma_f32_16x16x32_bf16 v[196:199], a[224:227], v[32:35], v[196:199]
    v_and_b32 v247, s91, v85
    v_lshlrev_b32 v248, 16, v86
    v_and_b32 v249, s91, v86
    v_mfma_f32_16x16x32_bf16 v[200:203], a[0:3], v[36:39], 0
    v_lshlrev_b32 v250, 16, v87
    v_and_b32 v251, s91, v87
    v_fma_f32 v244, v244, v242, v243
    v_fma_f32 v245, v245, v242, v243
    v_mfma_f32_16x16x32_bf16 v[204:207], a[4:7], v[36:39], 0
    v_fma_f32 v246, v246, v242, v243
    v_fma_f32 v247, v247, v242, v243
    v_fma_f32 v248, v248, v242, v243
    v_mfma_f32_16x16x32_bf16 v[208:211], a[8:11], v[36:39], 0
    v_fma_f32 v249, v249, v242, v243
    v_fma_f32 v250, v250, v242, v243
    v_fma_f32 v251, v251, v242, v243
    v_mfma_f32_16x16x32_bf16 v[212:215], a[12:15], v[36:39], 0
    v_fma_f32 v244, v244, v140, v132
    v_fma_f32 v245, v245, v141, v133
    v_fma_f32 v246, v246, v142, v134
    v_mfma_f32_16x16x32_bf16 v[216:219], a[16:19], v[36:39], 0
    v_fma_f32 v247, v247, v143, v135
    v_fma_f32 v248, v248, v144, v136
    v_fma_f32 v249, v249, v145, v137
    v_fma_f32 v250, v250, v146, v138
    v_mfma_f32_16x16x32_bf16 v[200:203], a[20:23], v[40:43], v[200:203]
    v_fma_f32 v251, v251, v147, v139
    v_cvt_pk_bf16_f32 v84, v244, v245
    v_cvt_pk_bf16_f32 v85, v246, v247
    v_cvt_pk_bf16_f32 v86, v248, v249
    v_mfma_f32_16x16x32_bf16 v[204:207], a[24:27], v[40:43], v[204:207]
    v_cvt_pk_bf16_f32 v87, v250, v251
    v_lshlrev_b32 v244, 16, v88
    v_and_b32 v245, s91, v88
    v_lshlrev_b32 v246, 16, v89
    v_mfma_f32_16x16x32_bf16 v[208:211], a[28:31], v[40:43], v[208:211]
    v_and_b32 v247, s91, v89
    v_mfma_f32_16x16x32_bf16 v[212:215], a[32:35], v[40:43], v[212:215]
    v_lshlrev_b32 v248, 16, v90
    v_and_b32 v249, s91, v90
    v_mfma_f32_16x16x32_bf16 v[216:219], a[36:39], v[40:43], v[216:219]
    v_lshlrev_b32 v250, 16, v91
    v_and_b32 v251, s91, v91
    ds_write_b128 v11, v[180:183] offset:0
    v_fma_f32 v244, v244, v242, v243
    v_fma_f32 v245, v245, v242, v243
    v_fma_f32 v246, v246, v242, v243
    v_mfma_f32_16x16x32_bf16 v[200:203], a[40:43], v[44:47], v[200:203]
    v_fma_f32 v247, v247, v242, v243
    v_fma_f32 v248, v248, v242, v243
    ds_write_b128 v11, v[184:187] offset:1024
    v_fma_f32 v249, v249, v242, v243
    v_fma_f32 v250, v250, v242, v243
    v_mfma_f32_16x16x32_bf16 v[204:207], a[44:47], v[44:47], v[204:207]
    v_fma_f32 v251, v251, v242, v243
    ds_write_b128 v11, v[188:191] offset:2048
    v_fma_f32 v244, v244, v156, v148
    v_fma_f32 v245, v245, v157, v149
    v_mfma_f32_16x16x32_bf16 v[208:211], a[48:51], v[44:47], v[208:211]
    v_fma_f32 v246, v246, v158, v150
    v_fma_f32 v247, v247, v159, v151
    v_fma_f32 v248, v248, v160, v152
    ds_write_b128 v11, v[192:195] offset:3072
    v_fma_f32 v249, v249, v161, v153
    v_fma_f32 v250, v250, v162, v154
    v_mfma_f32_16x16x32_bf16 v[212:215], a[52:55], v[44:47], v[212:215]
    v_fma_f32 v251, v251, v163, v155
    v_cvt_pk_bf16_f32 v88, v244, v245
    ds_write_b128 v11, v[196:199] offset:4096
    v_cvt_pk_bf16_f32 v89, v246, v247
    v_cvt_pk_bf16_f32 v90, v248, v249
    v_mfma_f32_16x16x32_bf16 v[216:219], a[56:59], v[44:47], v[216:219]
    v_cvt_pk_bf16_f32 v91, v250, v251
    v_lshlrev_b32 v244, 16, v92
    v_and_b32 v245, s91, v92
    v_lshlrev_b32 v246, 16, v93
    v_mfma_f32_16x16x32_bf16 v[200:203], a[60:63], v[48:51], v[200:203]
    v_and_b32 v247, s91, v93
    v_lshlrev_b32 v248, 16, v94
    v_and_b32 v249, s91, v94
    v_mfma_f32_16x16x32_bf16 v[204:207], a[64:67], v[48:51], v[204:207]
    v_lshlrev_b32 v250, 16, v95
    v_and_b32 v251, s91, v95
    v_fma_f32 v244, v244, v242, v243
    v_fma_f32 v245, v245, v242, v243
    v_mfma_f32_16x16x32_bf16 v[208:211], a[68:71], v[48:51], v[208:211]
    v_fma_f32 v246, v246, v242, v243
    v_fma_f32 v247, v247, v242, v243
    v_fma_f32 v248, v248, v242, v243
    v_mfma_f32_16x16x32_bf16 v[212:215], a[72:75], v[48:51], v[212:215]
    v_fma_f32 v249, v249, v242, v243
    v_fma_f32 v250, v250, v242, v243
    v_fma_f32 v251, v251, v242, v243
    v_mfma_f32_16x16x32_bf16 v[216:219], a[76:79], v[48:51], v[216:219]
    v_fma_f32 v244, v244, v172, v164
    v_fma_f32 v245, v245, v173, v165
    v_fma_f32 v246, v246, v174, v166
    v_mfma_f32_16x16x32_bf16 v[200:203], a[208:211], v[52:55], v[200:203]
    v_fma_f32 v247, v247, v175, v167
    v_fma_f32 v248, v248, v176, v168
    v_fma_f32 v249, v249, v177, v169
    v_fma_f32 v250, v250, v178, v170
    v_mfma_f32_16x16x32_bf16 v[204:207], a[212:215], v[52:55], v[204:207]
    v_fma_f32 v251, v251, v179, v171
    v_cvt_pk_bf16_f32 v92, v244, v245
    v_cvt_pk_bf16_f32 v93, v246, v247
    v_cvt_pk_bf16_f32 v94, v248, v249
    v_mfma_f32_16x16x32_bf16 v[208:211], a[216:219], v[52:55], v[208:211]
    v_cvt_pk_bf16_f32 v95, v250, v251
    buffer_load_dwordx4 v[220:223], v12, s[36:39], s59 offen offset:0 sc1
    s_nop 1
    v_mfma_f32_16x16x32_bf16 v[212:215], a[220:223], v[52:55], v[212:215]
    v_mfma_f32_16x16x32_bf16 v[216:219], a[224:227], v[52:55], v[216:219]
    v_mfma_f32_16x16x32_bf16 v[180:183], a[0:3], v[56:59], 0
    v_mfma_f32_16x16x32_bf16 v[184:187], a[4:7], v[56:59], 0
    v_mfma_f32_16x16x32_bf16 v[188:191], a[8:11], v[56:59], 0
    v_mfma_f32_16x16x32_bf16 v[192:195], a[12:15], v[56:59], 0
    v_mfma_f32_16x16x32_bf16 v[196:199], a[16:19], v[56:59], 0
    v_mfma_f32_16x16x32_bf16 v[180:183], a[20:23], v[60:63], v[180:183]
    v_mfma_f32_16x16x32_bf16 v[184:187], a[24:27], v[60:63], v[184:187]
    v_mfma_f32_16x16x32_bf16 v[188:191], a[28:31], v[60:63], v[188:191]
    v_mfma_f32_16x16x32_bf16 v[192:195], a[32:35], v[60:63], v[192:195]
    v_mfma_f32_16x16x32_bf16 v[196:199], a[36:39], v[60:63], v[196:199]
    ds_write_b128 v11, v[200:203] offset:5120
    v_mfma_f32_16x16x32_bf16 v[180:183], a[40:43], v[64:67], v[180:183]
    ds_write_b128 v11, v[204:207] offset:6144
    v_mfma_f32_16x16x32_bf16 v[184:187], a[44:47], v[64:67], v[184:187]
    ds_write_b128 v11, v[208:211] offset:7168
    v_mfma_f32_16x16x32_bf16 v[188:191], a[48:51], v[64:67], v[188:191]
    ds_write_b128 v11, v[212:215] offset:8192
    v_mfma_f32_16x16x32_bf16 v[192:195], a[52:55], v[64:67], v[192:195]
    ds_write_b128 v11, v[216:219] offset:9216
    v_mfma_f32_16x16x32_bf16 v[196:199], a[56:59], v[64:67], v[196:199]
    v_mfma_f32_16x16x32_bf16 v[180:183], a[60:63], v[68:71], v[180:183]
    v_mfma_f32_16x16x32_bf16 v[184:187], a[64:67], v[68:71], v[184:187]
    v_mfma_f32_16x16x32_bf16 v[188:191], a[68:71], v[68:71], v[188:191]
    v_mfma_f32_16x16x32_bf16 v[192:195], a[72:75], v[68:71], v[192:195]
    v_mfma_f32_16x16x32_bf16 v[196:199], a[76:79], v[68:71], v[196:199]
    v_mfma_f32_16x16x32_bf16 v[180:183], a[208:211], v[72:75], v[180:183]
    v_mfma_f32_16x16x32_bf16 v[184:187], a[212:215], v[72:75], v[184:187]
    v_mfma_f32_16x16x32_bf16 v[188:191], a[216:219], v[72:75], v[188:191]
    v_mfma_f32_16x16x32_bf16 v[192:195], a[220:223], v[72:75], v[192:195]
    v_mfma_f32_16x16x32_bf16 v[196:199], a[224:227], v[72:75], v[196:199]
    v_mfma_f32_16x16x32_bf16 v[200:203], a[0:3], v[76:79], 0
    v_mfma_f32_16x16x32_bf16 v[204:207], a[4:7], v[76:79], 0
    v_mfma_f32_16x16x32_bf16 v[208:211], a[8:11], v[76:79], 0
    v_mfma_f32_16x16x32_bf16 v[212:215], a[12:15], v[76:79], 0
    v_mfma_f32_16x16x32_bf16 v[216:219], a[16:19], v[76:79], 0
    v_mfma_f32_16x16x32_bf16 v[200:203], a[20:23], v[80:83], v[200:203]
    v_mfma_f32_16x16x32_bf16 v[204:207], a[24:27], v[80:83], v[204:207]
    v_mfma_f32_16x16x32_bf16 v[208:211], a[28:31], v[80:83], v[208:211]
    v_mfma_f32_16x16x32_bf16 v[212:215], a[32:35], v[80:83], v[212:215]
    v_mfma_f32_16x16x32_bf16 v[216:219], a[36:39], v[80:83], v[216:219]
    ds_write_b128 v11, v[180:183] offset:10240
    v_mfma_f32_16x16x32_bf16 v[200:203], a[40:43], v[84:87], v[200:203]
    ds_write_b128 v11, v[184:187] offset:11264
    v_mfma_f32_16x16x32_bf16 v[204:207], a[44:47], v[84:87], v[204:207]
    ds_write_b128 v11, v[188:191] offset:12288
    v_mfma_f32_16x16x32_bf16 v[208:211], a[48:51], v[84:87], v[208:211]
    ds_write_b128 v11, v[192:195] offset:13312
    v_mfma_f32_16x16x32_bf16 v[212:215], a[52:55], v[84:87], v[212:215]
    ds_write_b128 v11, v[196:199] offset:14336
    v_mfma_f32_16x16x32_bf16 v[216:219], a[56:59], v[84:87], v[216:219]
    v_mfma_f32_16x16x32_bf16 v[200:203], a[60:63], v[88:91], v[200:203]
    v_mfma_f32_16x16x32_bf16 v[204:207], a[64:67], v[88:91], v[204:207]
    v_mfma_f32_16x16x32_bf16 v[208:211], a[68:71], v[88:91], v[208:211]
    v_mfma_f32_16x16x32_bf16 v[212:215], a[72:75], v[88:91], v[212:215]
    v_mfma_f32_16x16x32_bf16 v[216:219], a[76:79], v[88:91], v[216:219]
    v_mfma_f32_16x16x32_bf16 v[200:203], a[208:211], v[92:95], v[200:203]
    v_mfma_f32_16x16x32_bf16 v[204:207], a[212:215], v[92:95], v[204:207]
    v_mfma_f32_16x16x32_bf16 v[208:211], a[216:219], v[92:95], v[208:211]
    v_mfma_f32_16x16x32_bf16 v[212:215], a[220:223], v[92:95], v[212:215]
    v_mfma_f32_16x16x32_bf16 v[216:219], a[224:227], v[92:95], v[216:219]
    s_mul_i32 s52, s30, 5120
    v_add_u32 v9, s52, v4
    v_add_u32 v10, 61440, v9
    s_nop 4
    ds_write_b128 v11, v[200:203] offset:15360
    ds_write_b128 v11, v[204:207] offset:16384
    ds_write_b128 v11, v[208:211] offset:17408
    ds_write_b128 v11, v[212:215] offset:18432
    ds_write_b128 v11, v[216:219] offset:19456
    v_and_b32 v5, 31, v1
    v_lshrrev_b32 v6, 5, v1
    v_lshlrev_b32 v96, 3, v1
    v_mul_u32_u24 v97, 320, v6
    v_lshl_add_u32 v97, v5, 4, v97
    s_lshr_b32 s53, s2, 3
    s_mul_i32 s53, s53, 1280
    s_add_u32 s53, s53, s75
    v_lshlrev_b32 v5, 7, v1
    s_mov_b32 s80, 0xfffff
    s_mov_b32 s81, 0xfffff
    s_mov_b32 s58, 8388608
    s_waitcnt vmcnt(0)
    s_branch L_adaLN_cond__grouped_kv_mqa__dense_activation_silu__prompt_kernel_pkvc_9
L_adaLN_cond__grouped_kv_mqa__dense_activation_silu__prompt_kernel_pkv_8:
    buffer_load_dwordx4 v[220:223], v12, s[36:39], s59 offen offset:0 sc1
    s_sub_u32 s58, s58, 1
    s_cbranch_scc1 L_adaLN_cond__grouped_kv_mqa__dense_activation_silu__prompt_kernel_pkvd_10
    s_waitcnt vmcnt(0)
L_adaLN_cond__grouped_kv_mqa__dense_activation_silu__prompt_kernel_pkvc_9:
    v_cmp_ne_u64 vcc, s[32:33], v[220:221]
    v_cmp_ne_u64 s[56:57], s[32:33], v[222:223]
    s_or_b64 vcc, vcc, s[56:57]
    s_cbranch_vccz L_adaLN_cond__grouped_kv_mqa__dense_activation_silu__prompt_kernel_pkvd_10
    s_sleep 1
    s_branch L_adaLN_cond__grouped_kv_mqa__dense_activation_silu__prompt_kernel_pkv_8
L_adaLN_cond__grouped_kv_mqa__dense_activation_silu__prompt_kernel_pkvd_10:
    s_add_u32 s52, s75, 0
    buffer_load_dwordx2 a[8:9], v96, s[36:39], s52 offen offset:2048 sc1
    buffer_load_dwordx4 a[0:3], v4, s[36:39], s52 offen sc1
    buffer_load_dwordx4 a[4:7], v4, s[36:39], s52 offen offset:1024 sc1
    s_mov_b64 exec, 0x3ff
    buffer_load_dword v14, v5, s[36:39], s53 offen sc1
    s_mov_b64 exec, -1
    s_mul_i32 s52, s30, 6400
    s_add_u32 s52, s52, 122880
    v_add_u32 v5, s52, v4
    v_lshlrev_b32 v6, 3, v3
    v_bfe_u32 v8, v1, 2, 2
    v_add_u32 v6, v6, v8
    v_lshlrev_b32 v6, 6, v6
    v_and_b32 v8, 3, v1
    v_lshl_add_u32 v6, v8, 3, v6
    v_add_u32 v6, s52, v6
    s_waitcnt lgkmcnt(0)
    ds_write_b128 v5, a[228:231] offset:0
    ds_write_b128 v5, a[232:235] offset:1024
    ds_write_b128 v5, a[236:239] offset:2048
    ds_write_b128 v5, a[240:243] offset:3072
    ds_write_b128 v5, a[244:247] offset:4096
    ds_write_b128 v5, a[248:251] offset:5120
    ds_read_b64_tr_b16 v[100:101], v6 offset:0
    ds_read_b64_tr_b16 v[102:103], v6 offset:256
    ds_read_b64_tr_b16 v[104:105], v6 offset:32
    ds_read_b64_tr_b16 v[106:107], v6 offset:288
    s_waitcnt lgkmcnt(4)
    ds_read_b64_tr_b16 v[108:109], v6 offset:2048
    ds_read_b64_tr_b16 v[110:111], v6 offset:2304
    ds_read_b64_tr_b16 v[112:113], v6 offset:2080
    ds_read_b64_tr_b16 v[114:115], v6 offset:2336
    ds_read_b64_tr_b16 v[116:117], v6 offset:4096
    ds_read_b64_tr_b16 v[118:119], v6 offset:4352
    ds_read_b64_tr_b16 v[120:121], v6 offset:4128
    ds_read_b64_tr_b16 v[122:123], v6 offset:4384
    s_waitcnt lgkmcnt(0)
    s_barrier
    ds_read_b128 v[16:19], v9 offset:0
    ds_read_b128 v[36:39], v9 offset:30720
    ds_read_b128 v[56:59], v10 offset:0
    ds_read_b128 v[76:79], v10 offset:30720
    ds_read_b128 v[20:23], v9 offset:1024
    ds_read_b128 v[40:43], v9 offset:31744
    ds_read_b128 v[60:63], v10 offset:1024
    ds_read_b128 v[80:83], v10 offset:31744
    ds_read_b128 v[24:27], v9 offset:2048
    ds_read_b128 v[44:47], v9 offset:32768
    ds_read_b128 v[64:67], v10 offset:2048
    ds_read_b128 v[84:87], v10 offset:32768
    s_waitcnt lgkmcnt(8)
    ds_read_b128 v[28:31], v9 offset:3072
    ds_read_b128 v[48:51], v9 offset:33792
    ds_read_b128 v[68:71], v10 offset:3072
    ds_read_b128 v[88:91], v10 offset:33792
    ds_read_b128 v[32:35], v9 offset:4096
    ds_read_b128 v[52:55], v9 offset:34816
    ds_read_b128 v[72:75], v10 offset:4096
    ds_read_b128 v[92:95], v10 offset:34816
    s_add_u32 s52, s75, 2560
    s_mov_b64 exec, s[80:81]
    buffer_load_dwordx4 a[80:83], v97, s[36:39], s52 offen offset:0 sc1
    buffer_load_dwordx4 a[84:87], v97, s[36:39], s52 offen offset:640 sc1
    buffer_load_dwordx4 a[88:91], v97, s[36:39], s52 offen offset:1280 sc1
    buffer_load_dwordx4 a[92:95], v97, s[36:39], s52 offen offset:1920 sc1
    s_mov_b64 exec, -1
    v_mov_b32 v5, 0xdddd
    v_and_b32 v9, 31, v1
    v_lshrrev_b32 v10, 5, v1
    s_mul_i32 s52, s30, 12288
    s_add_u32 s52, s52, 102400
    v_add_u32 v6, s52, v4
    v_add_u32 v7, 153600, v4
    v_lshlrev_b32 v8, 3, v9
    v_add_u32 v8, 154624, v8
    v_accvgpr_write_b32 a252, 0
    v_accvgpr_write_b32 a253, 0
    s_mul_i32 s52, s30, 3072
    s_add_u32 s52, s52, 102400
    v_add_u32 v13, s52, v4
    v_bfe_u32 v9, v1, 4, 1
    v_mul_u32_u24 v12, 20480, v9
    v_lshl_add_u32 v12, v2, 4, v12
    v_lshl_add_u32 v12, v10, 8, v12
    v_lshlrev_b32 v11, 7, v1
    s_waitcnt lgkmcnt(15)
    v_pk_add_f32 v[16:17], v[16:17], v[36:37]
    v_pk_add_f32 v[56:57], v[56:57], v[76:77]
    v_pk_add_f32 v[18:19], v[18:19], v[38:39]
    v_pk_add_f32 v[58:59], v[58:59], v[78:79]
    v_pk_add_f32 v[16:17], v[16:17], v[56:57]
    v_pk_add_f32 v[18:19], v[18:19], v[58:59]
    v_cvt_pk_bf16_f32 v16, v16, v17
    v_cvt_pk_bf16_f32 v17, v18, v19
    ds_write_b64 v228, v[16:17]
    s_waitcnt lgkmcnt(13)
    v_pk_add_f32 v[20:21], v[20:21], v[40:41]
    v_pk_add_f32 v[60:61], v[60:61], v[80:81]
    v_pk_add_f32 v[22:23], v[22:23], v[42:43]
    v_pk_add_f32 v[62:63], v[62:63], v[82:83]
    v_pk_add_f32 v[20:21], v[20:21], v[60:61]
    v_pk_add_f32 v[22:23], v[22:23], v[62:63]
    v_cvt_pk_bf16_f32 v20, v20, v21
    v_cvt_pk_bf16_f32 v21, v22, v23
    ds_write_b64 v229, v[20:21]
    s_waitcnt lgkmcnt(10)
    v_pk_add_f32 v[24:25], v[24:25], v[44:45]
    v_pk_add_f32 v[64:65], v[64:65], v[84:85]
    v_pk_add_f32 v[26:27], v[26:27], v[46:47]
    v_pk_add_f32 v[66:67], v[66:67], v[86:87]
    v_pk_add_f32 v[24:25], v[24:25], v[64:65]
    v_pk_add_f32 v[26:27], v[26:27], v[66:67]
    v_cvt_pk_bf16_f32 v24, v24, v25
    v_cvt_pk_bf16_f32 v25, v26, v27
    ds_write_b64 v230, v[24:25]
    s_waitcnt lgkmcnt(7)
    v_pk_add_f32 v[28:29], v[28:29], v[48:49]
    v_pk_add_f32 v[68:69], v[68:69], v[88:89]
    v_pk_add_f32 v[30:31], v[30:31], v[50:51]
    v_pk_add_f32 v[70:71], v[70:71], v[90:91]
    v_pk_add_f32 v[28:29], v[28:29], v[68:69]
    v_pk_add_f32 v[30:31], v[30:31], v[70:71]
    v_cvt_pk_bf16_f32 v28, v28, v29
    v_cvt_pk_bf16_f32 v29, v30, v31
    ds_write_b64 v231, v[28:29]
    s_waitcnt lgkmcnt(4)
    v_pk_add_f32 v[32:33], v[32:33], v[52:53]
    v_pk_add_f32 v[72:73], v[72:73], v[92:93]
    v_pk_add_f32 v[34:35], v[34:35], v[54:55]
    v_pk_add_f32 v[74:75], v[74:75], v[94:95]
    v_pk_add_f32 v[32:33], v[32:33], v[72:73]
    v_pk_add_f32 v[34:35], v[34:35], v[74:75]
    v_cvt_pk_bf16_f32 v32, v32, v33
    v_cvt_pk_bf16_f32 v33, v34, v35
    ds_write_b64 v232, v[32:33]
    s_add_u32 s52, s75, 5120
    buffer_load_dwordx2 a[18:19], v96, s[36:39], s52 offen offset:2048 sc1
    buffer_load_dwordx4 a[10:13], v4, s[36:39], s52 offen sc1
    buffer_load_dwordx4 a[14:17], v4, s[36:39], s52 offen offset:1024 sc1
    s_waitcnt lgkmcnt(0)
    s_barrier
    ds_read_b128 v[80:83], v7 offset:0
    ds_read_b64 v[84:85], v8 offset:0
    ds_read_b128 v[86:89], v7 offset:1280
    ds_read_b64 v[90:91], v8 offset:1280
    v_mfma_f32_32x32x8_bf16 a[208:223], a[252:253], a[252:253], 0
    v_mfma_f32_32x32x8_bf16 a[224:239], a[252:253], a[252:253], 0
    s_add_u32 s52, s75, 7680
    s_mov_b64 exec, s[80:81]
    buffer_load_dwordx4 a[96:99], v97, s[36:39], s52 offen offset:0 sc1
    buffer_load_dwordx4 a[100:103], v97, s[36:39], s52 offen offset:640 sc1
    buffer_load_dwordx4 a[104:107], v97, s[36:39], s52 offen offset:1280 sc1
    buffer_load_dwordx4 a[108:111], v97, s[36:39], s52 offen offset:1920 sc1
    s_mov_b64 exec, -1
    s_add_u32 s52, s75, 10240
    buffer_load_dwordx2 a[28:29], v96, s[36:39], s52 offen offset:2048 sc1
    buffer_load_dwordx4 a[20:23], v4, s[36:39], s52 offen sc1
    buffer_load_dwordx4 a[24:27], v4, s[36:39], s52 offen offset:1024 sc1
    s_waitcnt vmcnt(15)
    s_waitcnt lgkmcnt(0)
    v_mfma_f32_32x32x4_2b_bf16 v[16:47], a[8:9], v[84:85], 0
    s_nop 15
    s_nop 1
    v_mfma_f32_32x32x16_bf16 v[16:31], a[0:3], v[80:83], v[16:31]
    v_mfma_f32_32x32x16_bf16 v[32:47], a[4:7], v[80:83], v[32:47]
    s_nop 10
    v_exp_f32 v16, v16
    v_exp_f32 v17, v17
    v_exp_f32 v18, v18
    v_exp_f32 v19, v19
    v_exp_f32 v20, v20
    v_mfma_f32_32x32x4_2b_bf16 v[48:79], a[8:9], v[90:91], 0
    s_add_u32 s52, s75, 12800
    s_mov_b64 exec, s[80:81]
    buffer_load_dwordx4 a[112:115], v97, s[36:39], s52 offen offset:0 sc1
    buffer_load_dwordx4 a[116:119], v97, s[36:39], s52 offen offset:640 sc1
    buffer_load_dwordx4 a[120:123], v97, s[36:39], s52 offen offset:1280 sc1
    buffer_load_dwordx4 a[124:127], v97, s[36:39], s52 offen offset:1920 sc1
    s_mov_b64 exec, -1
    v_exp_f32 v21, v21
    v_exp_f32 v22, v22
    v_exp_f32 v23, v23
    v_exp_f32 v24, v24
    v_exp_f32 v25, v25
    v_exp_f32 v26, v26
    v_exp_f32 v27, v27
    v_exp_f32 v28, v28
    s_waitcnt vmcnt(14)
    v_smfmac_f32_32x32x32_bf16 a[208:223], a[80:83], v[16:23], v5
    v_exp_f32 v29, v29
    v_exp_f32 v30, v30
    v_exp_f32 v31, v31
    v_exp_f32 v32, v32
    v_exp_f32 v33, v33
    v_smfmac_f32_32x32x32_bf16 a[208:223], a[84:87], v[24:31], v5
    v_exp_f32 v34, v34
    v_exp_f32 v35, v35
    v_exp_f32 v36, v36
    v_exp_f32 v37, v37
    v_mfma_f32_32x32x16_bf16 v[48:63], a[0:3], v[86:89], v[48:63]
    v_exp_f32 v38, v38
    v_exp_f32 v39, v39
    v_exp_f32 v40, v40
    v_exp_f32 v41, v41
    v_smfmac_f32_32x32x32_bf16 a[208:223], a[88:91], v[32:39], v5
    v_exp_f32 v42, v42
    v_exp_f32 v43, v43
    v_exp_f32 v44, v44
    v_exp_f32 v45, v45
    v_mfma_f32_32x32x16_bf16 v[64:79], a[4:7], v[86:89], v[64:79]
    v_exp_f32 v46, v46
    v_exp_f32 v47, v47
    v_exp_f32 v48, v48
    v_exp_f32 v49, v49
    v_smfmac_f32_32x32x32_bf16 a[208:223], a[92:95], v[40:47], v5
    v_exp_f32 v50, v50
    v_exp_f32 v51, v51
    v_exp_f32 v52, v52
    s_waitcnt vmcnt(11)
    v_mfma_f32_32x32x4_2b_bf16 v[16:47], a[18:19], v[84:85], 0
    s_add_u32 s52, s75, 15360
    buffer_load_dwordx2 a[38:39], v96, s[36:39], s52 offen offset:2048 sc1
    buffer_load_dwordx4 a[30:33], v4, s[36:39], s52 offen sc1
    buffer_load_dwordx4 a[34:37], v4, s[36:39], s52 offen offset:1024 sc1
    s_cmp_lg_u32 s30, 0
    s_cbranch_scc1 L_noxf
    s_getreg_b32 s52, hwreg(HW_REG_XCC_ID)
    v_mov_b32 v124, s32
    v_mov_b32 v125, s33
    v_mov_b32 v126, s52
    v_mov_b32 v127, 0
    s_lshl_b32 s52, s28, 3
    s_add_u32 s52, s52, s29
    s_lshl_b32 s52, s52, 4
    s_add_u32 s52, s52, 442368
    s_mov_b64 exec, 1
    buffer_store_dwordx4 v[124:127], v127, s[36:39], s52 offen sc1
    s_mov_b64 exec, -1
L_noxf:
    buffer_store_dwordx4 v[100:103], v4, s[36:39], s60 offen sc1
    buffer_store_dwordx4 v[104:107], v4, s[36:39], s61 offen sc1
    buffer_store_dwordx4 v[108:111], v4, s[36:39], s62 offen sc1
    buffer_store_dwordx4 v[112:115], v4, s[36:39], s63 offen sc1
    buffer_store_dwordx4 v[116:119], v4, s[36:39], s64 offen sc1
    buffer_store_dwordx4 v[120:123], v4, s[36:39], s65 offen sc1
    v_exp_f32 v53, v53
    v_exp_f32 v54, v54
    v_exp_f32 v55, v55
    v_exp_f32 v56, v56
    v_exp_f32 v57, v57
    v_exp_f32 v58, v58
    v_exp_f32 v59, v59
    v_exp_f32 v60, v60
    v_smfmac_f32_32x32x32_bf16 a[224:239], a[80:83], v[48:55], v5
    v_exp_f32 v61, v61
    v_exp_f32 v62, v62
    v_exp_f32 v63, v63
    v_exp_f32 v64, v64
    v_exp_f32 v65, v65
    v_smfmac_f32_32x32x32_bf16 a[224:239], a[84:87], v[56:63], v5
    v_exp_f32 v66, v66
    v_exp_f32 v67, v67
    v_exp_f32 v68, v68
    v_exp_f32 v69, v69
    v_mfma_f32_32x32x16_bf16 v[16:31], a[10:13], v[80:83], v[16:31]
    v_exp_f32 v70, v70
    v_exp_f32 v71, v71
    v_exp_f32 v72, v72
    v_exp_f32 v73, v73
    v_smfmac_f32_32x32x32_bf16 a[224:239], a[88:91], v[64:71], v5
    v_exp_f32 v74, v74
    v_exp_f32 v75, v75
    v_exp_f32 v76, v76
    v_exp_f32 v77, v77
    v_mfma_f32_32x32x16_bf16 v[32:47], a[14:17], v[80:83], v[32:47]
    v_exp_f32 v78, v78
    v_exp_f32 v79, v79
    v_exp_f32 v16, v16
    v_exp_f32 v17, v17
    v_smfmac_f32_32x32x32_bf16 a[224:239], a[92:95], v[72:79], v5
    v_exp_f32 v18, v18
    v_exp_f32 v19, v19
    v_exp_f32 v20, v20
    v_mfma_f32_32x32x4_2b_bf16 v[48:79], a[18:19], v[90:91], 0
    s_add_u32 s52, s75, 17920
    s_mov_b64 exec, s[80:81]
    buffer_load_dwordx4 a[128:131], v97, s[36:39], s52 offen offset:0 sc1
    buffer_load_dwordx4 a[132:135], v97, s[36:39], s52 offen offset:640 sc1
    buffer_load_dwordx4 a[136:139], v97, s[36:39], s52 offen offset:1280 sc1
    buffer_load_dwordx4 a[140:143], v97, s[36:39], s52 offen offset:1920 sc1
    s_mov_b64 exec, -1
    v_exp_f32 v21, v21
    v_exp_f32 v22, v22
    v_exp_f32 v23, v23
    v_exp_f32 v24, v24
    v_exp_f32 v25, v25
    v_exp_f32 v26, v26
    v_exp_f32 v27, v27
    v_exp_f32 v28, v28
    s_waitcnt vmcnt(20)
    v_smfmac_f32_32x32x32_bf16 a[208:223], a[96:99], v[16:23], v5
    v_exp_f32 v29, v29
    v_exp_f32 v30, v30
    v_exp_f32 v31, v31
    v_exp_f32 v32, v32
    v_exp_f32 v33, v33
    v_smfmac_f32_32x32x32_bf16 a[208:223], a[100:103], v[24:31], v5
    v_exp_f32 v34, v34
    v_exp_f32 v35, v35
    v_exp_f32 v36, v36
    v_exp_f32 v37, v37
    v_mfma_f32_32x32x16_bf16 v[48:63], a[10:13], v[86:89], v[48:63]
    v_exp_f32 v38, v38
    v_exp_f32 v39, v39
    v_exp_f32 v40, v40
    v_exp_f32 v41, v41
    v_smfmac_f32_32x32x32_bf16 a[208:223], a[104:107], v[32:39], v5
    v_exp_f32 v42, v42
    v_exp_f32 v43, v43
    v_exp_f32 v44, v44
    v_exp_f32 v45, v45
    v_mfma_f32_32x32x16_bf16 v[64:79], a[14:17], v[86:89], v[64:79]
    v_exp_f32 v46, v46
    v_exp_f32 v47, v47
    v_exp_f32 v48, v48
    v_exp_f32 v49, v49
    v_smfmac_f32_32x32x32_bf16 a[208:223], a[108:111], v[40:47], v5
    v_exp_f32 v50, v50
    v_exp_f32 v51, v51
    v_exp_f32 v52, v52
    s_waitcnt vmcnt(17)
    v_mfma_f32_32x32x4_2b_bf16 v[16:47], a[28:29], v[84:85], 0
    s_add_u32 s52, s75, 20480
    buffer_load_dwordx2 a[48:49], v96, s[36:39], s52 offen offset:2048 sc1
    buffer_load_dwordx4 a[40:43], v4, s[36:39], s52 offen sc1
    buffer_load_dwordx4 a[44:47], v4, s[36:39], s52 offen offset:1024 sc1
    v_exp_f32 v53, v53
    v_exp_f32 v54, v54
    v_exp_f32 v55, v55
    v_exp_f32 v56, v56
    v_exp_f32 v57, v57
    v_exp_f32 v58, v58
    v_exp_f32 v59, v59
    v_exp_f32 v60, v60
    v_smfmac_f32_32x32x32_bf16 a[224:239], a[96:99], v[48:55], v5
    v_exp_f32 v61, v61
    v_exp_f32 v62, v62
    v_exp_f32 v63, v63
    v_exp_f32 v64, v64
    v_exp_f32 v65, v65
    v_smfmac_f32_32x32x32_bf16 a[224:239], a[100:103], v[56:63], v5
    v_exp_f32 v66, v66
    v_exp_f32 v67, v67
    v_exp_f32 v68, v68
    v_exp_f32 v69, v69
    v_mfma_f32_32x32x16_bf16 v[16:31], a[20:23], v[80:83], v[16:31]
    v_exp_f32 v70, v70
    v_exp_f32 v71, v71
    v_exp_f32 v72, v72
    v_exp_f32 v73, v73
    v_smfmac_f32_32x32x32_bf16 a[224:239], a[104:107], v[64:71], v5
    v_exp_f32 v74, v74
    v_exp_f32 v75, v75
    v_exp_f32 v76, v76
    v_exp_f32 v77, v77
    v_mfma_f32_32x32x16_bf16 v[32:47], a[24:27], v[80:83], v[32:47]
    v_exp_f32 v78, v78
    v_exp_f32 v79, v79
    v_exp_f32 v16, v16
    v_exp_f32 v17, v17
    v_smfmac_f32_32x32x32_bf16 a[224:239], a[108:111], v[72:79], v5
    v_exp_f32 v18, v18
    v_exp_f32 v19, v19
    v_exp_f32 v20, v20
    v_mfma_f32_32x32x4_2b_bf16 v[48:79], a[28:29], v[90:91], 0
    s_add_u32 s52, s75, 23040
    s_mov_b64 exec, s[80:81]
    buffer_load_dwordx4 a[144:147], v97, s[36:39], s52 offen offset:0 sc1
    buffer_load_dwordx4 a[148:151], v97, s[36:39], s52 offen offset:640 sc1
    buffer_load_dwordx4 a[152:155], v97, s[36:39], s52 offen offset:1280 sc1
    buffer_load_dwordx4 a[156:159], v97, s[36:39], s52 offen offset:1920 sc1
    s_mov_b64 exec, -1
    v_exp_f32 v21, v21
    v_exp_f32 v22, v22
    v_exp_f32 v23, v23
    v_exp_f32 v24, v24
    v_exp_f32 v25, v25
    v_exp_f32 v26, v26
    v_exp_f32 v27, v27
    v_exp_f32 v28, v28
    s_waitcnt vmcnt(20)
    v_smfmac_f32_32x32x32_bf16 a[208:223], a[112:115], v[16:23], v5
    v_exp_f32 v29, v29
    v_exp_f32 v30, v30
    v_exp_f32 v31, v31
    v_exp_f32 v32, v32
    v_exp_f32 v33, v33
    v_smfmac_f32_32x32x32_bf16 a[208:223], a[116:119], v[24:31], v5
    v_exp_f32 v34, v34
    v_exp_f32 v35, v35
    v_exp_f32 v36, v36
    v_exp_f32 v37, v37
    v_mfma_f32_32x32x16_bf16 v[48:63], a[20:23], v[86:89], v[48:63]
    v_exp_f32 v38, v38
    v_exp_f32 v39, v39
    v_exp_f32 v40, v40
    v_exp_f32 v41, v41
    v_smfmac_f32_32x32x32_bf16 a[208:223], a[120:123], v[32:39], v5
    v_exp_f32 v42, v42
    v_exp_f32 v43, v43
    v_exp_f32 v44, v44
    v_exp_f32 v45, v45
    v_mfma_f32_32x32x16_bf16 v[64:79], a[24:27], v[86:89], v[64:79]
    v_exp_f32 v46, v46
    v_exp_f32 v47, v47
    v_exp_f32 v48, v48
    v_exp_f32 v49, v49
    v_smfmac_f32_32x32x32_bf16 a[208:223], a[124:127], v[40:47], v5
    v_exp_f32 v50, v50
    v_exp_f32 v51, v51
    v_exp_f32 v52, v52
    s_waitcnt vmcnt(17)
    v_mfma_f32_32x32x4_2b_bf16 v[16:47], a[38:39], v[84:85], 0
    s_add_u32 s52, s75, 25600
    buffer_load_dwordx2 a[58:59], v96, s[36:39], s52 offen offset:2048 sc1
    buffer_load_dwordx4 a[50:53], v4, s[36:39], s52 offen sc1
    buffer_load_dwordx4 a[54:57], v4, s[36:39], s52 offen offset:1024 sc1
    v_exp_f32 v53, v53
    v_exp_f32 v54, v54
    v_exp_f32 v55, v55
    v_exp_f32 v56, v56
    v_exp_f32 v57, v57
    v_exp_f32 v58, v58
    v_exp_f32 v59, v59
    v_exp_f32 v60, v60
    v_smfmac_f32_32x32x32_bf16 a[224:239], a[112:115], v[48:55], v5
    v_exp_f32 v61, v61
    v_exp_f32 v62, v62
    v_exp_f32 v63, v63
    v_exp_f32 v64, v64
    v_exp_f32 v65, v65
    v_smfmac_f32_32x32x32_bf16 a[224:239], a[116:119], v[56:63], v5
    v_exp_f32 v66, v66
    v_exp_f32 v67, v67
    v_exp_f32 v68, v68
    v_exp_f32 v69, v69
    v_mfma_f32_32x32x16_bf16 v[16:31], a[30:33], v[80:83], v[16:31]
    v_exp_f32 v70, v70
    v_exp_f32 v71, v71
    v_exp_f32 v72, v72
    v_exp_f32 v73, v73
    v_smfmac_f32_32x32x32_bf16 a[224:239], a[120:123], v[64:71], v5
    v_exp_f32 v74, v74
    v_exp_f32 v75, v75
    v_exp_f32 v76, v76
    v_exp_f32 v77, v77
    v_mfma_f32_32x32x16_bf16 v[32:47], a[34:37], v[80:83], v[32:47]
    v_exp_f32 v78, v78
    v_exp_f32 v79, v79
    v_exp_f32 v16, v16
    v_exp_f32 v17, v17
    v_smfmac_f32_32x32x32_bf16 a[224:239], a[124:127], v[72:79], v5
    v_exp_f32 v18, v18
    v_exp_f32 v19, v19
    v_exp_f32 v20, v20
    v_mfma_f32_32x32x4_2b_bf16 v[48:79], a[38:39], v[90:91], 0
    s_add_u32 s52, s75, 28160
    s_mov_b64 exec, s[80:81]
    buffer_load_dwordx4 a[160:163], v97, s[36:39], s52 offen offset:0 sc1
    buffer_load_dwordx4 a[164:167], v97, s[36:39], s52 offen offset:640 sc1
    buffer_load_dwordx4 a[168:171], v97, s[36:39], s52 offen offset:1280 sc1
    buffer_load_dwordx4 a[172:175], v97, s[36:39], s52 offen offset:1920 sc1
    s_mov_b64 exec, -1
    v_exp_f32 v21, v21
    v_exp_f32 v22, v22
    v_exp_f32 v23, v23
    v_exp_f32 v24, v24
    v_exp_f32 v25, v25
    v_exp_f32 v26, v26
    v_exp_f32 v27, v27
    v_exp_f32 v28, v28
    s_waitcnt vmcnt(14)
    v_smfmac_f32_32x32x32_bf16 a[208:223], a[128:131], v[16:23], v5
    v_exp_f32 v29, v29
    v_exp_f32 v30, v30
    v_exp_f32 v31, v31
    v_exp_f32 v32, v32
    v_exp_f32 v33, v33
    v_smfmac_f32_32x32x32_bf16 a[208:223], a[132:135], v[24:31], v5
    v_exp_f32 v34, v34
    v_exp_f32 v35, v35
    v_exp_f32 v36, v36
    v_exp_f32 v37, v37
    v_mfma_f32_32x32x16_bf16 v[48:63], a[30:33], v[86:89], v[48:63]
    v_exp_f32 v38, v38
    v_exp_f32 v39, v39
    v_exp_f32 v40, v40
    v_exp_f32 v41, v41
    v_smfmac_f32_32x32x32_bf16 a[208:223], a[136:139], v[32:39], v5
    v_exp_f32 v42, v42
    v_exp_f32 v43, v43
    v_exp_f32 v44, v44
    v_exp_f32 v45, v45
    v_mfma_f32_32x32x16_bf16 v[64:79], a[34:37], v[86:89], v[64:79]
    v_exp_f32 v46, v46
    v_exp_f32 v47, v47
    s_waitcnt vmcnt(18)
    s_barrier
    s_cmp_lg_u32 s30, 0
    s_cbranch_scc1 L_noprepflag
    s_lshl_b32 s52, s2, 6
    s_add_u32 s52, s52, 425984
    v_mov_b32 v208, s32
    v_mov_b32 v209, s33
    v_mov_b32 v210, 0
    s_mov_b64 exec, 1
    buffer_store_dwordx2 v[208:209], v210, s[36:39], s52 offen sc1
    s_mov_b64 exec, -1
L_noprepflag:
    v_exp_f32 v48, v48
    v_exp_f32 v49, v49
    v_smfmac_f32_32x32x32_bf16 a[208:223], a[140:143], v[40:47], v5
    v_exp_f32 v50, v50
    v_exp_f32 v51, v51
    v_exp_f32 v52, v52
    s_waitcnt vmcnt(11)
    v_mfma_f32_32x32x4_2b_bf16 v[16:47], a[48:49], v[84:85], 0
    s_add_u32 s52, s75, 30720
    buffer_load_dwordx2 a[68:69], v96, s[36:39], s52 offen offset:2048 sc1
    buffer_load_dwordx4 a[60:63], v4, s[36:39], s52 offen sc1
    buffer_load_dwordx4 a[64:67], v4, s[36:39], s52 offen offset:1024 sc1
    v_exp_f32 v53, v53
    v_exp_f32 v54, v54
    v_exp_f32 v55, v55
    v_exp_f32 v56, v56
    v_exp_f32 v57, v57
    v_exp_f32 v58, v58
    v_exp_f32 v59, v59
    v_exp_f32 v60, v60
    v_smfmac_f32_32x32x32_bf16 a[224:239], a[128:131], v[48:55], v5
    v_exp_f32 v61, v61
    v_exp_f32 v62, v62
    v_exp_f32 v63, v63
    v_exp_f32 v64, v64
    v_exp_f32 v65, v65
    v_smfmac_f32_32x32x32_bf16 a[224:239], a[132:135], v[56:63], v5
    v_exp_f32 v66, v66
    v_exp_f32 v67, v67
    v_exp_f32 v68, v68
    v_exp_f32 v69, v69
    v_mfma_f32_32x32x16_bf16 v[16:31], a[40:43], v[80:83], v[16:31]
    v_exp_f32 v70, v70
    v_exp_f32 v71, v71
    v_exp_f32 v72, v72
    v_exp_f32 v73, v73
    v_smfmac_f32_32x32x32_bf16 a[224:239], a[136:139], v[64:71], v5
    v_exp_f32 v74, v74
    v_exp_f32 v75, v75
    v_exp_f32 v76, v76
    v_exp_f32 v77, v77
    v_mfma_f32_32x32x16_bf16 v[32:47], a[44:47], v[80:83], v[32:47]
    v_exp_f32 v78, v78
    v_exp_f32 v79, v79
    v_exp_f32 v16, v16
    v_exp_f32 v17, v17
    v_smfmac_f32_32x32x32_bf16 a[224:239], a[140:143], v[72:79], v5
    v_exp_f32 v18, v18
    v_exp_f32 v19, v19
    v_exp_f32 v20, v20
    v_mfma_f32_32x32x4_2b_bf16 v[48:79], a[48:49], v[90:91], 0
    s_add_u32 s52, s75, 33280
    s_mov_b64 exec, s[80:81]
    buffer_load_dwordx4 a[176:179], v97, s[36:39], s52 offen offset:0 sc1
    buffer_load_dwordx4 a[180:183], v97, s[36:39], s52 offen offset:640 sc1
    buffer_load_dwordx4 a[184:187], v97, s[36:39], s52 offen offset:1280 sc1
    buffer_load_dwordx4 a[188:191], v97, s[36:39], s52 offen offset:1920 sc1
    s_mov_b64 exec, -1
    v_exp_f32 v21, v21
    v_exp_f32 v22, v22
    v_exp_f32 v23, v23
    v_exp_f32 v24, v24
    v_exp_f32 v25, v25
    v_exp_f32 v26, v26
    v_exp_f32 v27, v27
    v_exp_f32 v28, v28
    s_waitcnt vmcnt(14)
    v_smfmac_f32_32x32x32_bf16 a[208:223], a[144:147], v[16:23], v5
    v_exp_f32 v29, v29
    v_exp_f32 v30, v30
    v_exp_f32 v31, v31
    v_exp_f32 v32, v32
    v_exp_f32 v33, v33
    v_smfmac_f32_32x32x32_bf16 a[208:223], a[148:151], v[24:31], v5
    v_exp_f32 v34, v34
    v_exp_f32 v35, v35
    v_exp_f32 v36, v36
    v_exp_f32 v37, v37
    v_mfma_f32_32x32x16_bf16 v[48:63], a[40:43], v[86:89], v[48:63]
    v_exp_f32 v38, v38
    v_exp_f32 v39, v39
    v_exp_f32 v40, v40
    v_exp_f32 v41, v41
    v_smfmac_f32_32x32x32_bf16 a[208:223], a[152:155], v[32:39], v5
    v_exp_f32 v42, v42
    v_exp_f32 v43, v43
    v_exp_f32 v44, v44
    v_exp_f32 v45, v45
    v_mfma_f32_32x32x16_bf16 v[64:79], a[44:47], v[86:89], v[64:79]
    v_exp_f32 v46, v46
    v_exp_f32 v47, v47
    v_exp_f32 v48, v48
    v_exp_f32 v49, v49
    v_smfmac_f32_32x32x32_bf16 a[208:223], a[156:159], v[40:47], v5
    v_exp_f32 v50, v50
    v_exp_f32 v51, v51
    v_exp_f32 v52, v52
    s_waitcnt vmcnt(11)
    v_mfma_f32_32x32x4_2b_bf16 v[16:47], a[58:59], v[84:85], 0
    s_add_u32 s52, s75, 35840
    buffer_load_dwordx2 a[78:79], v96, s[36:39], s52 offen offset:2048 sc1
    buffer_load_dwordx4 a[70:73], v4, s[36:39], s52 offen sc1
    buffer_load_dwordx4 a[74:77], v4, s[36:39], s52 offen offset:1024 sc1
    v_exp_f32 v53, v53
    v_exp_f32 v54, v54
    v_exp_f32 v55, v55
    v_exp_f32 v56, v56
    v_exp_f32 v57, v57
    v_exp_f32 v58, v58
    v_exp_f32 v59, v59
    v_exp_f32 v60, v60
    v_smfmac_f32_32x32x32_bf16 a[224:239], a[144:147], v[48:55], v5
    v_exp_f32 v61, v61
    v_exp_f32 v62, v62
    v_exp_f32 v63, v63
    v_exp_f32 v64, v64
    v_exp_f32 v65, v65
    v_smfmac_f32_32x32x32_bf16 a[224:239], a[148:151], v[56:63], v5
    v_exp_f32 v66, v66
    v_exp_f32 v67, v67
    v_exp_f32 v68, v68
    v_exp_f32 v69, v69
    v_mfma_f32_32x32x16_bf16 v[16:31], a[50:53], v[80:83], v[16:31]
    v_exp_f32 v70, v70
    v_exp_f32 v71, v71
    v_exp_f32 v72, v72
    v_exp_f32 v73, v73
    v_smfmac_f32_32x32x32_bf16 a[224:239], a[152:155], v[64:71], v5
    v_exp_f32 v74, v74
    v_exp_f32 v75, v75
    v_exp_f32 v76, v76
    v_exp_f32 v77, v77
    v_mfma_f32_32x32x16_bf16 v[32:47], a[54:57], v[80:83], v[32:47]
    v_exp_f32 v78, v78
    v_exp_f32 v79, v79
    v_exp_f32 v16, v16
    v_exp_f32 v17, v17
    v_smfmac_f32_32x32x32_bf16 a[224:239], a[156:159], v[72:79], v5
    v_exp_f32 v18, v18
    v_exp_f32 v19, v19
    v_exp_f32 v20, v20
    v_mfma_f32_32x32x4_2b_bf16 v[48:79], a[58:59], v[90:91], 0
    s_add_u32 s52, s75, 38400
    s_mov_b64 exec, s[80:81]
    buffer_load_dwordx4 a[192:195], v97, s[36:39], s52 offen offset:0 sc1
    buffer_load_dwordx4 a[196:199], v97, s[36:39], s52 offen offset:640 sc1
    buffer_load_dwordx4 a[200:203], v97, s[36:39], s52 offen offset:1280 sc1
    buffer_load_dwordx4 a[204:207], v97, s[36:39], s52 offen offset:1920 sc1
    s_mov_b64 exec, -1
    s_sub_u32 s52, s35, 80
    s_cmp_lt_u32 s52, 160
    s_cselect_b32 s90, 1, 0
    s_cmp_eq_u32 s30, 0
    s_cselect_b32 s87, s90, 0
    v_exp_f32 v21, v21
    v_exp_f32 v22, v22
    v_exp_f32 v23, v23
    v_exp_f32 v24, v24
    v_exp_f32 v25, v25
    v_exp_f32 v26, v26
    v_exp_f32 v27, v27
    v_exp_f32 v28, v28
    s_waitcnt vmcnt(14)
    v_smfmac_f32_32x32x32_bf16 a[208:223], a[160:163], v[16:23], v5
    v_exp_f32 v29, v29
    v_exp_f32 v30, v30
    v_exp_f32 v31, v31
    v_exp_f32 v32, v32
    v_exp_f32 v33, v33
    v_smfmac_f32_32x32x32_bf16 a[208:223], a[164:167], v[24:31], v5
    v_exp_f32 v34, v34
    v_exp_f32 v35, v35
    v_exp_f32 v36, v36
    v_exp_f32 v37, v37
    v_mfma_f32_32x32x16_bf16 v[48:63], a[50:53], v[86:89], v[48:63]
    v_exp_f32 v38, v38
    v_exp_f32 v39, v39
    v_exp_f32 v40, v40
    v_exp_f32 v41, v41
    v_smfmac_f32_32x32x32_bf16 a[208:223], a[168:171], v[32:39], v5
    v_exp_f32 v42, v42
    v_exp_f32 v43, v43
    v_exp_f32 v44, v44
    v_exp_f32 v45, v45
    v_mfma_f32_32x32x16_bf16 v[64:79], a[54:57], v[86:89], v[64:79]
    v_exp_f32 v46, v46
    v_exp_f32 v47, v47
    v_exp_f32 v48, v48
    v_exp_f32 v49, v49
    v_smfmac_f32_32x32x32_bf16 a[208:223], a[172:175], v[40:47], v5
    v_exp_f32 v50, v50
    v_exp_f32 v51, v51
    v_exp_f32 v52, v52
    s_waitcnt vmcnt(11)
    v_mfma_f32_32x32x4_2b_bf16 v[16:47], a[68:69], v[84:85], 0
    v_exp_f32 v53, v53
    v_exp_f32 v54, v54
    v_exp_f32 v55, v55
    v_exp_f32 v56, v56
    v_exp_f32 v57, v57
    v_exp_f32 v58, v58
    v_exp_f32 v59, v59
    v_exp_f32 v60, v60
    v_smfmac_f32_32x32x32_bf16 a[224:239], a[160:163], v[48:55], v5
    v_exp_f32 v61, v61
    v_exp_f32 v62, v62
    v_exp_f32 v63, v63
    v_exp_f32 v64, v64
    v_exp_f32 v65, v65
    v_smfmac_f32_32x32x32_bf16 a[224:239], a[164:167], v[56:63], v5
    v_exp_f32 v66, v66
    v_exp_f32 v67, v67
    v_exp_f32 v68, v68
    v_exp_f32 v69, v69
    v_mfma_f32_32x32x16_bf16 v[16:31], a[60:63], v[80:83], v[16:31]
    v_exp_f32 v70, v70
    v_exp_f32 v71, v71
    v_exp_f32 v72, v72
    v_exp_f32 v73, v73
    v_smfmac_f32_32x32x32_bf16 a[224:239], a[168:171], v[64:71], v5
    v_exp_f32 v74, v74
    v_exp_f32 v75, v75
    v_exp_f32 v76, v76
    v_exp_f32 v77, v77
    v_mfma_f32_32x32x16_bf16 v[32:47], a[64:67], v[80:83], v[32:47]
    v_exp_f32 v78, v78
    v_exp_f32 v79, v79
    v_exp_f32 v16, v16
    v_exp_f32 v17, v17
    v_smfmac_f32_32x32x32_bf16 a[224:239], a[172:175], v[72:79], v5
    v_exp_f32 v18, v18
    v_exp_f32 v19, v19
    v_exp_f32 v20, v20
    v_mfma_f32_32x32x4_2b_bf16 v[48:79], a[68:69], v[90:91], 0
    s_cmp_lg_u32 s30, 0
    s_cbranch_scc1 L_nopfl
    v_lshlrev_b32 v10, 6, v1
    s_mov_b32 s59, 425984
    s_mov_b32 s60, 430080
    s_mov_b32 s61, 434176
    s_mov_b32 s62, 438272
    buffer_load_dwordx2 v[208:209], v10, s[36:39], s59 offen offset:0 sc1
    buffer_load_dwordx2 v[210:211], v10, s[36:39], s60 offen offset:0 sc1
    buffer_load_dwordx2 v[212:213], v10, s[36:39], s61 offen offset:0 sc1
    buffer_load_dwordx2 v[214:215], v10, s[36:39], s62 offen offset:0 sc1
L_nopfl:
    v_exp_f32 v21, v21
    v_exp_f32 v22, v22
    v_exp_f32 v23, v23
    v_exp_f32 v24, v24
    v_exp_f32 v25, v25
    v_exp_f32 v26, v26
    v_exp_f32 v27, v27
    v_exp_f32 v28, v28
    s_waitcnt vmcnt(7)
    v_smfmac_f32_32x32x32_bf16 a[208:223], a[176:179], v[16:23], v5
    v_exp_f32 v29, v29
    v_exp_f32 v30, v30
    v_exp_f32 v31, v31
    v_exp_f32 v32, v32
    v_exp_f32 v33, v33
    v_smfmac_f32_32x32x32_bf16 a[208:223], a[180:183], v[24:31], v5
    v_exp_f32 v34, v34
    v_exp_f32 v35, v35
    v_exp_f32 v36, v36
    v_exp_f32 v37, v37
    v_mfma_f32_32x32x16_bf16 v[48:63], a[60:63], v[86:89], v[48:63]
    v_exp_f32 v38, v38
    v_exp_f32 v39, v39
    v_exp_f32 v40, v40
    v_exp_f32 v41, v41
    v_smfmac_f32_32x32x32_bf16 a[208:223], a[184:187], v[32:39], v5
    v_exp_f32 v42, v42
    v_exp_f32 v43, v43
    v_exp_f32 v44, v44
    v_exp_f32 v45, v45
    v_mfma_f32_32x32x16_bf16 v[64:79], a[64:67], v[86:89], v[64:79]
    v_exp_f32 v46, v46
    v_exp_f32 v47, v47
    v_exp_f32 v48, v48
    v_exp_f32 v49, v49
    v_smfmac_f32_32x32x32_bf16 a[208:223], a[188:191], v[40:47], v5
    v_exp_f32 v50, v50
    v_exp_f32 v51, v51
    v_exp_f32 v52, v52
    s_waitcnt vmcnt(4)
    v_mfma_f32_32x32x4_2b_bf16 v[16:47], a[78:79], v[84:85], 0
    v_exp_f32 v53, v53
    v_exp_f32 v54, v54
    v_exp_f32 v55, v55
    v_exp_f32 v56, v56
    v_exp_f32 v57, v57
    v_exp_f32 v58, v58
    v_exp_f32 v59, v59
    v_exp_f32 v60, v60
    v_smfmac_f32_32x32x32_bf16 a[224:239], a[176:179], v[48:55], v5
    v_exp_f32 v61, v61
    v_exp_f32 v62, v62
    v_exp_f32 v63, v63
    v_exp_f32 v64, v64
    v_exp_f32 v65, v65
    v_smfmac_f32_32x32x32_bf16 a[224:239], a[180:183], v[56:63], v5
    v_exp_f32 v66, v66
    v_exp_f32 v67, v67
    v_exp_f32 v68, v68
    v_exp_f32 v69, v69
    v_mfma_f32_32x32x16_bf16 v[16:31], a[70:73], v[80:83], v[16:31]
    v_exp_f32 v70, v70
    v_exp_f32 v71, v71
    v_exp_f32 v72, v72
    v_exp_f32 v73, v73
    v_smfmac_f32_32x32x32_bf16 a[224:239], a[184:187], v[64:71], v5
    v_exp_f32 v74, v74
    v_exp_f32 v75, v75
    v_exp_f32 v76, v76
    v_exp_f32 v77, v77
    v_mfma_f32_32x32x16_bf16 v[32:47], a[74:77], v[80:83], v[32:47]
    v_exp_f32 v78, v78
    v_exp_f32 v79, v79
    s_cmp_lg_u32 s30, 0
    s_cbranch_scc1 L_noepoch
    s_mov_b32 s58, 8388608
    s_waitcnt vmcnt(0)
    s_branch L_adaLN_cond__grouped_kv_mqa__dense_activation_silu__prompt_kernel_pprepc_12
L_adaLN_cond__grouped_kv_mqa__dense_activation_silu__prompt_kernel_pprep_11:
    buffer_load_dwordx2 v[208:209], v10, s[36:39], s59 offen offset:0 sc1
    buffer_load_dwordx2 v[210:211], v10, s[36:39], s60 offen offset:0 sc1
    buffer_load_dwordx2 v[212:213], v10, s[36:39], s61 offen offset:0 sc1
    buffer_load_dwordx2 v[214:215], v10, s[36:39], s62 offen offset:0 sc1
    s_sub_u32 s58, s58, 1
    s_cbranch_scc1 L_adaLN_cond__grouped_kv_mqa__dense_activation_silu__prompt_kernel_pprepd_13
    s_waitcnt vmcnt(0)
L_adaLN_cond__grouped_kv_mqa__dense_activation_silu__prompt_kernel_pprepc_12:
    v_cmp_ne_u64 vcc, s[32:33], v[208:209]
    v_cmp_ne_u64 s[56:57], s[32:33], v[210:211]
    s_or_b64 vcc, vcc, s[56:57]
    v_cmp_ne_u64 s[56:57], s[32:33], v[212:213]
    s_or_b64 vcc, vcc, s[56:57]
    v_cmp_ne_u64 s[56:57], s[32:33], v[214:215]
    s_or_b64 vcc, vcc, s[56:57]
    s_cbranch_vccz L_adaLN_cond__grouped_kv_mqa__dense_activation_silu__prompt_kernel_pprepd_13
    s_sleep 1
    s_branch L_adaLN_cond__grouped_kv_mqa__dense_activation_silu__prompt_kernel_pprep_11
L_adaLN_cond__grouped_kv_mqa__dense_activation_silu__prompt_kernel_pprepd_13:
    s_cmp_lg_u32 s2, 0
    s_cbranch_scc1 L_noepoch
    s_mov_b32 s52, 0
    v_mov_b32 v208, s32
    v_mov_b32 v209, s33
    v_mov_b32 v210, 0
    s_mov_b64 exec, 1
    buffer_store_dwordx2 v[208:209], v210, s[36:39], s52 offen sc1
    s_mov_b64 exec, -1
L_noepoch:
    s_barrier
    v_exp_f32 v16, v16
    v_exp_f32 v17, v17
    v_smfmac_f32_32x32x32_bf16 a[224:239], a[188:191], v[72:79], v5
    v_exp_f32 v18, v18
    v_exp_f32 v19, v19
    v_exp_f32 v20, v20
    v_mfma_f32_32x32x4_2b_bf16 v[48:79], a[78:79], v[90:91], 0
    ds_read_b128 v[80:83], v7 offset:2560
    ds_read_b64 v[84:85], v8 offset:2560
    v_min_u32 v10, 7, v1
    v_lshlrev_b32 v10, 4, v10
    s_lshl_b32 s52, s28, 7
    s_add_u32 s52, s52, 442368
    buffer_load_dwordx4 v[208:211], v10, s[36:39], s52 offen sc1
    s_add_u32 m0, s71, 0
    s_add_u32 s52, s70, 0
    buffer_load_dwordx4 v4, s[36:39], s52 offen offset:0 sc1 lds
    buffer_load_dwordx4 v4, s[36:39], s52 offen offset:1024 sc1 lds
    buffer_load_dwordx4 v4, s[36:39], s52 offen offset:2048 sc1 lds
    buffer_load_dwordx4 v4, s[36:39], s52 offen offset:3072 sc1 lds
    v_exp_f32 v21, v21
    v_exp_f32 v22, v22
    v_exp_f32 v23, v23
    v_exp_f32 v24, v24
    v_exp_f32 v25, v25
    v_exp_f32 v26, v26
    v_exp_f32 v27, v27
    v_exp_f32 v28, v28
    s_waitcnt vmcnt(5)
    v_smfmac_f32_32x32x32_bf16 a[208:223], a[192:195], v[16:23], v5
    v_exp_f32 v29, v29
    v_exp_f32 v30, v30
    v_exp_f32 v31, v31
    v_exp_f32 v32, v32
    v_exp_f32 v33, v33
    v_smfmac_f32_32x32x32_bf16 a[208:223], a[196:199], v[24:31], v5
    v_exp_f32 v34, v34
    v_exp_f32 v35, v35
    v_exp_f32 v36, v36
    v_exp_f32 v37, v37
    v_mfma_f32_32x32x16_bf16 v[48:63], a[70:73], v[86:89], v[48:63]
    v_exp_f32 v38, v38
    v_exp_f32 v39, v39
    v_exp_f32 v40, v40
    v_exp_f32 v41, v41
    v_smfmac_f32_32x32x32_bf16 a[208:223], a[200:203], v[32:39], v5
    v_exp_f32 v42, v42
    v_exp_f32 v43, v43
    v_exp_f32 v44, v44
    v_exp_f32 v45, v45
    v_mfma_f32_32x32x16_bf16 v[64:79], a[74:77], v[86:89], v[64:79]
    v_exp_f32 v46, v46
    v_exp_f32 v47, v47
    s_waitcnt lgkmcnt(0)
    v_exp_f32 v48, v48
    v_exp_f32 v49, v49
    v_smfmac_f32_32x32x32_bf16 a[208:223], a[204:207], v[40:47], v5
    v_exp_f32 v50, v50
    v_exp_f32 v51, v51
    v_exp_f32 v52, v52
    v_mfma_f32_32x32x4_2b_bf16 v[16:47], a[8:9], v[84:85], 0
    ds_read_b128 v[86:89], v7 offset:3840
    ds_read_b64 v[90:91], v8 offset:3840
    s_add_u32 s52, s72, 0
    buffer_load_dwordx4 v[96:99], v4, s[36:39], s52 offen offset:0 sc1
    buffer_load_dwordx4 v[100:103], v4, s[36:39], s52 offen offset:1024 sc1
    buffer_load_dwordx4 v[104:107], v4, s[36:39], s52 offen offset:2048 sc1
    buffer_load_dwordx4 v[108:111], v4, s[36:39], s52 offen offset:3072 sc1
    s_mov_b32 s48, s22
    s_mov_b32 s49, s23
    s_mov_b32 s50, 0x4b0000
    s_mov_b32 s51, 0x00020000
    v_mul_u32_u24 v92, 13108, v1
    v_lshrrev_b32 v92, 16, v92
    v_mul_u32_u24 v93, 5, v92
    v_sub_u32 v93, v1, v93
    v_mul_u32_u24 v92, 7680, v92
    v_lshl_add_u32 v92, v93, 7, v92
    s_lshr_b32 s52, s2, 3
    s_lshl_b32 s52, s52, 2
    s_add_u32 s52, s52, s30
    s_mul_i32 s52, s52, 38400
    s_and_b32 s53, s2, 7
    s_mul_i32 s53, s53, 640
    s_add_u32 s52, s52, s53
    s_add_u32 s52, s52, 2560
    s_mov_b64 exec, 0x1ffffff
    buffer_load_dword v14, v92, s[48:51], s52 offen
    s_mov_b64 exec, -1
    v_exp_f32 v53, v53
    v_exp_f32 v54, v54
    v_exp_f32 v55, v55
    v_exp_f32 v56, v56
    v_exp_f32 v57, v57
    v_exp_f32 v58, v58
    v_exp_f32 v59, v59
    v_exp_f32 v60, v60
    v_smfmac_f32_32x32x32_bf16 a[224:239], a[192:195], v[48:55], v5
    v_exp_f32 v61, v61
    v_exp_f32 v62, v62
    v_exp_f32 v63, v63
    v_exp_f32 v64, v64
    v_exp_f32 v65, v65
    ds_write_b128 v6, a[208:211] offset:0
    ds_write_b128 v6, a[212:215] offset:1024
    ds_write_b128 v6, a[216:219] offset:2048
    v_smfmac_f32_32x32x32_bf16 a[224:239], a[196:199], v[56:63], v5
    v_exp_f32 v66, v66
    v_exp_f32 v67, v67
    v_exp_f32 v68, v68
    v_exp_f32 v69, v69
    v_mfma_f32_32x32x16_bf16 v[16:31], a[0:3], v[80:83], v[16:31]
    v_exp_f32 v70, v70
    v_exp_f32 v71, v71
    v_exp_f32 v72, v72
    v_exp_f32 v73, v73
    v_smfmac_f32_32x32x32_bf16 a[224:239], a[200:203], v[64:71], v5
    v_exp_f32 v74, v74
    v_exp_f32 v75, v75
    v_mfma_f32_32x32x8_bf16 a[208:223], a[252:253], a[252:253], 0
    v_exp_f32 v76, v76
    v_exp_f32 v77, v77
    v_mfma_f32_32x32x16_bf16 v[32:47], a[4:7], v[80:83], v[32:47]
    v_exp_f32 v78, v78
    v_exp_f32 v79, v79
    s_waitcnt lgkmcnt(3)
    v_exp_f32 v16, v16
    v_exp_f32 v17, v17
    v_smfmac_f32_32x32x32_bf16 a[224:239], a[204:207], v[72:79], v5
    v_exp_f32 v18, v18
    v_exp_f32 v19, v19
    v_exp_f32 v20, v20
    v_mfma_f32_32x32x4_2b_bf16 v[48:79], a[8:9], v[90:91], 0
    s_add_u32 m0, s71, 4096
    s_add_u32 s52, s70, 4096
    buffer_load_dwordx4 v4, s[36:39], s52 offen offset:0 sc1 lds
    buffer_load_dwordx4 v4, s[36:39], s52 offen offset:1024 sc1 lds
    buffer_load_dwordx4 v4, s[36:39], s52 offen offset:2048 sc1 lds
    buffer_load_dwordx4 v4, s[36:39], s52 offen offset:3072 sc1 lds
    v_exp_f32 v21, v21
    v_exp_f32 v22, v22
    v_exp_f32 v23, v23
    v_exp_f32 v24, v24
    v_exp_f32 v25, v25
    v_exp_f32 v26, v26
    v_exp_f32 v27, v27
    v_exp_f32 v28, v28
    v_smfmac_f32_32x32x32_bf16 a[208:223], a[80:83], v[16:23], v5
    v_exp_f32 v29, v29
    v_exp_f32 v30, v30
    v_exp_f32 v31, v31
    v_exp_f32 v32, v32
    v_exp_f32 v33, v33
    ds_write_b128 v6, a[224:227] offset:3072
    ds_write_b128 v6, a[228:231] offset:4096
    ds_write_b128 v6, a[232:235] offset:5120
    v_smfmac_f32_32x32x32_bf16 a[208:223], a[84:87], v[24:31], v5
    v_exp_f32 v34, v34
    v_exp_f32 v35, v35
    v_exp_f32 v36, v36
    v_exp_f32 v37, v37
    v_mfma_f32_32x32x16_bf16 v[48:63], a[0:3], v[86:89], v[48:63]
    v_exp_f32 v38, v38
    v_exp_f32 v39, v39
    v_exp_f32 v40, v40
    v_exp_f32 v41, v41
    v_smfmac_f32_32x32x32_bf16 a[208:223], a[88:91], v[32:39], v5
    v_exp_f32 v42, v42
    v_exp_f32 v43, v43
    v_mfma_f32_32x32x8_bf16 a[224:239], a[252:253], a[252:253], 0
    v_exp_f32 v44, v44
    v_exp_f32 v45, v45
    v_mfma_f32_32x32x16_bf16 v[64:79], a[4:7], v[86:89], v[64:79]
    v_exp_f32 v46, v46
    v_exp_f32 v47, v47
    v_exp_f32 v48, v48
    v_exp_f32 v49, v49
    v_smfmac_f32_32x32x32_bf16 a[208:223], a[92:95], v[40:47], v5
    v_exp_f32 v50, v50
    v_exp_f32 v51, v51
    v_exp_f32 v52, v52
    v_mfma_f32_32x32x4_2b_bf16 v[16:47], a[18:19], v[84:85], 0
    s_waitcnt vmcnt(13)
    s_getreg_b32 s52, hwreg(HW_REG_XCC_ID)
    v_cmp_eq_u64 vcc, s[32:33], v[208:209]
    v_cmp_eq_u32 s[54:55], s52, v210
    s_and_b64 vcc, vcc, s[54:55]
    s_cmp_eq_u64 vcc, -1
    s_cselect_b32 s92, 1, 0
    v_exp_f32 v53, v53
    v_exp_f32 v54, v54
    v_exp_f32 v55, v55
    v_exp_f32 v56, v56
    v_exp_f32 v57, v57
    v_exp_f32 v58, v58
    v_exp_f32 v59, v59
    v_exp_f32 v60, v60
    v_smfmac_f32_32x32x32_bf16 a[224:239], a[80:83], v[48:55], v5
    v_exp_f32 v61, v61
    v_exp_f32 v62, v62
    v_exp_f32 v63, v63
    v_exp_f32 v64, v64
    v_exp_f32 v65, v65
    v_smfmac_f32_32x32x32_bf16 a[224:239], a[84:87], v[56:63], v5
    v_exp_f32 v66, v66
    v_exp_f32 v67, v67
    v_exp_f32 v68, v68
    v_exp_f32 v69, v69
    v_mfma_f32_32x32x16_bf16 v[16:31], a[10:13], v[80:83], v[16:31]
    v_exp_f32 v70, v70
    v_exp_f32 v71, v71
    v_exp_f32 v72, v72
    v_exp_f32 v73, v73
    v_smfmac_f32_32x32x32_bf16 a[224:239], a[88:91], v[64:71], v5
    v_exp_f32 v74, v74
    v_exp_f32 v75, v75
    v_exp_f32 v76, v76
    v_exp_f32 v77, v77
    v_mfma_f32_32x32x16_bf16 v[32:47], a[14:17], v[80:83], v[32:47]
    v_exp_f32 v78, v78
    v_exp_f32 v79, v79
    v_exp_f32 v16, v16
    v_exp_f32 v17, v17
    v_smfmac_f32_32x32x32_bf16 a[224:239], a[92:95], v[72:79], v5
    v_exp_f32 v18, v18
    v_exp_f32 v19, v19
    v_exp_f32 v20, v20
    v_mfma_f32_32x32x4_2b_bf16 v[48:79], a[18:19], v[90:91], 0
    s_add_u32 s52, s72, 4096
    buffer_load_dwordx4 v[112:115], v4, s[36:39], s52 offen offset:0 sc1
    buffer_load_dwordx4 v[116:119], v4, s[36:39], s52 offen offset:1024 sc1
    buffer_load_dwordx4 v[120:123], v4, s[36:39], s52 offen offset:2048 sc1
    buffer_load_dwordx4 v[124:127], v4, s[36:39], s52 offen offset:3072 sc1
    s_add_u32 s52, s78, 1048576
    s_mov_b64 exec, 0x3ff
    buffer_load_dword v14, v11, s[36:39], s52 offen
    s_mov_b64 exec, -1
    v_exp_f32 v21, v21
    v_exp_f32 v22, v22
    v_exp_f32 v23, v23
    v_exp_f32 v24, v24
    v_exp_f32 v25, v25
    v_exp_f32 v26, v26
    v_exp_f32 v27, v27
    v_exp_f32 v28, v28
    v_smfmac_f32_32x32x32_bf16 a[208:223], a[96:99], v[16:23], v5
    v_exp_f32 v29, v29
    v_exp_f32 v30, v30
    v_exp_f32 v31, v31
    v_exp_f32 v32, v32
    v_exp_f32 v33, v33
    v_smfmac_f32_32x32x32_bf16 a[208:223], a[100:103], v[24:31], v5
    v_exp_f32 v34, v34
    v_exp_f32 v35, v35
    v_exp_f32 v36, v36
    v_exp_f32 v37, v37
    v_mfma_f32_32x32x16_bf16 v[48:63], a[10:13], v[86:89], v[48:63]
    v_exp_f32 v38, v38
    v_exp_f32 v39, v39
    v_exp_f32 v40, v40
    v_exp_f32 v41, v41
    v_smfmac_f32_32x32x32_bf16 a[208:223], a[104:107], v[32:39], v5
    v_exp_f32 v42, v42
    v_exp_f32 v43, v43
    v_exp_f32 v44, v44
    v_exp_f32 v45, v45
    v_mfma_f32_32x32x16_bf16 v[64:79], a[14:17], v[86:89], v[64:79]
    v_exp_f32 v46, v46
    v_exp_f32 v47, v47
    v_exp_f32 v48, v48
    v_exp_f32 v49, v49
    v_smfmac_f32_32x32x32_bf16 a[208:223], a[108:111], v[40:47], v5
    v_exp_f32 v50, v50
    v_exp_f32 v51, v51
    v_exp_f32 v52, v52
    v_mfma_f32_32x32x4_2b_bf16 v[16:47], a[28:29], v[84:85], 0
    s_add_u32 m0, s71, 8192
    s_add_u32 s52, s70, 8192
    buffer_load_dwordx4 v4, s[36:39], s52 offen offset:0 sc1 lds
    buffer_load_dwordx4 v4, s[36:39], s52 offen offset:1024 sc1 lds
    buffer_load_dwordx4 v4, s[36:39], s52 offen offset:2048 sc1 lds
    buffer_load_dwordx4 v4, s[36:39], s52 offen offset:3072 sc1 lds
    v_exp_f32 v53, v53
    v_exp_f32 v54, v54
    v_exp_f32 v55, v55
    v_exp_f32 v56, v56
    v_exp_f32 v57, v57
    v_exp_f32 v58, v58
    v_exp_f32 v59, v59
    v_exp_f32 v60, v60
    v_smfmac_f32_32x32x32_bf16 a[224:239], a[96:99], v[48:55], v5
    v_exp_f32 v61, v61
    v_exp_f32 v62, v62
    v_exp_f32 v63, v63
    v_exp_f32 v64, v64
    v_exp_f32 v65, v65
    v_smfmac_f32_32x32x32_bf16 a[224:239], a[100:103], v[56:63], v5
    v_exp_f32 v66, v66
    v_exp_f32 v67, v67
    v_exp_f32 v68, v68
    v_exp_f32 v69, v69
    v_mfma_f32_32x32x16_bf16 v[16:31], a[20:23], v[80:83], v[16:31]
    v_exp_f32 v70, v70
    v_exp_f32 v71, v71
    v_exp_f32 v72, v72
    v_exp_f32 v73, v73
    v_smfmac_f32_32x32x32_bf16 a[224:239], a[104:107], v[64:71], v5
    v_exp_f32 v74, v74
    v_exp_f32 v75, v75
    v_exp_f32 v76, v76
    v_exp_f32 v77, v77
    v_mfma_f32_32x32x16_bf16 v[32:47], a[24:27], v[80:83], v[32:47]
    v_exp_f32 v78, v78
    v_exp_f32 v79, v79
    v_exp_f32 v16, v16
    v_exp_f32 v17, v17
    v_smfmac_f32_32x32x32_bf16 a[224:239], a[108:111], v[72:79], v5
    v_exp_f32 v18, v18
    v_exp_f32 v19, v19
    v_exp_f32 v20, v20
    v_mfma_f32_32x32x4_2b_bf16 v[48:79], a[28:29], v[90:91], 0
    v_exp_f32 v21, v21
    v_exp_f32 v22, v22
    v_exp_f32 v23, v23
    v_exp_f32 v24, v24
    v_exp_f32 v25, v25
    v_exp_f32 v26, v26
    v_exp_f32 v27, v27
    v_exp_f32 v28, v28
    v_smfmac_f32_32x32x32_bf16 a[208:223], a[112:115], v[16:23], v5
    v_exp_f32 v29, v29
    v_exp_f32 v30, v30
    v_exp_f32 v31, v31
    v_exp_f32 v32, v32
    v_exp_f32 v33, v33
    v_smfmac_f32_32x32x32_bf16 a[208:223], a[116:119], v[24:31], v5
    v_exp_f32 v34, v34
    v_exp_f32 v35, v35
    v_exp_f32 v36, v36
    v_exp_f32 v37, v37
    v_mfma_f32_32x32x16_bf16 v[48:63], a[20:23], v[86:89], v[48:63]
    v_exp_f32 v38, v38
    v_exp_f32 v39, v39
    v_exp_f32 v40, v40
    v_exp_f32 v41, v41
    v_smfmac_f32_32x32x32_bf16 a[208:223], a[120:123], v[32:39], v5
    v_exp_f32 v42, v42
    v_exp_f32 v43, v43
    v_exp_f32 v44, v44
    v_exp_f32 v45, v45
    v_mfma_f32_32x32x16_bf16 v[64:79], a[24:27], v[86:89], v[64:79]
    v_exp_f32 v46, v46
    v_exp_f32 v47, v47
    v_exp_f32 v48, v48
    v_exp_f32 v49, v49
    v_smfmac_f32_32x32x32_bf16 a[208:223], a[124:127], v[40:47], v5
    v_exp_f32 v50, v50
    v_exp_f32 v51, v51
    v_exp_f32 v52, v52
    v_mfma_f32_32x32x4_2b_bf16 v[16:47], a[38:39], v[84:85], 0
    s_add_u32 s52, s72, 8192
    buffer_load_dwordx4 v[128:131], v4, s[36:39], s52 offen offset:0 sc1
    buffer_load_dwordx4 v[132:135], v4, s[36:39], s52 offen offset:1024 sc1
    buffer_load_dwordx4 v[136:139], v4, s[36:39], s52 offen offset:2048 sc1
    buffer_load_dwordx4 v[140:143], v4, s[36:39], s52 offen offset:3072 sc1
    s_cmp_eq_u32 s90, 0
    s_cbranch_scc1 L_adaLN_cond__grouped_kv_mqa__dense_activation_silu__prompt_kernel_nomb_14
    s_mov_b32 s48, s22
    s_mov_b32 s49, s23
    s_mov_b32 s50, 0x4b0000
    s_mov_b32 s51, 0x00020000
    v_lshrrev_b32 v92, 1, v1
    v_and_b32 v93, 0x13, v92
    v_lshlrev_b32 v9, 1, v92
    v_and_or_b32 v93, v9, 8, v93
    v_lshrrev_b32 v9, 1, v92
    v_and_or_b32 v93, v9, 4, v93
    v_mul_u32_u24 v93, 7680, v93
    v_and_b32 v92, 1, v1
    v_lshl_add_u32 v93, v92, 4, v93
    s_mul_i32 s88, s30, 1228800
    s_lshl_b32 s89, s34, 5
    s_add_u32 s88, s88, s89
    s_mul_i32 s89, s30, 25600
L_adaLN_cond__grouped_kv_mqa__dense_activation_silu__prompt_kernel_nomb_14:
    v_exp_f32 v53, v53
    v_exp_f32 v54, v54
    v_exp_f32 v55, v55
    v_exp_f32 v56, v56
    v_exp_f32 v57, v57
    v_exp_f32 v58, v58
    v_exp_f32 v59, v59
    v_exp_f32 v60, v60
    v_smfmac_f32_32x32x32_bf16 a[224:239], a[112:115], v[48:55], v5
    v_exp_f32 v61, v61
    v_exp_f32 v62, v62
    v_exp_f32 v63, v63
    v_exp_f32 v64, v64
    v_exp_f32 v65, v65
    v_smfmac_f32_32x32x32_bf16 a[224:239], a[116:119], v[56:63], v5
    v_exp_f32 v66, v66
    v_exp_f32 v67, v67
    v_exp_f32 v68, v68
    v_exp_f32 v69, v69
    v_mfma_f32_32x32x16_bf16 v[16:31], a[30:33], v[80:83], v[16:31]
    v_exp_f32 v70, v70
    v_exp_f32 v71, v71
    v_exp_f32 v72, v72
    v_exp_f32 v73, v73
    v_smfmac_f32_32x32x32_bf16 a[224:239], a[120:123], v[64:71], v5
    v_exp_f32 v74, v74
    v_exp_f32 v75, v75
    v_exp_f32 v76, v76
    v_exp_f32 v77, v77
    v_mfma_f32_32x32x16_bf16 v[32:47], a[34:37], v[80:83], v[32:47]
    v_exp_f32 v78, v78
    v_exp_f32 v79, v79
    v_exp_f32 v16, v16
    v_exp_f32 v17, v17
    v_smfmac_f32_32x32x32_bf16 a[224:239], a[124:127], v[72:79], v5
    v_exp_f32 v18, v18
    v_exp_f32 v19, v19
    v_exp_f32 v20, v20
    v_mfma_f32_32x32x4_2b_bf16 v[48:79], a[38:39], v[90:91], 0
    s_add_u32 m0, s71, 12288
    s_add_u32 s52, s70, 12288
    buffer_load_dwordx4 v4, s[36:39], s52 offen offset:0 sc1 lds
    buffer_load_dwordx4 v4, s[36:39], s52 offen offset:1024 sc1 lds
    buffer_load_dwordx4 v4, s[36:39], s52 offen offset:2048 sc1 lds
    buffer_load_dwordx4 v4, s[36:39], s52 offen offset:3072 sc1 lds
    s_cmp_eq_u32 s90, 0
    s_cbranch_scc1 L_adaLN_cond__grouped_kv_mqa__dense_activation_silu__prompt_kernel_nomb_15
    s_add_u32 m0, s89, 20480
    s_add_u32 s52, s88, 0
    buffer_load_dwordx4 v93, s[48:51], s52 offen lds
L_adaLN_cond__grouped_kv_mqa__dense_activation_silu__prompt_kernel_nomb_15:
    v_exp_f32 v21, v21
    v_exp_f32 v22, v22
    v_exp_f32 v23, v23
    v_exp_f32 v24, v24
    v_exp_f32 v25, v25
    v_exp_f32 v26, v26
    v_exp_f32 v27, v27
    v_exp_f32 v28, v28
    v_smfmac_f32_32x32x32_bf16 a[208:223], a[128:131], v[16:23], v5
    v_exp_f32 v29, v29
    v_exp_f32 v30, v30
    v_exp_f32 v31, v31
    v_exp_f32 v32, v32
    v_exp_f32 v33, v33
    v_smfmac_f32_32x32x32_bf16 a[208:223], a[132:135], v[24:31], v5
    v_exp_f32 v34, v34
    v_exp_f32 v35, v35
    v_exp_f32 v36, v36
    v_exp_f32 v37, v37
    v_mfma_f32_32x32x16_bf16 v[48:63], a[30:33], v[86:89], v[48:63]
    v_exp_f32 v38, v38
    v_exp_f32 v39, v39
    v_exp_f32 v40, v40
    v_exp_f32 v41, v41
    v_smfmac_f32_32x32x32_bf16 a[208:223], a[136:139], v[32:39], v5
    v_exp_f32 v42, v42
    v_exp_f32 v43, v43
    v_exp_f32 v44, v44
    v_exp_f32 v45, v45
    v_mfma_f32_32x32x16_bf16 v[64:79], a[34:37], v[86:89], v[64:79]
    v_exp_f32 v46, v46
    v_exp_f32 v47, v47
    v_exp_f32 v48, v48
    v_exp_f32 v49, v49
    v_smfmac_f32_32x32x32_bf16 a[208:223], a[140:143], v[40:47], v5
    v_exp_f32 v50, v50
    v_exp_f32 v51, v51
    v_exp_f32 v52, v52
    v_mfma_f32_32x32x4_2b_bf16 v[16:47], a[48:49], v[84:85], 0
    s_cmp_eq_u32 s90, 0
    s_cbranch_scc1 L_adaLN_cond__grouped_kv_mqa__dense_activation_silu__prompt_kernel_nomb_16
    s_add_u32 m0, s89, 21504
    s_add_u32 s52, s88, 245760
    buffer_load_dwordx4 v93, s[48:51], s52 offen lds
L_adaLN_cond__grouped_kv_mqa__dense_activation_silu__prompt_kernel_nomb_16:
    v_exp_f32 v53, v53
    v_exp_f32 v54, v54
    v_exp_f32 v55, v55
    v_exp_f32 v56, v56
    v_exp_f32 v57, v57
    v_exp_f32 v58, v58
    v_exp_f32 v59, v59
    v_exp_f32 v60, v60
    v_smfmac_f32_32x32x32_bf16 a[224:239], a[128:131], v[48:55], v5
    v_exp_f32 v61, v61
    v_exp_f32 v62, v62
    v_exp_f32 v63, v63
    v_exp_f32 v64, v64
    v_exp_f32 v65, v65
    v_smfmac_f32_32x32x32_bf16 a[224:239], a[132:135], v[56:63], v5
    v_exp_f32 v66, v66
    v_exp_f32 v67, v67
    v_exp_f32 v68, v68
    v_exp_f32 v69, v69
    v_mfma_f32_32x32x16_bf16 v[16:31], a[40:43], v[80:83], v[16:31]
    v_exp_f32 v70, v70
    v_exp_f32 v71, v71
    v_exp_f32 v72, v72
    v_exp_f32 v73, v73
    v_smfmac_f32_32x32x32_bf16 a[224:239], a[136:139], v[64:71], v5
    v_exp_f32 v74, v74
    v_exp_f32 v75, v75
    v_exp_f32 v76, v76
    v_exp_f32 v77, v77
    v_mfma_f32_32x32x16_bf16 v[32:47], a[44:47], v[80:83], v[32:47]
    v_exp_f32 v78, v78
    v_exp_f32 v79, v79
    s_waitcnt vmcnt(32)
    v_exp_f32 v16, v16
    v_exp_f32 v17, v17
    v_smfmac_f32_32x32x32_bf16 a[224:239], a[140:143], v[72:79], v5
    v_exp_f32 v18, v18
    v_exp_f32 v19, v19
    v_exp_f32 v20, v20
    v_mfma_f32_32x32x4_2b_bf16 v[48:79], a[48:49], v[90:91], 0
    s_add_u32 s52, s72, 12288
    buffer_load_dwordx4 v[144:147], v4, s[36:39], s52 offen offset:0 sc1
    buffer_load_dwordx4 v[148:151], v4, s[36:39], s52 offen offset:1024 sc1
    buffer_load_dwordx4 v[152:155], v4, s[36:39], s52 offen offset:2048 sc1
    buffer_load_dwordx4 v[156:159], v4, s[36:39], s52 offen offset:3072 sc1
    s_cmp_eq_u32 s90, 0
    s_cbranch_scc1 L_adaLN_cond__grouped_kv_mqa__dense_activation_silu__prompt_kernel_nomb_17
    s_add_u32 m0, s89, 22528
    s_add_u32 s52, s88, 491520
    buffer_load_dwordx4 v93, s[48:51], s52 offen lds
L_adaLN_cond__grouped_kv_mqa__dense_activation_silu__prompt_kernel_nomb_17:
    v_exp_f32 v21, v21
    v_exp_f32 v22, v22
    v_exp_f32 v23, v23
    v_exp_f32 v24, v24
    v_exp_f32 v25, v25
    v_exp_f32 v26, v26
    v_exp_f32 v27, v27
    v_exp_f32 v28, v28
    v_smfmac_f32_32x32x32_bf16 a[208:223], a[144:147], v[16:23], v5
    v_exp_f32 v29, v29
    v_exp_f32 v30, v30
    v_exp_f32 v31, v31
    v_exp_f32 v32, v32
    v_exp_f32 v33, v33
    v_smfmac_f32_32x32x32_bf16 a[208:223], a[148:151], v[24:31], v5
    v_exp_f32 v34, v34
    v_exp_f32 v35, v35
    v_exp_f32 v36, v36
    v_exp_f32 v37, v37
    v_mfma_f32_32x32x16_bf16 v[48:63], a[40:43], v[86:89], v[48:63]
    v_exp_f32 v38, v38
    v_exp_f32 v39, v39
    v_exp_f32 v40, v40
    v_exp_f32 v41, v41
    v_smfmac_f32_32x32x32_bf16 a[208:223], a[152:155], v[32:39], v5
    v_exp_f32 v42, v42
    v_exp_f32 v43, v43
    v_exp_f32 v44, v44
    v_exp_f32 v45, v45
    v_mfma_f32_32x32x16_bf16 v[64:79], a[44:47], v[86:89], v[64:79]
    v_exp_f32 v46, v46
    v_exp_f32 v47, v47
    v_exp_f32 v48, v48
    v_exp_f32 v49, v49
    v_smfmac_f32_32x32x32_bf16 a[208:223], a[156:159], v[40:47], v5
    v_exp_f32 v50, v50
    v_exp_f32 v51, v51
    v_exp_f32 v52, v52
    v_mfma_f32_32x32x4_2b_bf16 v[16:47], a[58:59], v[84:85], 0
    s_add_u32 m0, s71, 16384
    s_add_u32 s52, s70, 16384
    buffer_load_dwordx4 v4, s[36:39], s52 offen offset:0 sc1 lds
    buffer_load_dwordx4 v4, s[36:39], s52 offen offset:1024 sc1 lds
    buffer_load_dwordx4 v4, s[36:39], s52 offen offset:2048 sc1 lds
    buffer_load_dwordx4 v4, s[36:39], s52 offen offset:3072 sc1 lds
    s_cmp_eq_u32 s90, 0
    s_cbranch_scc1 L_adaLN_cond__grouped_kv_mqa__dense_activation_silu__prompt_kernel_nomb_18
    s_add_u32 m0, s89, 23552
    s_add_u32 s52, s88, 737280
    buffer_load_dwordx4 v93, s[48:51], s52 offen lds
L_adaLN_cond__grouped_kv_mqa__dense_activation_silu__prompt_kernel_nomb_18:
    v_exp_f32 v53, v53
    v_exp_f32 v54, v54
    v_exp_f32 v55, v55
    v_exp_f32 v56, v56
    v_exp_f32 v57, v57
    v_exp_f32 v58, v58
    v_exp_f32 v59, v59
    v_exp_f32 v60, v60
    v_smfmac_f32_32x32x32_bf16 a[224:239], a[144:147], v[48:55], v5
    v_exp_f32 v61, v61
    v_exp_f32 v62, v62
    v_exp_f32 v63, v63
    v_exp_f32 v64, v64
    v_exp_f32 v65, v65
    v_smfmac_f32_32x32x32_bf16 a[224:239], a[148:151], v[56:63], v5
    v_exp_f32 v66, v66
    v_exp_f32 v67, v67
    v_exp_f32 v68, v68
    v_exp_f32 v69, v69
    v_mfma_f32_32x32x16_bf16 v[16:31], a[50:53], v[80:83], v[16:31]
    v_exp_f32 v70, v70
    v_exp_f32 v71, v71
    v_exp_f32 v72, v72
    v_exp_f32 v73, v73
    v_smfmac_f32_32x32x32_bf16 a[224:239], a[152:155], v[64:71], v5
    v_exp_f32 v74, v74
    v_exp_f32 v75, v75
    v_exp_f32 v76, v76
    v_exp_f32 v77, v77
    v_mfma_f32_32x32x16_bf16 v[32:47], a[54:57], v[80:83], v[32:47]
    v_exp_f32 v78, v78
    v_exp_f32 v79, v79
    v_exp_f32 v16, v16
    v_exp_f32 v17, v17
    v_smfmac_f32_32x32x32_bf16 a[224:239], a[156:159], v[72:79], v5
    v_exp_f32 v18, v18
    v_exp_f32 v19, v19
    v_exp_f32 v20, v20
    v_mfma_f32_32x32x4_2b_bf16 v[48:79], a[58:59], v[90:91], 0
    s_cmp_eq_u32 s90, 0
    s_cbranch_scc1 L_adaLN_cond__grouped_kv_mqa__dense_activation_silu__prompt_kernel_nomb_19
    s_add_u32 m0, s89, 24576
    s_add_u32 s52, s88, 983040
    buffer_load_dwordx4 v93, s[48:51], s52 offen lds
L_adaLN_cond__grouped_kv_mqa__dense_activation_silu__prompt_kernel_nomb_19:
    v_exp_f32 v21, v21
    v_exp_f32 v22, v22
    v_exp_f32 v23, v23
    v_exp_f32 v24, v24
    v_exp_f32 v25, v25
    v_exp_f32 v26, v26
    v_exp_f32 v27, v27
    v_exp_f32 v28, v28
    v_smfmac_f32_32x32x32_bf16 a[208:223], a[160:163], v[16:23], v5
    v_exp_f32 v29, v29
    v_exp_f32 v30, v30
    v_exp_f32 v31, v31
    v_exp_f32 v32, v32
    v_exp_f32 v33, v33
    v_smfmac_f32_32x32x32_bf16 a[208:223], a[164:167], v[24:31], v5
    v_exp_f32 v34, v34
    v_exp_f32 v35, v35
    v_exp_f32 v36, v36
    v_exp_f32 v37, v37
    v_mfma_f32_32x32x16_bf16 v[48:63], a[50:53], v[86:89], v[48:63]
    v_exp_f32 v38, v38
    v_exp_f32 v39, v39
    v_exp_f32 v40, v40
    v_exp_f32 v41, v41
    v_smfmac_f32_32x32x32_bf16 a[208:223], a[168:171], v[32:39], v5
    v_exp_f32 v42, v42
    v_exp_f32 v43, v43
    v_exp_f32 v44, v44
    v_exp_f32 v45, v45
    v_mfma_f32_32x32x16_bf16 v[64:79], a[54:57], v[86:89], v[64:79]
    v_exp_f32 v46, v46
    v_exp_f32 v47, v47
    v_exp_f32 v48, v48
    v_exp_f32 v49, v49
    v_smfmac_f32_32x32x32_bf16 a[208:223], a[172:175], v[40:47], v5
    v_exp_f32 v50, v50
    v_exp_f32 v51, v51
    v_exp_f32 v52, v52
    v_mfma_f32_32x32x4_2b_bf16 v[16:47], a[68:69], v[84:85], 0
    s_cmp_eq_u32 s90, 0
    s_cbranch_scc1 L_adaLN_cond__grouped_kv_mqa__dense_activation_silu__prompt_kernel_nomb_20
    s_mul_i32 s52, s30, 320
    s_add_u32 s52, s52, 151552
    v_lshlrev_b32 v252, 3, v1
    v_add_u32 v252, s52, v252
    s_mov_b32 exec_hi, 0xff
    ds_write_b64 v252, a[254:255]
    s_mov_b32 exec_hi, -1
    s_mul_i32 s52, s30, 320
    s_add_u32 s52, s52, 151552
    v_lshlrev_b32 v253, 4, v3
    v_add_u32 v252, s52, v253
    ds_read_b128 v[208:211], v252 offset:0
    ds_read_b128 v[212:215], v252 offset:64
    ds_read_b128 v[216:219], v252 offset:128
    ds_read_b128 v[220:223], v252 offset:192
    ds_read_b128 v[224:227], v252 offset:256
    v_lshrrev_b32 v254, 1, v3
    v_lshlrev_b32 v254, 4, v254
    v_and_b32 v255, 1, v3
    v_lshl_add_u32 v254, v255, 2, v254
    v_bfe_u32 v255, v1, 2, 2
    v_add_u32 v254, v254, v255
    v_lshlrev_b32 v254, 5, v254
    v_and_b32 v255, 3, v1
    v_lshl_add_u32 v252, v255, 3, v254
    s_mul_i32 s52, s30, 25600
    s_add_u32 s52, s52, 20480
    v_add_u32 v252, s52, v252
    s_lshl_b32 s52, s30, 6
    s_add_u32 s52, s52, 152832
    v_add_u32 v255, s52, v253
L_adaLN_cond__grouped_kv_mqa__dense_activation_silu__prompt_kernel_nomb_20:
    v_exp_f32 v53, v53
    v_exp_f32 v54, v54
    v_exp_f32 v55, v55
    v_exp_f32 v56, v56
    v_exp_f32 v57, v57
    v_exp_f32 v58, v58
    v_exp_f32 v59, v59
    v_exp_f32 v60, v60
    v_smfmac_f32_32x32x32_bf16 a[224:239], a[160:163], v[48:55], v5
    v_exp_f32 v61, v61
    v_exp_f32 v62, v62
    v_exp_f32 v63, v63
    v_exp_f32 v64, v64
    v_exp_f32 v65, v65
    v_smfmac_f32_32x32x32_bf16 a[224:239], a[164:167], v[56:63], v5
    v_exp_f32 v66, v66
    v_exp_f32 v67, v67
    v_exp_f32 v68, v68
    v_exp_f32 v69, v69
    v_mfma_f32_32x32x16_bf16 v[16:31], a[60:63], v[80:83], v[16:31]
    v_exp_f32 v70, v70
    v_exp_f32 v71, v71
    v_exp_f32 v72, v72
    v_exp_f32 v73, v73
    v_smfmac_f32_32x32x32_bf16 a[224:239], a[168:171], v[64:71], v5
    v_exp_f32 v74, v74
    v_exp_f32 v75, v75
    v_exp_f32 v76, v76
    v_exp_f32 v77, v77
    v_mfma_f32_32x32x16_bf16 v[32:47], a[64:67], v[80:83], v[32:47]
    v_exp_f32 v78, v78
    v_exp_f32 v79, v79
    v_exp_f32 v16, v16
    v_exp_f32 v17, v17
    v_smfmac_f32_32x32x32_bf16 a[224:239], a[172:175], v[72:79], v5
    v_exp_f32 v18, v18
    v_exp_f32 v19, v19
    v_exp_f32 v20, v20
    v_mfma_f32_32x32x4_2b_bf16 v[48:79], a[68:69], v[90:91], 0
    s_cmp_eq_u32 s90, 0
    s_cbranch_scc1 L_adaLN_cond__grouped_kv_mqa__dense_activation_silu__prompt_kernel_nomb_21
    s_waitcnt vmcnt(0)
    s_waitcnt lgkmcnt(0)
    ds_read_b64_tr_b16 v[228:229], v252 offset:0
    ds_read_b64_tr_b16 v[230:231], v252 offset:256
    ds_read_b64_tr_b16 v[232:233], v252 offset:1024
    ds_read_b64_tr_b16 v[234:235], v252 offset:1280
    ds_read_b64_tr_b16 v[236:237], v252 offset:2048
    ds_read_b64_tr_b16 v[238:239], v252 offset:2304
    ds_read_b64_tr_b16 v[240:241], v252 offset:3072
    ds_read_b64_tr_b16 v[242:243], v252 offset:3328
    ds_read_b64_tr_b16 v[244:245], v252 offset:4096
    ds_read_b64_tr_b16 v[246:247], v252 offset:4352
L_adaLN_cond__grouped_kv_mqa__dense_activation_silu__prompt_kernel_nomb_21:
    v_exp_f32 v21, v21
    v_exp_f32 v22, v22
    v_exp_f32 v23, v23
    v_exp_f32 v24, v24
    v_exp_f32 v25, v25
    v_exp_f32 v26, v26
    v_exp_f32 v27, v27
    v_exp_f32 v28, v28
    v_smfmac_f32_32x32x32_bf16 a[208:223], a[176:179], v[16:23], v5
    v_exp_f32 v29, v29
    v_exp_f32 v30, v30
    v_exp_f32 v31, v31
    v_exp_f32 v32, v32
    v_exp_f32 v33, v33
    v_smfmac_f32_32x32x32_bf16 a[208:223], a[180:183], v[24:31], v5
    v_exp_f32 v34, v34
    v_exp_f32 v35, v35
    v_exp_f32 v36, v36
    v_exp_f32 v37, v37
    v_mfma_f32_32x32x16_bf16 v[48:63], a[60:63], v[86:89], v[48:63]
    v_exp_f32 v38, v38
    v_exp_f32 v39, v39
    v_exp_f32 v40, v40
    v_exp_f32 v41, v41
    v_smfmac_f32_32x32x32_bf16 a[208:223], a[184:187], v[32:39], v5
    v_exp_f32 v42, v42
    v_exp_f32 v43, v43
    v_exp_f32 v44, v44
    v_exp_f32 v45, v45
    v_mfma_f32_32x32x16_bf16 v[64:79], a[64:67], v[86:89], v[64:79]
    v_exp_f32 v46, v46
    v_exp_f32 v47, v47
    v_exp_f32 v48, v48
    v_exp_f32 v49, v49
    v_smfmac_f32_32x32x32_bf16 a[208:223], a[188:191], v[40:47], v5
    v_exp_f32 v50, v50
    v_exp_f32 v51, v51
    v_exp_f32 v52, v52
    v_mfma_f32_32x32x4_2b_bf16 v[16:47], a[78:79], v[84:85], 0
    s_add_u32 s52, s72, 16384
    buffer_load_dwordx4 v[160:163], v4, s[36:39], s52 offen offset:0 sc1
    buffer_load_dwordx4 v[164:167], v4, s[36:39], s52 offen offset:1024 sc1
    buffer_load_dwordx4 v[168:171], v4, s[36:39], s52 offen offset:2048 sc1
    buffer_load_dwordx4 v[172:175], v4, s[36:39], s52 offen offset:3072 sc1
    s_add_u32 s52, s78, 1049856
    s_mov_b64 exec, 0x3ff
    buffer_load_dword v14, v11, s[36:39], s52 offen
    s_mov_b64 exec, -1
    s_cmp_eq_u32 s90, 0
    s_cbranch_scc1 L_adaLN_cond__grouped_kv_mqa__dense_activation_silu__prompt_kernel_nomb_22
    s_waitcnt lgkmcnt(8)
    v_mfma_f32_16x16x32_bf16 v[248:251], v[228:231], v[208:211], 0
    s_waitcnt lgkmcnt(6)
    v_mfma_f32_16x16x32_bf16 v[248:251], v[232:235], v[212:215], v[248:251]
    s_waitcnt lgkmcnt(4)
    v_mfma_f32_16x16x32_bf16 v[248:251], v[236:239], v[216:219], v[248:251]
    s_waitcnt lgkmcnt(2)
    v_mfma_f32_16x16x32_bf16 v[248:251], v[240:243], v[220:223], v[248:251]
    s_waitcnt lgkmcnt(0)
    v_mfma_f32_16x16x32_bf16 v[248:251], v[244:247], v[224:227], v[248:251]
L_adaLN_cond__grouped_kv_mqa__dense_activation_silu__prompt_kernel_nomb_22:
    v_exp_f32 v53, v53
    v_exp_f32 v54, v54
    v_exp_f32 v55, v55
    v_exp_f32 v56, v56
    v_exp_f32 v57, v57
    v_exp_f32 v58, v58
    v_exp_f32 v59, v59
    v_exp_f32 v60, v60
    v_smfmac_f32_32x32x32_bf16 a[224:239], a[176:179], v[48:55], v5
    v_exp_f32 v61, v61
    v_exp_f32 v62, v62
    v_exp_f32 v63, v63
    v_exp_f32 v64, v64
    v_exp_f32 v65, v65
    v_smfmac_f32_32x32x32_bf16 a[224:239], a[180:183], v[56:63], v5
    v_exp_f32 v66, v66
    v_exp_f32 v67, v67
    v_exp_f32 v68, v68
    v_exp_f32 v69, v69
    v_mfma_f32_32x32x16_bf16 v[16:31], a[70:73], v[80:83], v[16:31]
    v_exp_f32 v70, v70
    v_exp_f32 v71, v71
    v_exp_f32 v72, v72
    v_exp_f32 v73, v73
    v_smfmac_f32_32x32x32_bf16 a[224:239], a[184:187], v[64:71], v5
    v_exp_f32 v74, v74
    v_exp_f32 v75, v75
    v_exp_f32 v76, v76
    v_exp_f32 v77, v77
    v_mfma_f32_32x32x16_bf16 v[32:47], a[74:77], v[80:83], v[32:47]
    v_exp_f32 v78, v78
    v_exp_f32 v79, v79
    v_exp_f32 v16, v16
    v_exp_f32 v17, v17
    v_smfmac_f32_32x32x32_bf16 a[224:239], a[188:191], v[72:79], v5
    v_exp_f32 v18, v18
    v_exp_f32 v19, v19
    v_exp_f32 v20, v20
    v_mfma_f32_32x32x4_2b_bf16 v[48:79], a[78:79], v[90:91], 0
    ds_read_b128 v[80:83], v7 offset:5120
    ds_read_b64 v[84:85], v8 offset:5120
    s_add_u32 s52, s72, 20480
    buffer_load_dwordx4 v[176:179], v4, s[36:39], s52 offen offset:0 sc1
    buffer_load_dwordx4 v[180:183], v4, s[36:39], s52 offen offset:1024 sc1
    buffer_load_dwordx4 v[184:187], v4, s[36:39], s52 offen offset:2048 sc1
    buffer_load_dwordx4 v[188:191], v4, s[36:39], s52 offen offset:3072 sc1
    s_lshl_b32 s52, s28, 3
    s_add_u32 s52, s52, s29
    s_lshl_b32 s52, s52, 2
    s_add_u32 s52, s52, s30
    s_lshl_b32 s53, s52, 7
    s_add_u32 s53, s53, 4096
    s_lshl_b32 s52, s52, 3
    v_cmp_eq_u32 vcc, 5, v1
    v_mov_b32 v10, s52
    v_mov_b32 v9, s53
    s_mov_b32 s52, 20480
    v_cndmask_b32 v10, v10, v9, vcc
    v_lshl_add_u32 v10, v1, 13, v10
    s_mov_b64 exec, 63
    buffer_load_dword v14, v10, s[36:39], s52 offen
    s_mov_b64 exec, -1
    s_cmp_eq_u32 s90, 0
    s_cbranch_scc1 L_adaLN_cond__grouped_kv_mqa__dense_activation_silu__prompt_kernel_nomb_23
    s_mov_b32 exec_lo, 65537
    s_mov_b32 exec_hi, 65537
    ds_write_b128 v255, v[248:251]
    s_mov_b64 exec, -1
L_adaLN_cond__grouped_kv_mqa__dense_activation_silu__prompt_kernel_nomb_23:
    v_exp_f32 v21, v21
    v_exp_f32 v22, v22
    v_exp_f32 v23, v23
    v_exp_f32 v24, v24
    v_exp_f32 v25, v25
    v_exp_f32 v26, v26
    v_exp_f32 v27, v27
    v_exp_f32 v28, v28
    v_smfmac_f32_32x32x32_bf16 a[208:223], a[192:195], v[16:23], v5
    v_exp_f32 v29, v29
    v_exp_f32 v30, v30
    v_exp_f32 v31, v31
    v_exp_f32 v32, v32
    v_exp_f32 v33, v33
    v_smfmac_f32_32x32x32_bf16 a[208:223], a[196:199], v[24:31], v5
    v_exp_f32 v34, v34
    v_exp_f32 v35, v35
    v_exp_f32 v36, v36
    v_exp_f32 v37, v37
    v_mfma_f32_32x32x16_bf16 v[48:63], a[70:73], v[86:89], v[48:63]
    v_exp_f32 v38, v38
    v_exp_f32 v39, v39
    v_exp_f32 v40, v40
    v_exp_f32 v41, v41
    v_smfmac_f32_32x32x32_bf16 a[208:223], a[200:203], v[32:39], v5
    v_exp_f32 v42, v42
    v_exp_f32 v43, v43
    v_exp_f32 v44, v44
    v_exp_f32 v45, v45
    v_mfma_f32_32x32x16_bf16 v[64:79], a[74:77], v[86:89], v[64:79]
    v_exp_f32 v46, v46
    v_exp_f32 v47, v47
    s_waitcnt lgkmcnt(0)
    v_exp_f32 v48, v48
    v_exp_f32 v49, v49
    v_smfmac_f32_32x32x32_bf16 a[208:223], a[204:207], v[40:47], v5
    v_exp_f32 v50, v50
    v_exp_f32 v51, v51
    v_exp_f32 v52, v52
    v_mfma_f32_32x32x4_2b_bf16 v[16:47], a[8:9], v[84:85], 0
    ds_read_b128 v[86:89], v7 offset:6400
    ds_read_b64 v[90:91], v8 offset:6400
    v_exp_f32 v53, v53
    v_exp_f32 v54, v54
    v_exp_f32 v55, v55
    v_exp_f32 v56, v56
    v_exp_f32 v57, v57
    v_exp_f32 v58, v58
    v_exp_f32 v59, v59
    v_exp_f32 v60, v60
    v_smfmac_f32_32x32x32_bf16 a[224:239], a[192:195], v[48:55], v5
    v_exp_f32 v61, v61
    v_exp_f32 v62, v62
    v_exp_f32 v63, v63
    v_exp_f32 v64, v64
    v_exp_f32 v65, v65
    ds_write_b128 v6, a[208:211] offset:6144
    ds_write_b128 v6, a[212:215] offset:7168
    ds_write_b128 v6, a[216:219] offset:8192
    v_smfmac_f32_32x32x32_bf16 a[224:239], a[196:199], v[56:63], v5
    v_exp_f32 v66, v66
    v_exp_f32 v67, v67
    v_exp_f32 v68, v68
    v_exp_f32 v69, v69
    v_mfma_f32_32x32x16_bf16 v[16:31], a[0:3], v[80:83], v[16:31]
    v_exp_f32 v70, v70
    v_exp_f32 v71, v71
    v_exp_f32 v72, v72
    v_exp_f32 v73, v73
    v_smfmac_f32_32x32x32_bf16 a[224:239], a[200:203], v[64:71], v5
    v_exp_f32 v74, v74
    v_exp_f32 v75, v75
    v_mfma_f32_32x32x8_bf16 a[208:223], a[252:253], a[252:253], 0
    v_exp_f32 v76, v76
    v_exp_f32 v77, v77
    v_mfma_f32_32x32x16_bf16 v[32:47], a[4:7], v[80:83], v[32:47]
    v_exp_f32 v78, v78
    v_exp_f32 v79, v79
    s_waitcnt vmcnt(32)
    s_waitcnt lgkmcnt(3)
    v_exp_f32 v16, v16
    v_exp_f32 v17, v17
    v_smfmac_f32_32x32x32_bf16 a[224:239], a[204:207], v[72:79], v5
    v_exp_f32 v18, v18
    v_exp_f32 v19, v19
    v_exp_f32 v20, v20
    v_mfma_f32_32x32x4_2b_bf16 v[48:79], a[8:9], v[90:91], 0
    v_exp_f32 v21, v21
    v_exp_f32 v22, v22
    v_exp_f32 v23, v23
    v_exp_f32 v24, v24
    v_exp_f32 v25, v25
    v_exp_f32 v26, v26
    v_exp_f32 v27, v27
    v_exp_f32 v28, v28
    v_smfmac_f32_32x32x32_bf16 a[208:223], a[80:83], v[16:23], v5
    v_exp_f32 v29, v29
    v_exp_f32 v30, v30
    v_exp_f32 v31, v31
    v_exp_f32 v32, v32
    v_exp_f32 v33, v33
    ds_write_b128 v6, a[224:227] offset:9216
    ds_write_b128 v6, a[228:231] offset:10240
    ds_write_b128 v6, a[232:235] offset:11264
    v_smfmac_f32_32x32x32_bf16 a[208:223], a[84:87], v[24:31], v5
    v_exp_f32 v34, v34
    v_exp_f32 v35, v35
    v_exp_f32 v36, v36
    v_exp_f32 v37, v37
    v_mfma_f32_32x32x16_bf16 v[48:63], a[0:3], v[86:89], v[48:63]
    v_exp_f32 v38, v38
    v_exp_f32 v39, v39
    v_exp_f32 v40, v40
    v_exp_f32 v41, v41
    v_smfmac_f32_32x32x32_bf16 a[208:223], a[88:91], v[32:39], v5
    v_exp_f32 v42, v42
    v_exp_f32 v43, v43
    v_mfma_f32_32x32x8_bf16 a[224:239], a[252:253], a[252:253], 0
    v_exp_f32 v44, v44
    v_exp_f32 v45, v45
    v_mfma_f32_32x32x16_bf16 v[64:79], a[4:7], v[86:89], v[64:79]
    v_exp_f32 v46, v46
    v_exp_f32 v47, v47
    s_waitcnt lgkmcnt(0)
    s_barrier
    v_exp_f32 v48, v48
    v_exp_f32 v49, v49
    v_smfmac_f32_32x32x32_bf16 a[208:223], a[92:95], v[40:47], v5
    v_exp_f32 v50, v50
    v_exp_f32 v51, v51
    v_exp_f32 v52, v52
    v_mfma_f32_32x32x4_2b_bf16 v[16:47], a[18:19], v[84:85], 0
    ds_read_b128 v[208:211], v13 offset:0
    ds_read_b128 v[212:215], v13 offset:1024
    ds_read_b128 v[216:219], v13 offset:2048
    ds_read_b128 v[220:223], v13 offset:12288
    ds_read_b128 v[224:227], v13 offset:13312
    ds_read_b128 v[228:231], v13 offset:14336
    ds_read_b128 v[232:235], v13 offset:24576
    ds_read_b128 v[236:239], v13 offset:25600
    ds_read_b128 v[240:243], v13 offset:26624
    ds_read_b128 v[244:247], v13 offset:36864
    ds_read_b128 v[248:251], v13 offset:37888
    ds_read_b128 v[252:255], v13 offset:38912
    v_exp_f32 v53, v53
    v_exp_f32 v54, v54
    v_exp_f32 v55, v55
    v_exp_f32 v56, v56
    v_exp_f32 v57, v57
    v_exp_f32 v58, v58
    v_exp_f32 v59, v59
    v_exp_f32 v60, v60
    v_smfmac_f32_32x32x32_bf16 a[224:239], a[80:83], v[48:55], v5
    v_exp_f32 v61, v61
    v_exp_f32 v62, v62
    v_exp_f32 v63, v63
    v_exp_f32 v64, v64
    v_exp_f32 v65, v65
    v_smfmac_f32_32x32x32_bf16 a[224:239], a[84:87], v[56:63], v5
    v_exp_f32 v66, v66
    v_exp_f32 v67, v67
    v_exp_f32 v68, v68
    v_exp_f32 v69, v69
    v_mfma_f32_32x32x16_bf16 v[16:31], a[10:13], v[80:83], v[16:31]
    v_exp_f32 v70, v70
    v_exp_f32 v71, v71
    v_exp_f32 v72, v72
    v_exp_f32 v73, v73
    v_smfmac_f32_32x32x32_bf16 a[224:239], a[88:91], v[64:71], v5
    v_exp_f32 v74, v74
    v_exp_f32 v75, v75
    v_exp_f32 v76, v76
    v_exp_f32 v77, v77
    v_mfma_f32_32x32x16_bf16 v[32:47], a[14:17], v[80:83], v[32:47]
    v_exp_f32 v78, v78
    v_exp_f32 v79, v79
    v_exp_f32 v16, v16
    v_exp_f32 v17, v17
    v_smfmac_f32_32x32x32_bf16 a[224:239], a[92:95], v[72:79], v5
    v_exp_f32 v18, v18
    v_exp_f32 v19, v19
    v_exp_f32 v20, v20
    v_mfma_f32_32x32x4_2b_bf16 v[48:79], a[18:19], v[90:91], 0
    v_exp_f32 v21, v21
    v_exp_f32 v22, v22
    v_exp_f32 v23, v23
    v_exp_f32 v24, v24
    v_exp_f32 v25, v25
    v_exp_f32 v26, v26
    v_exp_f32 v27, v27
    v_exp_f32 v28, v28
    s_waitcnt lgkmcnt(0)
    v_pk_add_f32 v[208:209], v[208:209], v[220:221]
    v_pk_add_f32 v[232:233], v[232:233], v[244:245]
    v_pk_add_f32 v[210:211], v[210:211], v[222:223]
    v_pk_add_f32 v[234:235], v[234:235], v[246:247]
    v_pk_add_f32 v[212:213], v[212:213], v[224:225]
    v_pk_add_f32 v[236:237], v[236:237], v[248:249]
    v_pk_add_f32 v[214:215], v[214:215], v[226:227]
    v_pk_add_f32 v[238:239], v[238:239], v[250:251]
    v_pk_add_f32 v[216:217], v[216:217], v[228:229]
    v_pk_add_f32 v[240:241], v[240:241], v[252:253]
    v_pk_add_f32 v[218:219], v[218:219], v[230:231]
    v_pk_add_f32 v[242:243], v[242:243], v[254:255]
    v_pk_add_f32 v[208:209], v[208:209], v[232:233]
    v_pk_add_f32 v[210:211], v[210:211], v[234:235]
    v_pk_add_f32 v[212:213], v[212:213], v[236:237]
    v_pk_add_f32 v[214:215], v[214:215], v[238:239]
    v_pk_add_f32 v[216:217], v[216:217], v[240:241]
    v_pk_add_f32 v[218:219], v[218:219], v[242:243]
    v_mov_b32 v221, v216
    v_mov_b32 v220, v216
    v_mov_b32 v222, 0
    s_mov_b32 s52, 0x35800000
    v_permlane32_swap_b32 v221, v220
    v_fmac_f32 v222, 0, v208
    v_fmac_f32 v222, 0, v209
    v_fmac_f32 v222, 0, v210
    v_fmac_f32 v222, 0, v211
    v_fmac_f32 v222, 0, v212
    v_fmac_f32 v222, 0, v213
    v_fmac_f32 v222, 0, v214
    v_fmac_f32 v222, 0, v215
    v_fmac_f32 v222, 0, v216
    v_fmac_f32 v222, 0, v217
    v_fmac_f32 v222, 0, v218
    v_fmac_f32 v222, 0, v219
    s_mov_b32 s53, 0x5d800000
    v_cmp_le_f32 vcc, s52, v220
    v_cmp_ge_f32 s[54:55], s53, v220
    s_and_b64 vcc, vcc, s[54:55]
    v_cmp_eq_f32 s[54:55], 0, v222
    s_and_b64 vcc, vcc, s[54:55]
    s_cmp_eq_u64 vcc, -1
    s_cselect_b32 s52, 0, 1
    s_or_b32 s79, s79, s52
    s_cmp_lg_u32 s52, 0
    s_cbranch_scc1 L_adaLN_cond__grouped_kv_mqa__dense_activation_silu__prompt_kernel_unsafe_24
    s_mov_b32 s52, 0
    v_rcp_f32 v220, v220
    s_add_u32 s53, s52, s69
    s_add_u32 s52, s52, s68
    s_nop 0
    v_pk_mul_f32 v[208:209], v[208:209], v[220:221] op_sel_hi:[1,0]
    v_pk_mul_f32 v[210:211], v[210:211], v[220:221] op_sel_hi:[1,0]
    v_pk_mul_f32 v[212:213], v[212:213], v[220:221] op_sel_hi:[1,0]
    v_pk_mul_f32 v[214:215], v[214:215], v[220:221] op_sel_hi:[1,0]
    v_pk_mul_f32 v[216:217], v[216:217], v[220:221] op_sel_hi:[1,0]
    v_pk_mul_f32 v[218:219], v[218:219], v[220:221] op_sel_hi:[1,0]
    v_cvt_pk_bf16_f32 v208, v208, v209
    v_cvt_pk_bf16_f32 v209, v210, v211
    v_cvt_pk_bf16_f32 v210, v212, v213
    v_cvt_pk_bf16_f32 v211, v214, v215
    v_cvt_pk_bf16_f32 v212, v216, v217
    v_cvt_pk_bf16_f32 v213, v218, v219
    s_cmp_eq_u32 s92, 0
    s_cbranch_scc1 L_adaLN_cond__grouped_kv_mqa__dense_activation_silu__prompt_kernel_wt_25
    buffer_store_dwordx4 v[208:211], v12, s[36:39], s52 offen
    s_mov_b32 exec_hi, 0
    buffer_store_dwordx2 v[212:213], v12, s[36:39], s53 offen
    s_branch L_adaLN_cond__grouped_kv_mqa__dense_activation_silu__prompt_kernel_wd_26
L_adaLN_cond__grouped_kv_mqa__dense_activation_silu__prompt_kernel_wt_25:
    buffer_store_dwordx4 v[208:211], v12, s[36:39], s52 offen sc1
    s_mov_b32 exec_hi, 0
    buffer_store_dwordx2 v[212:213], v12, s[36:39], s53 offen sc1
L_adaLN_cond__grouped_kv_mqa__dense_activation_silu__prompt_kernel_wd_26:
    s_mov_b32 exec_hi, -1
L_adaLN_cond__grouped_kv_mqa__dense_activation_silu__prompt_kernel_unsafe_24:
    v_smfmac_f32_32x32x32_bf16 a[208:223], a[96:99], v[16:23], v5
    v_exp_f32 v29, v29
    v_exp_f32 v30, v30
    v_exp_f32 v31, v31
    v_exp_f32 v32, v32
    v_exp_f32 v33, v33
    v_smfmac_f32_32x32x32_bf16 a[208:223], a[100:103], v[24:31], v5
    v_exp_f32 v34, v34
    v_exp_f32 v35, v35
    v_exp_f32 v36, v36
    v_exp_f32 v37, v37
    v_mfma_f32_32x32x16_bf16 v[48:63], a[10:13], v[86:89], v[48:63]
    v_exp_f32 v38, v38
    v_exp_f32 v39, v39
    v_exp_f32 v40, v40
    v_exp_f32 v41, v41
    v_smfmac_f32_32x32x32_bf16 a[208:223], a[104:107], v[32:39], v5
    v_exp_f32 v42, v42
    v_exp_f32 v43, v43
    v_exp_f32 v44, v44
    v_exp_f32 v45, v45
    v_mfma_f32_32x32x16_bf16 v[64:79], a[14:17], v[86:89], v[64:79]
    v_exp_f32 v46, v46
    v_exp_f32 v47, v47
    v_exp_f32 v48, v48
    v_exp_f32 v49, v49
    v_smfmac_f32_32x32x32_bf16 a[208:223], a[108:111], v[40:47], v5
    v_exp_f32 v50, v50
    v_exp_f32 v51, v51
    v_exp_f32 v52, v52
    v_mfma_f32_32x32x4_2b_bf16 v[16:47], a[28:29], v[84:85], 0
    s_add_u32 m0, s71, 20480
    s_add_u32 s52, s70, 20480
    buffer_load_dwordx4 v4, s[36:39], s52 offen offset:0 sc1 lds
    buffer_load_dwordx4 v4, s[36:39], s52 offen offset:1024 sc1 lds
    buffer_load_dwordx4 v4, s[36:39], s52 offen offset:2048 sc1 lds
    buffer_load_dwordx4 v4, s[36:39], s52 offen offset:3072 sc1 lds
    s_cmp_eq_u32 s87, 0
    s_cbranch_scc1 L_adaLN_cond__grouped_kv_mqa__dense_activation_silu__prompt_kernel_nomb_27
    v_lshlrev_b32 v253, 4, v3
    v_add_u32 v254, 152832, v253
    ds_read_b128 v[208:211], v254 offset:0
    ds_read_b128 v[212:215], v254 offset:64
    ds_read_b128 v[216:219], v254 offset:128
    ds_read_b128 v[220:223], v254 offset:192
L_adaLN_cond__grouped_kv_mqa__dense_activation_silu__prompt_kernel_nomb_27:
    v_exp_f32 v53, v53
    v_exp_f32 v54, v54
    v_exp_f32 v55, v55
    v_exp_f32 v56, v56
    v_exp_f32 v57, v57
    v_exp_f32 v58, v58
    v_exp_f32 v59, v59
    v_exp_f32 v60, v60
    v_smfmac_f32_32x32x32_bf16 a[224:239], a[96:99], v[48:55], v5
    v_exp_f32 v61, v61
    v_exp_f32 v62, v62
    v_exp_f32 v63, v63
    v_exp_f32 v64, v64
    v_exp_f32 v65, v65
    v_smfmac_f32_32x32x32_bf16 a[224:239], a[100:103], v[56:63], v5
    v_exp_f32 v66, v66
    v_exp_f32 v67, v67
    v_exp_f32 v68, v68
    v_exp_f32 v69, v69
    v_mfma_f32_32x32x16_bf16 v[16:31], a[20:23], v[80:83], v[16:31]
    v_exp_f32 v70, v70
    v_exp_f32 v71, v71
    v_exp_f32 v72, v72
    v_exp_f32 v73, v73
    v_smfmac_f32_32x32x32_bf16 a[224:239], a[104:107], v[64:71], v5
    v_exp_f32 v74, v74
    v_exp_f32 v75, v75
    v_exp_f32 v76, v76
    v_exp_f32 v77, v77
    v_mfma_f32_32x32x16_bf16 v[32:47], a[24:27], v[80:83], v[32:47]
    v_exp_f32 v78, v78
    v_exp_f32 v79, v79
    v_exp_f32 v16, v16
    v_exp_f32 v17, v17
    v_smfmac_f32_32x32x32_bf16 a[224:239], a[108:111], v[72:79], v5
    v_exp_f32 v18, v18
    v_exp_f32 v19, v19
    v_exp_f32 v20, v20
    v_mfma_f32_32x32x4_2b_bf16 v[48:79], a[28:29], v[90:91], 0
    s_add_u32 s52, s72, 24576
    buffer_load_dwordx4 v[192:195], v4, s[36:39], s52 offen offset:0 sc1
    buffer_load_dwordx4 v[196:199], v4, s[36:39], s52 offen offset:1024 sc1
    buffer_load_dwordx4 v[200:203], v4, s[36:39], s52 offen offset:2048 sc1
    buffer_load_dwordx4 v[204:207], v4, s[36:39], s52 offen offset:3072 sc1
    s_add_u32 m0, s71, 24576
    s_add_u32 s52, s70, 24576
    buffer_load_dwordx4 v4, s[36:39], s52 offen offset:0 sc1 lds
    s_cmp_eq_u32 s87, 0
    s_cbranch_scc1 L_adaLN_cond__grouped_kv_mqa__dense_activation_silu__prompt_kernel_nomb_28
    s_lshl_b32 s52, s34, 6
    s_add_u32 s52, s52, 4096
    v_mov_b32 v226, s32
    v_mov_b32 v227, s33
    s_waitcnt lgkmcnt(0)
    v_add_f32 v208, v208, v212
    v_add_f32 v216, v216, v220
    v_add_f32 v209, v209, v213
    v_add_f32 v217, v217, v221
    v_add_f32 v210, v210, v214
    v_add_f32 v218, v218, v222
    v_add_f32 v211, v211, v215
    v_add_f32 v219, v219, v223
    v_add_f32 v208, v208, v216
    v_add_f32 v209, v209, v217
    v_add_f32 v210, v210, v218
    v_add_f32 v211, v211, v219
    v_cvt_pk_bf16_f32 v224, v208, v209
    v_cvt_pk_bf16_f32 v225, v210, v211
    s_mov_b32 exec_lo, 65537
    s_mov_b32 exec_hi, 65537
    buffer_store_dwordx4 v[224:227], v253, s[36:39], s52 offen sc1
    s_mov_b64 exec, -1
L_adaLN_cond__grouped_kv_mqa__dense_activation_silu__prompt_kernel_nomb_28:
    v_exp_f32 v21, v21
    v_exp_f32 v22, v22
    v_exp_f32 v23, v23
    v_exp_f32 v24, v24
    v_exp_f32 v25, v25
    v_exp_f32 v26, v26
    v_exp_f32 v27, v27
    v_exp_f32 v28, v28
    v_smfmac_f32_32x32x32_bf16 a[208:223], a[112:115], v[16:23], v5
    v_exp_f32 v29, v29
    v_exp_f32 v30, v30
    v_exp_f32 v31, v31
    v_exp_f32 v32, v32
    v_exp_f32 v33, v33
    v_smfmac_f32_32x32x32_bf16 a[208:223], a[116:119], v[24:31], v5
    v_exp_f32 v34, v34
    v_exp_f32 v35, v35
    v_exp_f32 v36, v36
    v_exp_f32 v37, v37
    v_mfma_f32_32x32x16_bf16 v[48:63], a[20:23], v[86:89], v[48:63]
    v_exp_f32 v38, v38
    v_exp_f32 v39, v39
    v_exp_f32 v40, v40
    v_exp_f32 v41, v41
    v_smfmac_f32_32x32x32_bf16 a[208:223], a[120:123], v[32:39], v5
    v_exp_f32 v42, v42
    v_exp_f32 v43, v43
    v_exp_f32 v44, v44
    v_exp_f32 v45, v45
    v_mfma_f32_32x32x16_bf16 v[64:79], a[24:27], v[86:89], v[64:79]
    v_exp_f32 v46, v46
    v_exp_f32 v47, v47
    v_exp_f32 v48, v48
    v_exp_f32 v49, v49
    v_smfmac_f32_32x32x32_bf16 a[208:223], a[124:127], v[40:47], v5
    v_exp_f32 v50, v50
    v_exp_f32 v51, v51
    v_exp_f32 v52, v52
    v_mfma_f32_32x32x4_2b_bf16 v[16:47], a[38:39], v[84:85], 0
    s_add_u32 s52, s78, 4194304
    s_mov_b64 exec, 0x3ff
    buffer_load_dword v14, v11, s[36:39], s52 offen
    s_mov_b64 exec, -1
    v_exp_f32 v53, v53
    v_exp_f32 v54, v54
    v_exp_f32 v55, v55
    v_exp_f32 v56, v56
    v_exp_f32 v57, v57
    v_exp_f32 v58, v58
    v_exp_f32 v59, v59
    v_exp_f32 v60, v60
    v_smfmac_f32_32x32x32_bf16 a[224:239], a[112:115], v[48:55], v5
    v_exp_f32 v61, v61
    v_exp_f32 v62, v62
    v_exp_f32 v63, v63
    v_exp_f32 v64, v64
    v_exp_f32 v65, v65
    v_smfmac_f32_32x32x32_bf16 a[224:239], a[116:119], v[56:63], v5
    v_exp_f32 v66, v66
    v_exp_f32 v67, v67
    v_exp_f32 v68, v68
    v_exp_f32 v69, v69
    v_mfma_f32_32x32x16_bf16 v[16:31], a[30:33], v[80:83], v[16:31]
    v_exp_f32 v70, v70
    v_exp_f32 v71, v71
    v_exp_f32 v72, v72
    v_exp_f32 v73, v73
    v_smfmac_f32_32x32x32_bf16 a[224:239], a[120:123], v[64:71], v5
    v_exp_f32 v74, v74
    v_exp_f32 v75, v75
    v_exp_f32 v76, v76
    v_exp_f32 v77, v77
    v_mfma_f32_32x32x16_bf16 v[32:47], a[34:37], v[80:83], v[32:47]
    v_exp_f32 v78, v78
    v_exp_f32 v79, v79
    v_exp_f32 v16, v16
    v_exp_f32 v17, v17
    v_smfmac_f32_32x32x32_bf16 a[224:239], a[124:127], v[72:79], v5
    v_exp_f32 v18, v18
    v_exp_f32 v19, v19
    v_exp_f32 v20, v20
    v_mfma_f32_32x32x4_2b_bf16 v[48:79], a[38:39], v[90:91], 0
    s_cmp_lg_u32 s79, 0
    s_cbranch_scc1 L_nofoa
    s_lshl_b32 s53, s28, 5
    s_lshl_b32 s52, s29, 2
    s_add_u32 s53, s53, s52
    s_add_u32 s53, s53, s30
    s_lshl_b32 s53, s53, 3
    s_add_u32 s53, s53, 20480
    s_waitcnt vmcnt(10)
    v_mov_b32 v92, s32
    v_mov_b32 v93, s33
    v_mov_b32 v94, 0
    s_mov_b64 exec, 1
    s_cmp_eq_u32 s92, 0
    s_cbranch_scc1 L_adaLN_cond__grouped_kv_mqa__dense_activation_silu__prompt_kernel_wt_29
    buffer_store_dwordx2 v[92:93], v94, s[36:39], s53 offen
    s_branch L_adaLN_cond__grouped_kv_mqa__dense_activation_silu__prompt_kernel_wd_30
L_adaLN_cond__grouped_kv_mqa__dense_activation_silu__prompt_kernel_wt_29:
    buffer_store_dwordx2 v[92:93], v94, s[36:39], s53 offen sc1
L_adaLN_cond__grouped_kv_mqa__dense_activation_silu__prompt_kernel_wd_30:
    s_mov_b64 exec, -1
L_nofoa:
    s_add_u32 s52, s72, 28672
    buffer_load_dwordx4 v[208:211], v4, s[36:39], s52 offen offset:0 sc1
    buffer_load_dwordx4 v[212:215], v4, s[36:39], s52 offen offset:1024 sc1
    buffer_load_dwordx4 v[216:219], v4, s[36:39], s52 offen offset:2048 sc1
    buffer_load_dwordx4 v[220:223], v4, s[36:39], s52 offen offset:3072 sc1
    v_exp_f32 v21, v21
    v_exp_f32 v22, v22
    v_exp_f32 v23, v23
    v_exp_f32 v24, v24
    v_exp_f32 v25, v25
    v_exp_f32 v26, v26
    v_exp_f32 v27, v27
    v_exp_f32 v28, v28
    v_smfmac_f32_32x32x32_bf16 a[208:223], a[128:131], v[16:23], v5
    v_exp_f32 v29, v29
    v_exp_f32 v30, v30
    v_exp_f32 v31, v31
    v_exp_f32 v32, v32
    v_exp_f32 v33, v33
    v_smfmac_f32_32x32x32_bf16 a[208:223], a[132:135], v[24:31], v5
    v_exp_f32 v34, v34
    v_exp_f32 v35, v35
    v_exp_f32 v36, v36
    v_exp_f32 v37, v37
    v_mfma_f32_32x32x16_bf16 v[48:63], a[30:33], v[86:89], v[48:63]
    v_exp_f32 v38, v38
    v_exp_f32 v39, v39
    v_exp_f32 v40, v40
    v_exp_f32 v41, v41
    v_smfmac_f32_32x32x32_bf16 a[208:223], a[136:139], v[32:39], v5
    v_exp_f32 v42, v42
    v_exp_f32 v43, v43
    v_exp_f32 v44, v44
    v_exp_f32 v45, v45
    v_mfma_f32_32x32x16_bf16 v[64:79], a[34:37], v[86:89], v[64:79]
    v_exp_f32 v46, v46
    v_exp_f32 v47, v47
    v_exp_f32 v48, v48
    v_exp_f32 v49, v49
    v_smfmac_f32_32x32x32_bf16 a[208:223], a[140:143], v[40:47], v5
    v_exp_f32 v50, v50
    v_exp_f32 v51, v51
    v_exp_f32 v52, v52
    v_mfma_f32_32x32x4_2b_bf16 v[16:47], a[48:49], v[84:85], 0
    v_exp_f32 v53, v53
    v_exp_f32 v54, v54
    v_exp_f32 v55, v55
    v_exp_f32 v56, v56
    v_exp_f32 v57, v57
    v_exp_f32 v58, v58
    v_exp_f32 v59, v59
    v_exp_f32 v60, v60
    v_smfmac_f32_32x32x32_bf16 a[224:239], a[128:131], v[48:55], v5
    v_exp_f32 v61, v61
    v_exp_f32 v62, v62
    v_exp_f32 v63, v63
    v_exp_f32 v64, v64
    v_exp_f32 v65, v65
    v_smfmac_f32_32x32x32_bf16 a[224:239], a[132:135], v[56:63], v5
    v_exp_f32 v66, v66
    v_exp_f32 v67, v67
    v_exp_f32 v68, v68
    v_exp_f32 v69, v69
    v_mfma_f32_32x32x16_bf16 v[16:31], a[40:43], v[80:83], v[16:31]
    v_exp_f32 v70, v70
    v_exp_f32 v71, v71
    v_exp_f32 v72, v72
    v_exp_f32 v73, v73
    v_smfmac_f32_32x32x32_bf16 a[224:239], a[136:139], v[64:71], v5
    v_exp_f32 v74, v74
    v_exp_f32 v75, v75
    v_exp_f32 v76, v76
    v_exp_f32 v77, v77
    v_mfma_f32_32x32x16_bf16 v[32:47], a[44:47], v[80:83], v[32:47]
    v_exp_f32 v78, v78
    v_exp_f32 v79, v79
    s_waitcnt vmcnt(32)
    v_exp_f32 v16, v16
    v_exp_f32 v17, v17
    v_smfmac_f32_32x32x32_bf16 a[224:239], a[140:143], v[72:79], v5
    v_exp_f32 v18, v18
    v_exp_f32 v19, v19
    v_exp_f32 v20, v20
    v_mfma_f32_32x32x4_2b_bf16 v[48:79], a[48:49], v[90:91], 0
    s_add_u32 s52, s72, 32768
    buffer_load_dwordx4 v[224:227], v4, s[36:39], s52 offen offset:0 sc1
    buffer_load_dwordx4 v[228:231], v4, s[36:39], s52 offen offset:1024 sc1
    buffer_load_dwordx4 v[232:235], v4, s[36:39], s52 offen offset:2048 sc1
    buffer_load_dwordx4 v[236:239], v4, s[36:39], s52 offen offset:3072 sc1
    v_exp_f32 v21, v21
    v_exp_f32 v22, v22
    v_exp_f32 v23, v23
    v_exp_f32 v24, v24
    v_exp_f32 v25, v25
    v_exp_f32 v26, v26
    v_exp_f32 v27, v27
    v_exp_f32 v28, v28
    v_smfmac_f32_32x32x32_bf16 a[208:223], a[144:147], v[16:23], v5
    v_exp_f32 v29, v29
    v_exp_f32 v30, v30
    v_exp_f32 v31, v31
    v_exp_f32 v32, v32
    v_exp_f32 v33, v33
    v_smfmac_f32_32x32x32_bf16 a[208:223], a[148:151], v[24:31], v5
    v_exp_f32 v34, v34
    v_exp_f32 v35, v35
    v_exp_f32 v36, v36
    v_exp_f32 v37, v37
    v_mfma_f32_32x32x16_bf16 v[48:63], a[40:43], v[86:89], v[48:63]
    v_exp_f32 v38, v38
    v_exp_f32 v39, v39
    v_exp_f32 v40, v40
    v_exp_f32 v41, v41
    v_smfmac_f32_32x32x32_bf16 a[208:223], a[152:155], v[32:39], v5
    v_exp_f32 v42, v42
    v_exp_f32 v43, v43
    v_exp_f32 v44, v44
    v_exp_f32 v45, v45
    v_mfma_f32_32x32x16_bf16 v[64:79], a[44:47], v[86:89], v[64:79]
    v_exp_f32 v46, v46
    v_exp_f32 v47, v47
    v_exp_f32 v48, v48
    v_exp_f32 v49, v49
    v_smfmac_f32_32x32x32_bf16 a[208:223], a[156:159], v[40:47], v5
    v_exp_f32 v50, v50
    v_exp_f32 v51, v51
    v_exp_f32 v52, v52
    v_mfma_f32_32x32x4_2b_bf16 v[16:47], a[58:59], v[84:85], 0
    v_exp_f32 v53, v53
    v_exp_f32 v54, v54
    v_exp_f32 v55, v55
    v_exp_f32 v56, v56
    v_exp_f32 v57, v57
    v_exp_f32 v58, v58
    v_exp_f32 v59, v59
    v_exp_f32 v60, v60
    v_smfmac_f32_32x32x32_bf16 a[224:239], a[144:147], v[48:55], v5
    v_exp_f32 v61, v61
    v_exp_f32 v62, v62
    v_exp_f32 v63, v63
    v_exp_f32 v64, v64
    v_exp_f32 v65, v65
    v_smfmac_f32_32x32x32_bf16 a[224:239], a[148:151], v[56:63], v5
    v_exp_f32 v66, v66
    v_exp_f32 v67, v67
    v_exp_f32 v68, v68
    v_exp_f32 v69, v69
    v_mfma_f32_32x32x16_bf16 v[16:31], a[50:53], v[80:83], v[16:31]
    v_exp_f32 v70, v70
    v_exp_f32 v71, v71
    v_exp_f32 v72, v72
    v_exp_f32 v73, v73
    v_smfmac_f32_32x32x32_bf16 a[224:239], a[152:155], v[64:71], v5
    v_exp_f32 v74, v74
    v_exp_f32 v75, v75
    v_exp_f32 v76, v76
    v_exp_f32 v77, v77
    v_mfma_f32_32x32x16_bf16 v[32:47], a[54:57], v[80:83], v[32:47]
    v_exp_f32 v78, v78
    v_exp_f32 v79, v79
    s_barrier
    v_exp_f32 v16, v16
    v_exp_f32 v17, v17
    v_smfmac_f32_32x32x32_bf16 a[224:239], a[156:159], v[72:79], v5
    v_exp_f32 v18, v18
    v_exp_f32 v19, v19
    v_exp_f32 v20, v20
    v_mfma_f32_32x32x4_2b_bf16 v[48:79], a[58:59], v[90:91], 0
    s_add_u32 s52, s72, 36864
    buffer_load_dwordx4 v[240:243], v4, s[36:39], s52 offen offset:0 sc1
    buffer_load_dwordx4 v[244:247], v4, s[36:39], s52 offen offset:1024 sc1
    buffer_load_dwordx4 v[248:251], v4, s[36:39], s52 offen offset:2048 sc1
    buffer_load_dwordx4 v[252:255], v4, s[36:39], s52 offen offset:3072 sc1
    v_exp_f32 v21, v21
    v_exp_f32 v22, v22
    v_exp_f32 v23, v23
    v_exp_f32 v24, v24
    v_exp_f32 v25, v25
    v_exp_f32 v26, v26
    v_exp_f32 v27, v27
    v_exp_f32 v28, v28
    v_smfmac_f32_32x32x32_bf16 a[208:223], a[160:163], v[16:23], v5
    v_exp_f32 v29, v29
    v_exp_f32 v30, v30
    v_exp_f32 v31, v31
    v_exp_f32 v32, v32
    v_exp_f32 v33, v33
    v_smfmac_f32_32x32x32_bf16 a[208:223], a[164:167], v[24:31], v5
    v_exp_f32 v34, v34
    v_exp_f32 v35, v35
    v_exp_f32 v36, v36
    v_exp_f32 v37, v37
    v_mfma_f32_32x32x16_bf16 v[48:63], a[50:53], v[86:89], v[48:63]
    v_exp_f32 v38, v38
    v_exp_f32 v39, v39
    v_exp_f32 v40, v40
    v_exp_f32 v41, v41
    v_smfmac_f32_32x32x32_bf16 a[208:223], a[168:171], v[32:39], v5
    v_exp_f32 v42, v42
    v_exp_f32 v43, v43
    v_exp_f32 v44, v44
    v_exp_f32 v45, v45
    v_mfma_f32_32x32x16_bf16 v[64:79], a[54:57], v[86:89], v[64:79]
    v_exp_f32 v46, v46
    v_exp_f32 v47, v47
    v_exp_f32 v48, v48
    v_exp_f32 v49, v49
    v_smfmac_f32_32x32x32_bf16 a[208:223], a[172:175], v[40:47], v5
    v_exp_f32 v50, v50
    v_exp_f32 v51, v51
    v_exp_f32 v52, v52
    v_mfma_f32_32x32x4_2b_bf16 v[16:47], a[68:69], v[84:85], 0
    s_add_u32 s52, s78, 4195584
    s_mov_b64 exec, 0x3ff
    buffer_load_dword v14, v11, s[36:39], s52 offen
    s_mov_b64 exec, -1
    v_exp_f32 v53, v53
    v_exp_f32 v54, v54
    v_exp_f32 v55, v55
    v_exp_f32 v56, v56
    v_exp_f32 v57, v57
    v_exp_f32 v58, v58
    v_exp_f32 v59, v59
    v_exp_f32 v60, v60
    v_smfmac_f32_32x32x32_bf16 a[224:239], a[160:163], v[48:55], v5
    v_exp_f32 v61, v61
    v_exp_f32 v62, v62
    v_exp_f32 v63, v63
    v_exp_f32 v64, v64
    v_exp_f32 v65, v65
    v_smfmac_f32_32x32x32_bf16 a[224:239], a[164:167], v[56:63], v5
    v_exp_f32 v66, v66
    v_exp_f32 v67, v67
    v_exp_f32 v68, v68
    v_exp_f32 v69, v69
    v_mfma_f32_32x32x16_bf16 v[16:31], a[60:63], v[80:83], v[16:31]
    v_exp_f32 v70, v70
    v_exp_f32 v71, v71
    v_exp_f32 v72, v72
    v_exp_f32 v73, v73
    v_smfmac_f32_32x32x32_bf16 a[224:239], a[168:171], v[64:71], v5
    v_exp_f32 v74, v74
    v_exp_f32 v75, v75
    v_exp_f32 v76, v76
    v_exp_f32 v77, v77
    v_mfma_f32_32x32x16_bf16 v[32:47], a[64:67], v[80:83], v[32:47]
    v_exp_f32 v78, v78
    v_exp_f32 v79, v79
    v_exp_f32 v16, v16
    v_exp_f32 v17, v17
    v_smfmac_f32_32x32x32_bf16 a[224:239], a[172:175], v[72:79], v5
    v_exp_f32 v18, v18
    v_exp_f32 v19, v19
    v_exp_f32 v20, v20
    v_mfma_f32_32x32x4_2b_bf16 v[48:79], a[68:69], v[90:91], 0
    v_add_u32 v10, s31, v2
    v_mul_u32_u24 v10, 1280, v10
    v_and_b32 v9, 1, v3
    v_lshl_add_u32 v10, v9, 5, v10
    v_lshrrev_b32 v9, 1, v3
    v_lshl_add_u32 v10, v9, 4, v10
    buffer_load_dwordx4 a[240:243], v10, s[40:43], s67 offen offset:0
    v_exp_f32 v21, v21
    v_exp_f32 v22, v22
    v_exp_f32 v23, v23
    v_exp_f32 v24, v24
    v_exp_f32 v25, v25
    v_exp_f32 v26, v26
    v_exp_f32 v27, v27
    v_exp_f32 v28, v28
    v_smfmac_f32_32x32x32_bf16 a[208:223], a[176:179], v[16:23], v5
    v_exp_f32 v29, v29
    v_exp_f32 v30, v30
    v_exp_f32 v31, v31
    v_exp_f32 v32, v32
    v_exp_f32 v33, v33
    v_smfmac_f32_32x32x32_bf16 a[208:223], a[180:183], v[24:31], v5
    v_exp_f32 v34, v34
    v_exp_f32 v35, v35
    v_exp_f32 v36, v36
    v_exp_f32 v37, v37
    v_mfma_f32_32x32x16_bf16 v[48:63], a[60:63], v[86:89], v[48:63]
    v_exp_f32 v38, v38
    v_exp_f32 v39, v39
    v_exp_f32 v40, v40
    v_exp_f32 v41, v41
    v_smfmac_f32_32x32x32_bf16 a[208:223], a[184:187], v[32:39], v5
    v_exp_f32 v42, v42
    v_exp_f32 v43, v43
    v_exp_f32 v44, v44
    v_exp_f32 v45, v45
    v_mfma_f32_32x32x16_bf16 v[64:79], a[64:67], v[86:89], v[64:79]
    v_exp_f32 v46, v46
    v_exp_f32 v47, v47
    v_exp_f32 v48, v48
    v_exp_f32 v49, v49
    v_smfmac_f32_32x32x32_bf16 a[208:223], a[188:191], v[40:47], v5
    v_exp_f32 v50, v50
    v_exp_f32 v51, v51
    v_exp_f32 v52, v52
    v_mfma_f32_32x32x4_2b_bf16 v[16:47], a[78:79], v[84:85], 0
    v_exp_f32 v53, v53
    v_exp_f32 v54, v54
    v_exp_f32 v55, v55
    v_exp_f32 v56, v56
    v_exp_f32 v57, v57
    v_exp_f32 v58, v58
    v_exp_f32 v59, v59
    v_exp_f32 v60, v60
    v_smfmac_f32_32x32x32_bf16 a[224:239], a[176:179], v[48:55], v5
    v_exp_f32 v61, v61
    v_exp_f32 v62, v62
    v_exp_f32 v63, v63
    v_exp_f32 v64, v64
    v_exp_f32 v65, v65
    v_smfmac_f32_32x32x32_bf16 a[224:239], a[180:183], v[56:63], v5
    v_exp_f32 v66, v66
    v_exp_f32 v67, v67
    v_exp_f32 v68, v68
    v_exp_f32 v69, v69
    v_mfma_f32_32x32x16_bf16 v[16:31], a[70:73], v[80:83], v[16:31]
    v_exp_f32 v70, v70
    v_exp_f32 v71, v71
    v_exp_f32 v72, v72
    v_exp_f32 v73, v73
    v_smfmac_f32_32x32x32_bf16 a[224:239], a[184:187], v[64:71], v5
    v_exp_f32 v74, v74
    v_exp_f32 v75, v75
    v_exp_f32 v76, v76
    v_exp_f32 v77, v77
    v_mfma_f32_32x32x16_bf16 v[32:47], a[74:77], v[80:83], v[32:47]
    v_exp_f32 v78, v78
    v_exp_f32 v79, v79
    v_exp_f32 v16, v16
    v_exp_f32 v17, v17
    v_smfmac_f32_32x32x32_bf16 a[224:239], a[188:191], v[72:79], v5
    v_exp_f32 v18, v18
    v_exp_f32 v19, v19
    v_exp_f32 v20, v20
    v_mfma_f32_32x32x4_2b_bf16 v[48:79], a[78:79], v[90:91], 0
    ds_read_b128 v[80:83], v7 offset:7680
    ds_read_b64 v[84:85], v8 offset:7680
    buffer_load_dwordx4 a[244:247], v10, s[40:43], s67 offen offset:64
    v_exp_f32 v21, v21
    v_exp_f32 v22, v22
    v_exp_f32 v23, v23
    v_exp_f32 v24, v24
    v_exp_f32 v25, v25
    v_exp_f32 v26, v26
    v_exp_f32 v27, v27
    v_exp_f32 v28, v28
    v_smfmac_f32_32x32x32_bf16 a[208:223], a[192:195], v[16:23], v5
    v_exp_f32 v29, v29
    v_exp_f32 v30, v30
    v_exp_f32 v31, v31
    v_exp_f32 v32, v32
    v_exp_f32 v33, v33
    v_smfmac_f32_32x32x32_bf16 a[208:223], a[196:199], v[24:31], v5
    v_exp_f32 v34, v34
    v_exp_f32 v35, v35
    v_exp_f32 v36, v36
    v_exp_f32 v37, v37
    v_mfma_f32_32x32x16_bf16 v[48:63], a[70:73], v[86:89], v[48:63]
    v_exp_f32 v38, v38
    v_exp_f32 v39, v39
    v_exp_f32 v40, v40
    v_exp_f32 v41, v41
    v_smfmac_f32_32x32x32_bf16 a[208:223], a[200:203], v[32:39], v5
    v_exp_f32 v42, v42
    v_exp_f32 v43, v43
    v_exp_f32 v44, v44
    v_exp_f32 v45, v45
    v_mfma_f32_32x32x16_bf16 v[64:79], a[74:77], v[86:89], v[64:79]
    v_exp_f32 v46, v46
    v_exp_f32 v47, v47
    s_waitcnt lgkmcnt(0)
    v_exp_f32 v48, v48
    v_exp_f32 v49, v49
    v_smfmac_f32_32x32x32_bf16 a[208:223], a[204:207], v[40:47], v5
    v_exp_f32 v50, v50
    v_exp_f32 v51, v51
    v_exp_f32 v52, v52
    v_mfma_f32_32x32x4_2b_bf16 v[16:47], a[8:9], v[84:85], 0
    ds_read_b128 v[86:89], v7 offset:8960
    ds_read_b64 v[90:91], v8 offset:8960
    v_exp_f32 v53, v53
    v_exp_f32 v54, v54
    v_exp_f32 v55, v55
    v_exp_f32 v56, v56
    v_exp_f32 v57, v57
    v_exp_f32 v58, v58
    v_exp_f32 v59, v59
    v_exp_f32 v60, v60
    v_smfmac_f32_32x32x32_bf16 a[224:239], a[192:195], v[48:55], v5
    v_exp_f32 v61, v61
    v_exp_f32 v62, v62
    v_exp_f32 v63, v63
    v_exp_f32 v64, v64
    v_exp_f32 v65, v65
    ds_write_b128 v6, a[208:211] offset:0
    ds_write_b128 v6, a[212:215] offset:1024
    ds_write_b128 v6, a[216:219] offset:2048
    v_smfmac_f32_32x32x32_bf16 a[224:239], a[196:199], v[56:63], v5
    v_exp_f32 v66, v66
    v_exp_f32 v67, v67
    v_exp_f32 v68, v68
    v_exp_f32 v69, v69
    v_mfma_f32_32x32x16_bf16 v[16:31], a[0:3], v[80:83], v[16:31]
    v_exp_f32 v70, v70
    v_exp_f32 v71, v71
    v_exp_f32 v72, v72
    v_exp_f32 v73, v73
    v_smfmac_f32_32x32x32_bf16 a[224:239], a[200:203], v[64:71], v5
    v_exp_f32 v74, v74
    v_exp_f32 v75, v75
    v_mfma_f32_32x32x8_bf16 a[208:223], a[252:253], a[252:253], 0
    v_exp_f32 v76, v76
    v_exp_f32 v77, v77
    v_mfma_f32_32x32x16_bf16 v[32:47], a[4:7], v[80:83], v[32:47]
    v_exp_f32 v78, v78
    v_exp_f32 v79, v79
    s_waitcnt vmcnt(32)
    s_waitcnt lgkmcnt(3)
    v_exp_f32 v16, v16
    v_exp_f32 v17, v17
    v_smfmac_f32_32x32x32_bf16 a[224:239], a[204:207], v[72:79], v5
    v_exp_f32 v18, v18
    v_exp_f32 v19, v19
    v_exp_f32 v20, v20
    v_mfma_f32_32x32x4_2b_bf16 v[48:79], a[8:9], v[90:91], 0
    s_mov_b32 exec_lo, 65535
    s_mov_b32 exec_hi, 65535
    buffer_load_dwordx4 a[248:251], v10, s[40:43], s67 offen offset:128
    s_mov_b64 exec, -1
    v_exp_f32 v21, v21
    v_exp_f32 v22, v22
    v_exp_f32 v23, v23
    v_exp_f32 v24, v24
    v_exp_f32 v25, v25
    v_exp_f32 v26, v26
    v_exp_f32 v27, v27
    v_exp_f32 v28, v28
    v_smfmac_f32_32x32x32_bf16 a[208:223], a[80:83], v[16:23], v5
    v_exp_f32 v29, v29
    v_exp_f32 v30, v30
    v_exp_f32 v31, v31
    v_exp_f32 v32, v32
    v_exp_f32 v33, v33
    ds_write_b128 v6, a[224:227] offset:3072
    ds_write_b128 v6, a[228:231] offset:4096
    ds_write_b128 v6, a[232:235] offset:5120
    v_smfmac_f32_32x32x32_bf16 a[208:223], a[84:87], v[24:31], v5
    v_exp_f32 v34, v34
    v_exp_f32 v35, v35
    v_exp_f32 v36, v36
    v_exp_f32 v37, v37
    v_mfma_f32_32x32x16_bf16 v[48:63], a[0:3], v[86:89], v[48:63]
    v_exp_f32 v38, v38
    v_exp_f32 v39, v39
    v_exp_f32 v40, v40
    v_exp_f32 v41, v41
    v_smfmac_f32_32x32x32_bf16 a[208:223], a[88:91], v[32:39], v5
    v_exp_f32 v42, v42
    v_exp_f32 v43, v43
    v_mfma_f32_32x32x8_bf16 a[224:239], a[252:253], a[252:253], 0
    v_exp_f32 v44, v44
    v_exp_f32 v45, v45
    v_mfma_f32_32x32x16_bf16 v[64:79], a[4:7], v[86:89], v[64:79]
    v_exp_f32 v46, v46
    v_exp_f32 v47, v47
    v_exp_f32 v48, v48
    v_exp_f32 v49, v49
    v_smfmac_f32_32x32x32_bf16 a[208:223], a[92:95], v[40:47], v5
    v_exp_f32 v50, v50
    v_exp_f32 v51, v51
    v_exp_f32 v52, v52
    v_mfma_f32_32x32x4_2b_bf16 v[16:47], a[18:19], v[84:85], 0
    s_add_u32 s52, s72, 40960
    buffer_load_dwordx4 a[0:3], v4, s[36:39], s52 offen offset:0 sc1
    buffer_load_dwordx4 a[4:7], v4, s[36:39], s52 offen offset:1024 sc1
    v_exp_f32 v53, v53
    v_exp_f32 v54, v54
    v_exp_f32 v55, v55
    v_exp_f32 v56, v56
    v_exp_f32 v57, v57
    v_exp_f32 v58, v58
    v_exp_f32 v59, v59
    v_exp_f32 v60, v60
    v_smfmac_f32_32x32x32_bf16 a[224:239], a[80:83], v[48:55], v5
    v_exp_f32 v61, v61
    v_exp_f32 v62, v62
    v_exp_f32 v63, v63
    v_exp_f32 v64, v64
    v_exp_f32 v65, v65
    v_smfmac_f32_32x32x32_bf16 a[224:239], a[84:87], v[56:63], v5
    v_exp_f32 v66, v66
    v_exp_f32 v67, v67
    v_exp_f32 v68, v68
    v_exp_f32 v69, v69
    v_mfma_f32_32x32x16_bf16 v[16:31], a[10:13], v[80:83], v[16:31]
    v_exp_f32 v70, v70
    v_exp_f32 v71, v71
    v_exp_f32 v72, v72
    v_exp_f32 v73, v73
    v_smfmac_f32_32x32x32_bf16 a[224:239], a[88:91], v[64:71], v5
    v_exp_f32 v74, v74
    v_exp_f32 v75, v75
    v_exp_f32 v76, v76
    v_exp_f32 v77, v77
    v_mfma_f32_32x32x16_bf16 v[32:47], a[14:17], v[80:83], v[32:47]
    v_exp_f32 v78, v78
    v_exp_f32 v79, v79
    v_exp_f32 v16, v16
    v_exp_f32 v17, v17
    v_smfmac_f32_32x32x32_bf16 a[224:239], a[92:95], v[72:79], v5
    v_exp_f32 v18, v18
    v_exp_f32 v19, v19
    v_exp_f32 v20, v20
    v_mfma_f32_32x32x4_2b_bf16 v[48:79], a[18:19], v[90:91], 0
    s_add_u32 s52, s93, 7340032
    s_mov_b64 exec, 0xfff
    buffer_load_dword v14, v11, s[36:39], s52 offen
    s_mov_b64 exec, -1
    v_exp_f32 v21, v21
    v_exp_f32 v22, v22
    v_exp_f32 v23, v23
    v_exp_f32 v24, v24
    v_exp_f32 v25, v25
    v_exp_f32 v26, v26
    v_exp_f32 v27, v27
    v_exp_f32 v28, v28
    v_smfmac_f32_32x32x32_bf16 a[208:223], a[96:99], v[16:23], v5
    v_exp_f32 v29, v29
    v_exp_f32 v30, v30
    v_exp_f32 v31, v31
    v_exp_f32 v32, v32
    v_exp_f32 v33, v33
    v_smfmac_f32_32x32x32_bf16 a[208:223], a[100:103], v[24:31], v5
    v_exp_f32 v34, v34
    v_exp_f32 v35, v35
    v_exp_f32 v36, v36
    v_exp_f32 v37, v37
    v_mfma_f32_32x32x16_bf16 v[48:63], a[10:13], v[86:89], v[48:63]
    v_exp_f32 v38, v38
    v_exp_f32 v39, v39
    v_exp_f32 v40, v40
    v_exp_f32 v41, v41
    v_smfmac_f32_32x32x32_bf16 a[208:223], a[104:107], v[32:39], v5
    v_exp_f32 v42, v42
    v_exp_f32 v43, v43
    v_exp_f32 v44, v44
    v_exp_f32 v45, v45
    v_mfma_f32_32x32x16_bf16 v[64:79], a[14:17], v[86:89], v[64:79]
    v_exp_f32 v46, v46
    v_exp_f32 v47, v47
    v_exp_f32 v48, v48
    v_exp_f32 v49, v49
    v_smfmac_f32_32x32x32_bf16 a[208:223], a[108:111], v[40:47], v5
    v_exp_f32 v50, v50
    v_exp_f32 v51, v51
    v_exp_f32 v52, v52
    v_mfma_f32_32x32x4_2b_bf16 v[16:47], a[28:29], v[84:85], 0
    s_add_u32 s52, s72, 43008
    buffer_load_dwordx4 a[8:11], v4, s[36:39], s52 offen offset:0 sc1
    buffer_load_dwordx4 a[12:15], v4, s[36:39], s52 offen offset:1024 sc1
    buffer_load_dwordx4 a[16:19], v4, s[36:39], s52 offen offset:2048 sc1
    v_exp_f32 v53, v53
    v_exp_f32 v54, v54
    v_exp_f32 v55, v55
    v_exp_f32 v56, v56
    v_exp_f32 v57, v57
    v_exp_f32 v58, v58
    v_exp_f32 v59, v59
    v_exp_f32 v60, v60
    v_smfmac_f32_32x32x32_bf16 a[224:239], a[96:99], v[48:55], v5
    v_exp_f32 v61, v61
    v_exp_f32 v62, v62
    v_exp_f32 v63, v63
    v_exp_f32 v64, v64
    v_exp_f32 v65, v65
    v_smfmac_f32_32x32x32_bf16 a[224:239], a[100:103], v[56:63], v5
    v_exp_f32 v66, v66
    v_exp_f32 v67, v67
    v_exp_f32 v68, v68
    v_exp_f32 v69, v69
    v_mfma_f32_32x32x16_bf16 v[16:31], a[20:23], v[80:83], v[16:31]
    v_exp_f32 v70, v70
    v_exp_f32 v71, v71
    v_exp_f32 v72, v72
    v_exp_f32 v73, v73
    v_smfmac_f32_32x32x32_bf16 a[224:239], a[104:107], v[64:71], v5
    v_exp_f32 v74, v74
    v_exp_f32 v75, v75
    v_exp_f32 v76, v76
    v_exp_f32 v77, v77
    v_mfma_f32_32x32x16_bf16 v[32:47], a[24:27], v[80:83], v[32:47]
    v_exp_f32 v78, v78
    v_exp_f32 v79, v79
    v_exp_f32 v16, v16
    v_exp_f32 v17, v17
    v_smfmac_f32_32x32x32_bf16 a[224:239], a[108:111], v[72:79], v5
    v_exp_f32 v18, v18
    v_exp_f32 v19, v19
    v_exp_f32 v20, v20
    v_mfma_f32_32x32x4_2b_bf16 v[48:79], a[28:29], v[90:91], 0
    v_exp_f32 v21, v21
    v_exp_f32 v22, v22
    v_exp_f32 v23, v23
    v_exp_f32 v24, v24
    v_exp_f32 v25, v25
    v_exp_f32 v26, v26
    v_exp_f32 v27, v27
    v_exp_f32 v28, v28
    v_smfmac_f32_32x32x32_bf16 a[208:223], a[112:115], v[16:23], v5
    v_exp_f32 v29, v29
    v_exp_f32 v30, v30
    v_exp_f32 v31, v31
    v_exp_f32 v32, v32
    v_exp_f32 v33, v33
    v_smfmac_f32_32x32x32_bf16 a[208:223], a[116:119], v[24:31], v5
    v_exp_f32 v34, v34
    v_exp_f32 v35, v35
    v_exp_f32 v36, v36
    v_exp_f32 v37, v37
    v_mfma_f32_32x32x16_bf16 v[48:63], a[20:23], v[86:89], v[48:63]
    v_exp_f32 v38, v38
    v_exp_f32 v39, v39
    v_exp_f32 v40, v40
    v_exp_f32 v41, v41
    v_smfmac_f32_32x32x32_bf16 a[208:223], a[120:123], v[32:39], v5
    v_exp_f32 v42, v42
    v_exp_f32 v43, v43
    v_exp_f32 v44, v44
    v_exp_f32 v45, v45
    v_mfma_f32_32x32x16_bf16 v[64:79], a[24:27], v[86:89], v[64:79]
    v_exp_f32 v46, v46
    v_exp_f32 v47, v47
    v_exp_f32 v48, v48
    v_exp_f32 v49, v49
    v_smfmac_f32_32x32x32_bf16 a[208:223], a[124:127], v[40:47], v5
    v_exp_f32 v50, v50
    v_exp_f32 v51, v51
    v_exp_f32 v52, v52
    v_mfma_f32_32x32x4_2b_bf16 v[16:47], a[38:39], v[84:85], 0
    s_add_u32 s52, s72, 46080
    buffer_load_dwordx4 a[20:23], v4, s[36:39], s52 offen offset:0 sc1
    buffer_load_dwordx4 a[24:27], v4, s[36:39], s52 offen offset:1024 sc1
    v_exp_f32 v53, v53
    v_exp_f32 v54, v54
    v_exp_f32 v55, v55
    v_exp_f32 v56, v56
    v_exp_f32 v57, v57
    v_exp_f32 v58, v58
    v_exp_f32 v59, v59
    v_exp_f32 v60, v60
    v_smfmac_f32_32x32x32_bf16 a[224:239], a[112:115], v[48:55], v5
    v_exp_f32 v61, v61
    v_exp_f32 v62, v62
    v_exp_f32 v63, v63
    v_exp_f32 v64, v64
    v_exp_f32 v65, v65
    v_smfmac_f32_32x32x32_bf16 a[224:239], a[116:119], v[56:63], v5
    v_exp_f32 v66, v66
    v_exp_f32 v67, v67
    v_exp_f32 v68, v68
    v_exp_f32 v69, v69
    v_mfma_f32_32x32x16_bf16 v[16:31], a[30:33], v[80:83], v[16:31]
    v_exp_f32 v70, v70
    v_exp_f32 v71, v71
    v_exp_f32 v72, v72
    v_exp_f32 v73, v73
    v_smfmac_f32_32x32x32_bf16 a[224:239], a[120:123], v[64:71], v5
    v_exp_f32 v74, v74
    v_exp_f32 v75, v75
    v_exp_f32 v76, v76
    v_exp_f32 v77, v77
    v_mfma_f32_32x32x16_bf16 v[32:47], a[34:37], v[80:83], v[32:47]
    v_exp_f32 v78, v78
    v_exp_f32 v79, v79
    v_exp_f32 v16, v16
    v_exp_f32 v17, v17
    v_smfmac_f32_32x32x32_bf16 a[224:239], a[124:127], v[72:79], v5
    v_exp_f32 v18, v18
    v_exp_f32 v19, v19
    v_exp_f32 v20, v20
    v_mfma_f32_32x32x4_2b_bf16 v[48:79], a[38:39], v[90:91], 0
    s_add_u32 s52, s73, 0
    buffer_load_dwordx4 a[112:115], v4, s[36:39], s52 offen offset:0 sc1
    buffer_load_dwordx4 a[116:119], v4, s[36:39], s52 offen offset:1024 sc1
    buffer_load_dwordx4 a[120:123], v4, s[36:39], s52 offen offset:2048 sc1
    buffer_load_dwordx4 a[124:127], v4, s[36:39], s52 offen offset:3072 sc1
    v_exp_f32 v21, v21
    v_exp_f32 v22, v22
    v_exp_f32 v23, v23
    v_exp_f32 v24, v24
    v_exp_f32 v25, v25
    v_exp_f32 v26, v26
    v_exp_f32 v27, v27
    v_exp_f32 v28, v28
    v_smfmac_f32_32x32x32_bf16 a[208:223], a[128:131], v[16:23], v5
    v_exp_f32 v29, v29
    v_exp_f32 v30, v30
    v_exp_f32 v31, v31
    v_exp_f32 v32, v32
    v_exp_f32 v33, v33
    v_smfmac_f32_32x32x32_bf16 a[208:223], a[132:135], v[24:31], v5
    v_exp_f32 v34, v34
    v_exp_f32 v35, v35
    v_exp_f32 v36, v36
    v_exp_f32 v37, v37
    v_mfma_f32_32x32x16_bf16 v[48:63], a[30:33], v[86:89], v[48:63]
    v_exp_f32 v38, v38
    v_exp_f32 v39, v39
    v_exp_f32 v40, v40
    v_exp_f32 v41, v41
    v_smfmac_f32_32x32x32_bf16 a[208:223], a[136:139], v[32:39], v5
    v_exp_f32 v42, v42
    v_exp_f32 v43, v43
    v_exp_f32 v44, v44
    v_exp_f32 v45, v45
    v_mfma_f32_32x32x16_bf16 v[64:79], a[34:37], v[86:89], v[64:79]
    v_exp_f32 v46, v46
    v_exp_f32 v47, v47
    v_exp_f32 v48, v48
    v_exp_f32 v49, v49
    v_smfmac_f32_32x32x32_bf16 a[208:223], a[140:143], v[40:47], v5
    v_exp_f32 v50, v50
    v_exp_f32 v51, v51
    v_exp_f32 v52, v52
    v_mfma_f32_32x32x4_2b_bf16 v[16:47], a[48:49], v[84:85], 0
    s_add_u32 s52, s72, 48128
    buffer_load_dwordx4 a[28:31], v4, s[36:39], s52 offen offset:0 sc1
    buffer_load_dwordx4 a[32:35], v4, s[36:39], s52 offen offset:1024 sc1
    buffer_load_dwordx4 a[36:39], v4, s[36:39], s52 offen offset:2048 sc1
    v_exp_f32 v53, v53
    v_exp_f32 v54, v54
    v_exp_f32 v55, v55
    v_exp_f32 v56, v56
    v_exp_f32 v57, v57
    v_exp_f32 v58, v58
    v_exp_f32 v59, v59
    v_exp_f32 v60, v60
    v_smfmac_f32_32x32x32_bf16 a[224:239], a[128:131], v[48:55], v5
    v_exp_f32 v61, v61
    v_exp_f32 v62, v62
    v_exp_f32 v63, v63
    v_exp_f32 v64, v64
    v_exp_f32 v65, v65
    v_smfmac_f32_32x32x32_bf16 a[224:239], a[132:135], v[56:63], v5
    v_exp_f32 v66, v66
    v_exp_f32 v67, v67
    v_exp_f32 v68, v68
    v_exp_f32 v69, v69
    v_mfma_f32_32x32x16_bf16 v[16:31], a[40:43], v[80:83], v[16:31]
    v_exp_f32 v70, v70
    v_exp_f32 v71, v71
    v_exp_f32 v72, v72
    v_exp_f32 v73, v73
    v_smfmac_f32_32x32x32_bf16 a[224:239], a[136:139], v[64:71], v5
    v_exp_f32 v74, v74
    v_exp_f32 v75, v75
    v_exp_f32 v76, v76
    v_exp_f32 v77, v77
    v_mfma_f32_32x32x16_bf16 v[32:47], a[44:47], v[80:83], v[32:47]
    v_exp_f32 v78, v78
    v_exp_f32 v79, v79
    s_waitcnt vmcnt(32)
    v_exp_f32 v16, v16
    v_exp_f32 v17, v17
    v_smfmac_f32_32x32x32_bf16 a[224:239], a[140:143], v[72:79], v5
    v_exp_f32 v18, v18
    v_exp_f32 v19, v19
    v_exp_f32 v20, v20
    v_mfma_f32_32x32x4_2b_bf16 v[48:79], a[48:49], v[90:91], 0
    v_min_u32 v9, 31, v1
    v_lshlrev_b32 v9, 3, v9
    s_lshl_b32 s52, s28, 8
    s_add_u32 s52, s52, 20480
    buffer_load_dwordx2 v[92:93], v9, s[36:39], s52 offen sc1
    s_add_u32 s52, s73, 4096
    buffer_load_dwordx4 a[128:131], v4, s[36:39], s52 offen offset:0 sc1
    buffer_load_dwordx4 a[132:135], v4, s[36:39], s52 offen offset:1024 sc1
    buffer_load_dwordx4 a[136:139], v4, s[36:39], s52 offen offset:2048 sc1
    buffer_load_dwordx4 a[140:143], v4, s[36:39], s52 offen offset:3072 sc1
    v_exp_f32 v21, v21
    v_exp_f32 v22, v22
    v_exp_f32 v23, v23
    v_exp_f32 v24, v24
    v_exp_f32 v25, v25
    v_exp_f32 v26, v26
    v_exp_f32 v27, v27
    v_exp_f32 v28, v28
    v_smfmac_f32_32x32x32_bf16 a[208:223], a[144:147], v[16:23], v5
    v_exp_f32 v29, v29
    v_exp_f32 v30, v30
    v_exp_f32 v31, v31
    v_exp_f32 v32, v32
    v_exp_f32 v33, v33
    v_smfmac_f32_32x32x32_bf16 a[208:223], a[148:151], v[24:31], v5
    v_exp_f32 v34, v34
    v_exp_f32 v35, v35
    v_exp_f32 v36, v36
    v_exp_f32 v37, v37
    v_mfma_f32_32x32x16_bf16 v[48:63], a[40:43], v[86:89], v[48:63]
    v_exp_f32 v38, v38
    v_exp_f32 v39, v39
    v_exp_f32 v40, v40
    v_exp_f32 v41, v41
    v_smfmac_f32_32x32x32_bf16 a[208:223], a[152:155], v[32:39], v5
    v_exp_f32 v42, v42
    v_exp_f32 v43, v43
    v_exp_f32 v44, v44
    v_exp_f32 v45, v45
    v_mfma_f32_32x32x16_bf16 v[64:79], a[44:47], v[86:89], v[64:79]
    v_exp_f32 v46, v46
    v_exp_f32 v47, v47
    v_exp_f32 v48, v48
    v_exp_f32 v49, v49
    v_smfmac_f32_32x32x32_bf16 a[208:223], a[156:159], v[40:47], v5
    v_exp_f32 v50, v50
    v_exp_f32 v51, v51
    v_exp_f32 v52, v52
    v_mfma_f32_32x32x4_2b_bf16 v[16:47], a[58:59], v[84:85], 0
    s_add_u32 s52, s72, 51200
    buffer_load_dwordx4 a[40:43], v4, s[36:39], s52 offen offset:0 sc1
    buffer_load_dwordx4 a[44:47], v4, s[36:39], s52 offen offset:1024 sc1
    v_exp_f32 v53, v53
    v_exp_f32 v54, v54
    v_exp_f32 v55, v55
    v_exp_f32 v56, v56
    v_exp_f32 v57, v57
    v_exp_f32 v58, v58
    v_exp_f32 v59, v59
    v_exp_f32 v60, v60
    v_smfmac_f32_32x32x32_bf16 a[224:239], a[144:147], v[48:55], v5
    v_exp_f32 v61, v61
    v_exp_f32 v62, v62
    v_exp_f32 v63, v63
    v_exp_f32 v64, v64
    v_exp_f32 v65, v65
    v_smfmac_f32_32x32x32_bf16 a[224:239], a[148:151], v[56:63], v5
    v_exp_f32 v66, v66
    v_exp_f32 v67, v67
    v_exp_f32 v68, v68
    v_exp_f32 v69, v69
    v_mfma_f32_32x32x16_bf16 v[16:31], a[50:53], v[80:83], v[16:31]
    v_exp_f32 v70, v70
    v_exp_f32 v71, v71
    v_exp_f32 v72, v72
    v_exp_f32 v73, v73
    v_smfmac_f32_32x32x32_bf16 a[224:239], a[152:155], v[64:71], v5
    v_exp_f32 v74, v74
    v_exp_f32 v75, v75
    v_exp_f32 v76, v76
    v_exp_f32 v77, v77
    v_mfma_f32_32x32x16_bf16 v[32:47], a[54:57], v[80:83], v[32:47]
    v_exp_f32 v78, v78
    v_exp_f32 v79, v79
    v_exp_f32 v16, v16
    v_exp_f32 v17, v17
    v_smfmac_f32_32x32x32_bf16 a[224:239], a[156:159], v[72:79], v5
    v_exp_f32 v18, v18
    v_exp_f32 v19, v19
    v_exp_f32 v20, v20
    v_mfma_f32_32x32x4_2b_bf16 v[48:79], a[58:59], v[90:91], 0
    s_add_u32 s52, s73, 8192
    buffer_load_dwordx4 a[144:147], v4, s[36:39], s52 offen offset:0 sc1
    buffer_load_dwordx4 a[148:151], v4, s[36:39], s52 offen offset:1024 sc1
    buffer_load_dwordx4 a[152:155], v4, s[36:39], s52 offen offset:2048 sc1
    buffer_load_dwordx4 a[156:159], v4, s[36:39], s52 offen offset:3072 sc1
    v_exp_f32 v21, v21
    v_exp_f32 v22, v22
    v_exp_f32 v23, v23
    v_exp_f32 v24, v24
    v_exp_f32 v25, v25
    v_exp_f32 v26, v26
    v_exp_f32 v27, v27
    v_exp_f32 v28, v28
    v_smfmac_f32_32x32x32_bf16 a[208:223], a[160:163], v[16:23], v5
    v_exp_f32 v29, v29
    v_exp_f32 v30, v30
    v_exp_f32 v31, v31
    v_exp_f32 v32, v32
    v_exp_f32 v33, v33
    v_smfmac_f32_32x32x32_bf16 a[208:223], a[164:167], v[24:31], v5
    v_exp_f32 v34, v34
    v_exp_f32 v35, v35
    v_exp_f32 v36, v36
    v_exp_f32 v37, v37
    v_mfma_f32_32x32x16_bf16 v[48:63], a[50:53], v[86:89], v[48:63]
    v_exp_f32 v38, v38
    v_exp_f32 v39, v39
    v_exp_f32 v40, v40
    v_exp_f32 v41, v41
    v_smfmac_f32_32x32x32_bf16 a[208:223], a[168:171], v[32:39], v5
    v_exp_f32 v42, v42
    v_exp_f32 v43, v43
    v_exp_f32 v44, v44
    v_exp_f32 v45, v45
    v_mfma_f32_32x32x16_bf16 v[64:79], a[54:57], v[86:89], v[64:79]
    v_exp_f32 v46, v46
    v_exp_f32 v47, v47
    v_exp_f32 v48, v48
    v_exp_f32 v49, v49
    v_smfmac_f32_32x32x32_bf16 a[208:223], a[172:175], v[40:47], v5
    v_exp_f32 v50, v50
    v_exp_f32 v51, v51
    v_exp_f32 v52, v52
    v_mfma_f32_32x32x4_2b_bf16 v[16:47], a[68:69], v[84:85], 0
    s_waitcnt vmcnt(10)
    v_cmp_eq_u64 vcc, s[32:33], v[92:93]
    s_lshl_b32 s63, s28, 2
    s_add_u32 s63, s63, s30
    s_mul_i32 s63, s63, 20480
    s_add_u32 s64, s63, 1048576
    s_cmp_eq_u64 vcc, -1
    s_cselect_b32 s66, 1, 0
    s_cmp_lt_u32 s30, 2
    s_cselect_b32 s66, s66, 0
    s_cmp_eq_u32 s66, 0
    s_cbranch_scc1 L_nooa
    buffer_load_dwordx4 a[80:83], v4, s[36:39], s64 offen offset:0 sc1
    buffer_load_dwordx4 a[84:87], v4, s[36:39], s64 offen offset:1024 sc1
    buffer_load_dwordx4 a[88:91], v4, s[36:39], s64 offen offset:2048 sc1
    buffer_load_dwordx4 a[92:95], v4, s[36:39], s64 offen offset:3072 sc1
    s_add_u32 s64, s64, 4096
    buffer_load_dwordx4 a[96:99], v4, s[36:39], s64 offen offset:0 sc1
    buffer_load_dwordx4 a[100:103], v4, s[36:39], s64 offen offset:1024 sc1
    buffer_load_dwordx4 a[104:107], v4, s[36:39], s64 offen offset:2048 sc1
    buffer_load_dwordx4 a[108:111], v4, s[36:39], s64 offen offset:3072 sc1
L_nooa:
    s_add_u32 s52, s72, 53248
    buffer_load_dwordx4 a[48:51], v4, s[36:39], s52 offen offset:0 sc1
    buffer_load_dwordx4 a[52:55], v4, s[36:39], s52 offen offset:1024 sc1
    buffer_load_dwordx4 a[56:59], v4, s[36:39], s52 offen offset:2048 sc1
    v_exp_f32 v53, v53
    v_exp_f32 v54, v54
    v_exp_f32 v55, v55
    v_exp_f32 v56, v56
    v_exp_f32 v57, v57
    v_exp_f32 v58, v58
    v_exp_f32 v59, v59
    v_exp_f32 v60, v60
    v_smfmac_f32_32x32x32_bf16 a[224:239], a[160:163], v[48:55], v5
    v_exp_f32 v61, v61
    v_exp_f32 v62, v62
    v_exp_f32 v63, v63
    v_exp_f32 v64, v64
    v_exp_f32 v65, v65
    v_smfmac_f32_32x32x32_bf16 a[224:239], a[164:167], v[56:63], v5
    v_exp_f32 v66, v66
    v_exp_f32 v67, v67
    v_exp_f32 v68, v68
    v_exp_f32 v69, v69
    v_mfma_f32_32x32x16_bf16 v[16:31], a[60:63], v[80:83], v[16:31]
    v_exp_f32 v70, v70
    v_exp_f32 v71, v71
    v_exp_f32 v72, v72
    v_exp_f32 v73, v73
    v_smfmac_f32_32x32x32_bf16 a[224:239], a[168:171], v[64:71], v5
    v_exp_f32 v74, v74
    v_exp_f32 v75, v75
    v_exp_f32 v76, v76
    v_exp_f32 v77, v77
    v_mfma_f32_32x32x16_bf16 v[32:47], a[64:67], v[80:83], v[32:47]
    v_exp_f32 v78, v78
    v_exp_f32 v79, v79
    s_waitcnt vmcnt(32)
    v_exp_f32 v16, v16
    v_exp_f32 v17, v17
    v_smfmac_f32_32x32x32_bf16 a[224:239], a[172:175], v[72:79], v5
    v_exp_f32 v18, v18
    v_exp_f32 v19, v19
    v_exp_f32 v20, v20
    v_mfma_f32_32x32x4_2b_bf16 v[48:79], a[68:69], v[90:91], 0
    s_add_u32 s52, s73, 12288
    buffer_load_dwordx4 a[160:163], v4, s[36:39], s52 offen offset:0 sc1
    buffer_load_dwordx4 a[164:167], v4, s[36:39], s52 offen offset:1024 sc1
    buffer_load_dwordx4 a[168:171], v4, s[36:39], s52 offen offset:2048 sc1
    buffer_load_dwordx4 a[172:175], v4, s[36:39], s52 offen offset:3072 sc1
    v_exp_f32 v21, v21
    v_exp_f32 v22, v22
    v_exp_f32 v23, v23
    v_exp_f32 v24, v24
    v_exp_f32 v25, v25
    v_exp_f32 v26, v26
    v_exp_f32 v27, v27
    v_exp_f32 v28, v28
    v_smfmac_f32_32x32x32_bf16 a[208:223], a[176:179], v[16:23], v5
    v_exp_f32 v29, v29
    v_exp_f32 v30, v30
    v_exp_f32 v31, v31
    v_exp_f32 v32, v32
    v_exp_f32 v33, v33
    v_smfmac_f32_32x32x32_bf16 a[208:223], a[180:183], v[24:31], v5
    v_exp_f32 v34, v34
    v_exp_f32 v35, v35
    v_exp_f32 v36, v36
    v_exp_f32 v37, v37
    v_mfma_f32_32x32x16_bf16 v[48:63], a[60:63], v[86:89], v[48:63]
    v_exp_f32 v38, v38
    v_exp_f32 v39, v39
    v_exp_f32 v40, v40
    v_exp_f32 v41, v41
    v_smfmac_f32_32x32x32_bf16 a[208:223], a[184:187], v[32:39], v5
    v_exp_f32 v42, v42
    v_exp_f32 v43, v43
    v_exp_f32 v44, v44
    v_exp_f32 v45, v45
    v_mfma_f32_32x32x16_bf16 v[64:79], a[64:67], v[86:89], v[64:79]
    v_exp_f32 v46, v46
    v_exp_f32 v47, v47
    v_exp_f32 v48, v48
    v_exp_f32 v49, v49
    v_smfmac_f32_32x32x32_bf16 a[208:223], a[188:191], v[40:47], v5
    v_exp_f32 v50, v50
    v_exp_f32 v51, v51
    v_exp_f32 v52, v52
    v_mfma_f32_32x32x4_2b_bf16 v[16:47], a[78:79], v[84:85], 0
    s_add_u32 s52, s72, 56320
    buffer_load_dwordx4 a[60:63], v4, s[36:39], s52 offen offset:0 sc1
    buffer_load_dwordx4 a[64:67], v4, s[36:39], s52 offen offset:1024 sc1
    v_exp_f32 v53, v53
    v_exp_f32 v54, v54
    v_exp_f32 v55, v55
    v_exp_f32 v56, v56
    v_exp_f32 v57, v57
    v_exp_f32 v58, v58
    v_exp_f32 v59, v59
    v_exp_f32 v60, v60
    v_smfmac_f32_32x32x32_bf16 a[224:239], a[176:179], v[48:55], v5
    v_exp_f32 v61, v61
    v_exp_f32 v62, v62
    v_exp_f32 v63, v63
    v_exp_f32 v64, v64
    v_exp_f32 v65, v65
    v_smfmac_f32_32x32x32_bf16 a[224:239], a[180:183], v[56:63], v5
    v_exp_f32 v66, v66
    v_exp_f32 v67, v67
    v_exp_f32 v68, v68
    v_exp_f32 v69, v69
    v_mfma_f32_32x32x16_bf16 v[16:31], a[70:73], v[80:83], v[16:31]
    v_exp_f32 v70, v70
    v_exp_f32 v71, v71
    v_exp_f32 v72, v72
    v_exp_f32 v73, v73
    v_smfmac_f32_32x32x32_bf16 a[224:239], a[184:187], v[64:71], v5
    v_exp_f32 v74, v74
    v_exp_f32 v75, v75
    v_exp_f32 v76, v76
    v_exp_f32 v77, v77
    v_mfma_f32_32x32x16_bf16 v[32:47], a[74:77], v[80:83], v[32:47]
    v_exp_f32 v78, v78
    v_exp_f32 v79, v79
    v_exp_f32 v16, v16
    v_exp_f32 v17, v17
    v_smfmac_f32_32x32x32_bf16 a[224:239], a[188:191], v[72:79], v5
    v_exp_f32 v18, v18
    v_exp_f32 v19, v19
    v_exp_f32 v20, v20
    v_mfma_f32_32x32x4_2b_bf16 v[48:79], a[78:79], v[90:91], 0
    s_add_u32 s52, s73, 16384
    buffer_load_dwordx4 a[176:179], v4, s[36:39], s52 offen offset:0 sc1
    buffer_load_dwordx4 a[180:183], v4, s[36:39], s52 offen offset:1024 sc1
    buffer_load_dwordx4 a[184:187], v4, s[36:39], s52 offen offset:2048 sc1
    buffer_load_dwordx4 a[188:191], v4, s[36:39], s52 offen offset:3072 sc1
    v_exp_f32 v21, v21
    v_exp_f32 v22, v22
    v_exp_f32 v23, v23
    v_exp_f32 v24, v24
    v_exp_f32 v25, v25
    v_exp_f32 v26, v26
    v_exp_f32 v27, v27
    v_exp_f32 v28, v28
    v_smfmac_f32_32x32x32_bf16 a[208:223], a[192:195], v[16:23], v5
    v_exp_f32 v29, v29
    v_exp_f32 v30, v30
    v_exp_f32 v31, v31
    v_exp_f32 v32, v32
    v_exp_f32 v33, v33
    v_smfmac_f32_32x32x32_bf16 a[208:223], a[196:199], v[24:31], v5
    v_exp_f32 v34, v34
    v_exp_f32 v35, v35
    v_exp_f32 v36, v36
    v_exp_f32 v37, v37
    v_mfma_f32_32x32x16_bf16 v[48:63], a[70:73], v[86:89], v[48:63]
    v_exp_f32 v38, v38
    v_exp_f32 v39, v39
    v_exp_f32 v40, v40
    v_exp_f32 v41, v41
    v_smfmac_f32_32x32x32_bf16 a[208:223], a[200:203], v[32:39], v5
    v_exp_f32 v42, v42
    v_exp_f32 v43, v43
    v_exp_f32 v44, v44
    v_exp_f32 v45, v45
    v_mfma_f32_32x32x16_bf16 v[64:79], a[74:77], v[86:89], v[64:79]
    v_exp_f32 v46, v46
    v_exp_f32 v47, v47
    v_exp_f32 v48, v48
    v_exp_f32 v49, v49
    v_smfmac_f32_32x32x32_bf16 a[208:223], a[204:207], v[40:47], v5
    v_exp_f32 v50, v50
    v_exp_f32 v51, v51
    v_exp_f32 v52, v52
    s_add_u32 s52, s72, 58368
    buffer_load_dwordx4 a[68:71], v4, s[36:39], s52 offen offset:0 sc1
    buffer_load_dwordx4 a[72:75], v4, s[36:39], s52 offen offset:1024 sc1
    buffer_load_dwordx4 a[76:79], v4, s[36:39], s52 offen offset:2048 sc1
    v_exp_f32 v53, v53
    v_exp_f32 v54, v54
    v_exp_f32 v55, v55
    v_exp_f32 v56, v56
    v_exp_f32 v57, v57
    v_exp_f32 v58, v58
    v_exp_f32 v59, v59
    v_exp_f32 v60, v60
    v_smfmac_f32_32x32x32_bf16 a[224:239], a[192:195], v[48:55], v5
    v_exp_f32 v61, v61
    v_exp_f32 v62, v62
    v_exp_f32 v63, v63
    v_exp_f32 v64, v64
    v_exp_f32 v65, v65
    ds_write_b128 v6, a[208:211] offset:6144
    ds_write_b128 v6, a[212:215] offset:7168
    ds_write_b128 v6, a[216:219] offset:8192
    v_smfmac_f32_32x32x32_bf16 a[224:239], a[196:199], v[56:63], v5
    v_exp_f32 v66, v66
    v_exp_f32 v67, v67
    v_exp_f32 v68, v68
    v_exp_f32 v69, v69
    v_exp_f32 v70, v70
    v_exp_f32 v71, v71
    v_exp_f32 v72, v72
    v_exp_f32 v73, v73
    v_smfmac_f32_32x32x32_bf16 a[224:239], a[200:203], v[64:71], v5
    v_exp_f32 v74, v74
    v_exp_f32 v75, v75
    v_exp_f32 v76, v76
    v_exp_f32 v77, v77
    v_exp_f32 v78, v78
    v_exp_f32 v79, v79
    s_nop 1
    v_smfmac_f32_32x32x32_bf16 a[224:239], a[204:207], v[72:79], v5
    s_nop 2
    s_andn2_b32 s60, s69, 255
    v_min_u32 v11, 31, v1
    v_lshlrev_b32 v11, 3, v11
    s_lshl_b32 s59, s28, 8
    s_cmp_lt_u32 s30, 2
    s_cselect_b32 s61, 5, 7
    s_lshl_b32 s61, s61, 12
    s_add_u32 s59, s59, s61
    s_lshl_b32 s65, s28, 5
    s_lshl_b32 s52, s29, 2
    s_add_u32 s65, s65, s52
    s_add_u32 s65, s65, s30
    s_lshl_b32 s65, s65, 3
    s_add_u32 s65, s65, 28672
    ds_write_b128 v6, a[224:227] offset:9216
    ds_write_b128 v6, a[228:231] offset:10240
    ds_write_b128 v6, a[232:235] offset:11264
    v_mov_b32 v6, v11
    v_mov_b32 v5, v10
    s_waitcnt lgkmcnt(0)
    s_barrier
    ds_read_b128 v[16:19], v13 offset:0
    ds_read_b128 v[20:23], v13 offset:1024
    ds_read_b128 v[24:27], v13 offset:2048
    ds_read_b128 v[28:31], v13 offset:12288
    ds_read_b128 v[32:35], v13 offset:13312
    ds_read_b128 v[36:39], v13 offset:14336
    ds_read_b128 v[40:43], v13 offset:24576
    ds_read_b128 v[44:47], v13 offset:25600
    ds_read_b128 v[48:51], v13 offset:26624
    ds_read_b128 v[52:55], v13 offset:36864
    ds_read_b128 v[56:59], v13 offset:37888
    ds_read_b128 v[60:63], v13 offset:38912
    v_and_b32 v7, 127, v0
    v_add_u32 v8, 256, v7
    v_min_u32 v8, 319, v8
    v_lshlrev_b32 v8, 4, v8
    v_lshlrev_b32 v7, 4, v7
    v_min_u32 v9, 59, v1
    v_mul_u32_u24 v10, 3277, v9
    v_lshrrev_b32 v10, 16, v10
    v_mul_u32_u24 v11, 300, v10
    v_cmp_eq_u32 s[86:87], 2, v10
    v_add_u32 v11, v11, v9
    v_subrev_u32 v95, 160, v11
    s_mul_i32 s52, s29, 20
    s_add_u32 s52, s52, 320
    v_cndmask_b32 v11, v11, v95, s[86:87]
    v_add_u32 v11, s52, v11
    v_lshlrev_b32 v11, 4, v11
    s_mov_b32 s61, 11776
    s_mov_b32 s62, 4096
    s_waitcnt lgkmcnt(0)
    v_pk_add_f32 v[16:17], v[16:17], v[28:29]
    v_pk_add_f32 v[40:41], v[40:41], v[52:53]
    v_pk_add_f32 v[18:19], v[18:19], v[30:31]
    v_pk_add_f32 v[42:43], v[42:43], v[54:55]
    v_pk_add_f32 v[20:21], v[20:21], v[32:33]
    v_pk_add_f32 v[44:45], v[44:45], v[56:57]
    v_pk_add_f32 v[22:23], v[22:23], v[34:35]
    v_pk_add_f32 v[46:47], v[46:47], v[58:59]
    v_pk_add_f32 v[24:25], v[24:25], v[36:37]
    v_pk_add_f32 v[48:49], v[48:49], v[60:61]
    v_pk_add_f32 v[26:27], v[26:27], v[38:39]
    v_pk_add_f32 v[50:51], v[50:51], v[62:63]
    v_pk_add_f32 v[16:17], v[16:17], v[40:41]
    v_pk_add_f32 v[18:19], v[18:19], v[42:43]
    v_pk_add_f32 v[20:21], v[20:21], v[44:45]
    v_pk_add_f32 v[22:23], v[22:23], v[46:47]
    v_pk_add_f32 v[24:25], v[24:25], v[48:49]
    v_pk_add_f32 v[26:27], v[26:27], v[50:51]
    v_mov_b32 v29, v24
    v_mov_b32 v28, v24
    v_mov_b32 v30, 0
    s_mov_b32 s52, 0x35800000
    v_permlane32_swap_b32 v29, v28
    v_fmac_f32 v30, 0, v16
    v_fmac_f32 v30, 0, v17
    v_fmac_f32 v30, 0, v18
    v_fmac_f32 v30, 0, v19
    v_fmac_f32 v30, 0, v20
    v_fmac_f32 v30, 0, v21
    v_fmac_f32 v30, 0, v22
    v_fmac_f32 v30, 0, v23
    v_fmac_f32 v30, 0, v24
    v_fmac_f32 v30, 0, v25
    v_fmac_f32 v30, 0, v26
    v_fmac_f32 v30, 0, v27
    s_mov_b32 s53, 0x5d800000
    v_cmp_le_f32 vcc, s52, v28
    v_cmp_ge_f32 s[54:55], s53, v28
    s_and_b64 vcc, vcc, s[54:55]
    v_cmp_eq_f32 s[54:55], 0, v30
    s_and_b64 vcc, vcc, s[54:55]
    s_cmp_eq_u64 vcc, -1
    s_cselect_b32 s52, 0, 2
    s_or_b32 s79, s79, s52
    s_cmp_lg_u32 s52, 0
    s_cbranch_scc1 L_adaLN_cond__grouped_kv_mqa__dense_activation_silu__prompt_kernel_unsafe_31
    s_mov_b32 s52, 40960
    v_rcp_f32 v28, v28
    s_add_u32 s53, s52, s69
    s_add_u32 s52, s52, s68
    s_nop 0
    v_pk_mul_f32 v[16:17], v[16:17], v[28:29] op_sel_hi:[1,0]
    v_pk_mul_f32 v[18:19], v[18:19], v[28:29] op_sel_hi:[1,0]
    v_pk_mul_f32 v[20:21], v[20:21], v[28:29] op_sel_hi:[1,0]
    v_pk_mul_f32 v[22:23], v[22:23], v[28:29] op_sel_hi:[1,0]
    v_pk_mul_f32 v[24:25], v[24:25], v[28:29] op_sel_hi:[1,0]
    v_pk_mul_f32 v[26:27], v[26:27], v[28:29] op_sel_hi:[1,0]
    v_cvt_pk_bf16_f32 v16, v16, v17
    v_cvt_pk_bf16_f32 v17, v18, v19
    v_cvt_pk_bf16_f32 v18, v20, v21
    v_cvt_pk_bf16_f32 v19, v22, v23
    v_cvt_pk_bf16_f32 v20, v24, v25
    v_cvt_pk_bf16_f32 v21, v26, v27
    s_cmp_eq_u32 s92, 0
    s_cbranch_scc1 L_adaLN_cond__grouped_kv_mqa__dense_activation_silu__prompt_kernel_wt_32
    buffer_store_dwordx4 v[16:19], v12, s[36:39], s52 offen
    s_mov_b32 exec_hi, 0
    buffer_store_dwordx2 v[20:21], v12, s[36:39], s53 offen
    s_branch L_adaLN_cond__grouped_kv_mqa__dense_activation_silu__prompt_kernel_wd_33
L_adaLN_cond__grouped_kv_mqa__dense_activation_silu__prompt_kernel_wt_32:
    buffer_store_dwordx4 v[16:19], v12, s[36:39], s52 offen sc1
    s_mov_b32 exec_hi, 0
    buffer_store_dwordx2 v[20:21], v12, s[36:39], s53 offen sc1
L_adaLN_cond__grouped_kv_mqa__dense_activation_silu__prompt_kernel_wd_33:
    s_mov_b32 exec_hi, -1
L_adaLN_cond__grouped_kv_mqa__dense_activation_silu__prompt_kernel_unsafe_31:
L_slowchk:
    s_cmp_eq_u32 s79, 0
    s_cbranch_scc0 L_slow
    s_cmp_lt_u32 s30, 2
    s_cbranch_scc1 L_nogl
    s_waitcnt vmcnt(59)
    buffer_load_dwordx4 v[64:67], v7, s[36:39], s61 offen offset:0 sc1
    buffer_load_dwordx4 v[68:71], v7, s[36:39], s61 offen offset:2048 sc1
    buffer_load_dwordx4 v[72:75], v8, s[36:39], s61 offen offset:0 sc1
    buffer_load_dwordx4 v[76:79], v11, s[36:39], s62 offen offset:0 sc1
    s_waitcnt vmcnt(4)
    s_branch L_gld
L_nogl:
    s_waitcnt vmcnt(0)
L_gld:
    v_mov_b32 v16, s32
    v_mov_b32 v17, s33
    v_mov_b32 v18, 0
    s_mov_b64 exec, 1
    s_cmp_eq_u32 s92, 0
    s_cbranch_scc1 L_adaLN_cond__grouped_kv_mqa__dense_activation_silu__prompt_kernel_wt_34
    buffer_store_dwordx2 v[16:17], v18, s[36:39], s65 offen
    s_branch L_adaLN_cond__grouped_kv_mqa__dense_activation_silu__prompt_kernel_wd_35
L_adaLN_cond__grouped_kv_mqa__dense_activation_silu__prompt_kernel_wt_34:
    buffer_store_dwordx2 v[16:17], v18, s[36:39], s65 offen sc1
    s_mov_b64 exec, -1
    v_mul_u32_u24 v16, 16385, v1
    v_lshrrev_b32 v16, 16, v16
    v_mul_u32_u24 v17, 4, v16
    v_sub_u32 v17, v1, v17
    v_mul_u32_u24 v16, 20480, v16
    v_lshl_add_u32 v16, v17, 7, v16
    s_mov_b32 exec_lo, 0xffff
    s_mov_b32 exec_hi, 0x0
    buffer_load_dword v14, v16, s[36:39], s68 offen sc1
    s_mov_b64 exec, -1
    v_mul_u32_u24 v16, 32769, v1
    v_lshrrev_b32 v16, 16, v16
    v_mul_u32_u24 v17, 2, v16
    v_sub_u32 v17, v1, v17
    v_mul_u32_u24 v16, 20480, v16
    v_lshl_add_u32 v16, v17, 7, v16
    s_mov_b32 exec_lo, 0xff
    s_mov_b32 exec_hi, 0x0
    buffer_load_dword v14, v16, s[36:39], s60 offen sc1
L_adaLN_cond__grouped_kv_mqa__dense_activation_silu__prompt_kernel_wd_35:
    s_mov_b64 exec, -1
    v_add_u32 v95, 65536, v4
    s_barrier
    s_cmp_ge_u32 s30, 2
    s_cbranch_scc1 L_olate
    v_lshlrev_b32 v7, 4, v3
    s_cmp_lg_u32 s66, 0
    s_cbranch_scc1 L_oearly
    s_mov_b32 s58, 8388608
L_adaLN_cond__grouped_kv_mqa__dense_activation_silu__prompt_kernel_poa_36:
    buffer_load_dwordx2 v[40:41], v6, s[36:39], s59 offen offset:0 sc1
    s_sub_u32 s58, s58, 1
    s_cbranch_scc1 L_adaLN_cond__grouped_kv_mqa__dense_activation_silu__prompt_kernel_poad_38
    s_waitcnt vmcnt(0)
L_adaLN_cond__grouped_kv_mqa__dense_activation_silu__prompt_kernel_poac_37:
    v_cmp_ne_u64 vcc, s[32:33], v[40:41]
    s_cbranch_vccz L_adaLN_cond__grouped_kv_mqa__dense_activation_silu__prompt_kernel_poad_38
    s_sleep 1
    s_branch L_adaLN_cond__grouped_kv_mqa__dense_activation_silu__prompt_kernel_poa_36
L_adaLN_cond__grouped_kv_mqa__dense_activation_silu__prompt_kernel_poad_38:
    buffer_load_dwordx4 a[80:83], v4, s[36:39], s64 offen offset:0 sc1
    buffer_load_dwordx4 a[84:87], v4, s[36:39], s64 offen offset:1024 sc1
    buffer_load_dwordx4 a[88:91], v4, s[36:39], s64 offen offset:2048 sc1
    buffer_load_dwordx4 a[92:95], v4, s[36:39], s64 offen offset:3072 sc1
    s_add_u32 s64, s64, 4096
    buffer_load_dwordx4 a[96:99], v4, s[36:39], s64 offen offset:0 sc1
    buffer_load_dwordx4 a[100:103], v4, s[36:39], s64 offen offset:1024 sc1
    buffer_load_dwordx4 a[104:107], v4, s[36:39], s64 offen offset:2048 sc1
    buffer_load_dwordx4 a[108:111], v4, s[36:39], s64 offen offset:3072 sc1
    s_branch L_oearly
L_olate:
    s_mov_b32 s58, 8388608
    s_waitcnt vmcnt(1)
    s_branch L_adaLN_cond__grouped_kv_mqa__dense_activation_silu__prompt_kernel_pmodbc_40
L_adaLN_cond__grouped_kv_mqa__dense_activation_silu__prompt_kernel_pmodb_39:
    buffer_load_dwordx4 v[64:67], v7, s[36:39], s61 offen offset:0 sc1
    buffer_load_dwordx4 v[68:71], v7, s[36:39], s61 offen offset:2048 sc1
    buffer_load_dwordx4 v[72:75], v8, s[36:39], s61 offen offset:0 sc1
    buffer_load_dwordx4 v[76:79], v11, s[36:39], s62 offen offset:0 sc1
    s_sub_u32 s58, s58, 1
    s_cbranch_scc1 L_adaLN_cond__grouped_kv_mqa__dense_activation_silu__prompt_kernel_pmodbd_41
    s_waitcnt vmcnt(0)
L_adaLN_cond__grouped_kv_mqa__dense_activation_silu__prompt_kernel_pmodbc_40:
    v_cmp_ne_u64 vcc, s[32:33], v[66:67]
    v_cmp_ne_u64 s[56:57], s[32:33], v[70:71]
    s_or_b64 vcc, vcc, s[56:57]
    v_cmp_ne_u64 s[56:57], s[32:33], v[74:75]
    s_or_b64 vcc, vcc, s[56:57]
    v_cmp_ne_u64 s[56:57], s[32:33], v[78:79]
    s_or_b64 vcc, vcc, s[56:57]
    s_cbranch_vccz L_adaLN_cond__grouped_kv_mqa__dense_activation_silu__prompt_kernel_pmodbd_41
    s_sleep 1
    s_branch L_adaLN_cond__grouped_kv_mqa__dense_activation_silu__prompt_kernel_pmodb_39
L_adaLN_cond__grouped_kv_mqa__dense_activation_silu__prompt_kernel_pmodbd_41:
    v_cmp_le_u32 vcc, 512, v7
    v_lshlrev_b32 v16, 16, v68
    v_and_b32 v17, s91, v68
    v_lshlrev_b32 v18, 16, v69
    v_and_b32 v19, s91, v69
    v_lshlrev_b32 v20, 16, v72
    v_and_b32 v21, s91, v72
    v_lshlrev_b32 v22, 16, v73
    v_and_b32 v23, s91, v73
    v_lshlrev_b32 v24, 16, v76
    v_and_b32 v25, s91, v76
    v_lshlrev_b32 v26, 16, v77
    v_and_b32 v27, s91, v77
    v_pk_add_f32 v[16:17], v[16:17], 1.0 op_sel_hi:[1,0]
    v_pk_add_f32 v[18:19], v[18:19], 1.0 op_sel_hi:[1,0]
    v_pk_add_f32 v[20:21], v[20:21], 1.0 op_sel_hi:[1,0]
    v_pk_add_f32 v[22:23], v[22:23], 1.0 op_sel_hi:[1,0]
    v_pk_add_f32 v[28:29], v[24:25], 1.0 op_sel_hi:[1,0]
    v_pk_add_f32 v[30:31], v[26:27], 1.0 op_sel_hi:[1,0]
    v_cvt_pk_bf16_f32 v16, v16, v17
    v_cvt_pk_bf16_f32 v17, v18, v19
    v_cvt_pk_bf16_f32 v18, v20, v21
    v_cvt_pk_bf16_f32 v19, v22, v23
    v_cvt_pk_bf16_f32 v20, v28, v29
    v_cvt_pk_bf16_f32 v21, v30, v31
    v_cndmask_b32 v16, v68, v16, vcc
    v_cndmask_b32 v17, v69, v17, vcc
    v_lshrrev_b32 v7, 1, v7
    v_add_u32 v12, 154880, v7
    ds_write_b64 v12, v[64:65]
    v_add_u32 v13, 1024, v12
    v_add_u32 v7, 153344, v7
    v_cndmask_b32 v7, v13, v7, vcc
    v_lshrrev_b32 v8, 1, v8
    v_add_u32 v8, 152320, v8
    ds_write_b64 v7, v[16:17]
    ds_write_b64 v8, v[18:19]
    v_cmp_eq_u32 vcc, 1, v10
    v_mov_b32 v12, 0xbf317218
    v_cndmask_b32 v12, 1.0, v12, s[86:87]
    v_cndmask_b32 v20, v76, v20, vcc
    v_cndmask_b32 v21, v77, v21, vcc
    v_lshlrev_b32 v24, 16, v20
    v_and_b32 v25, s91, v20
    v_lshlrev_b32 v26, 16, v21
    v_and_b32 v27, s91, v21
    v_mul_f32 v24, v12, v24
    v_mul_f32 v25, v12, v25
    v_mul_f32 v26, v12, v26
    v_mul_f32 v27, v12, v27
    v_lshlrev_b32 v9, 4, v9
    v_add_u32 v9, 156160, v9
    ds_write_b128 v9, v[24:27]
    v_lshlrev_b32 v7, 4, v3
    s_waitcnt lgkmcnt(0)
    s_barrier
    v_min_u32 v11, 1, v2
    v_mul_u32_u24 v11, 1280, v11
    v_add_u32 v11, v11, v7
    v_add_u32 v11, 153600, v11
    ds_read_b128 v[16:19], v11 offset:0
    ds_read_b128 v[20:23], v11 offset:64
    s_waitcnt lgkmcnt(1)
    v_mfma_f32_16x16x32_bf16 v[28:31], v[96:99], v[16:19], 0
    ds_read_b128 v[24:27], v11 offset:128
    v_mfma_f32_16x16x32_bf16 v[32:35], v[100:103], v[16:19], 0
    v_mfma_f32_16x16x32_bf16 v[36:39], v[104:107], v[16:19], 0
    s_waitcnt lgkmcnt(1)
    v_mfma_f32_16x16x32_bf16 v[28:31], v[108:111], v[20:23], v[28:31]
    ds_read_b128 v[16:19], v11 offset:192
    v_mfma_f32_16x16x32_bf16 v[32:35], v[112:115], v[20:23], v[32:35]
    v_mfma_f32_16x16x32_bf16 v[36:39], v[116:119], v[20:23], v[36:39]
    s_waitcnt lgkmcnt(1)
    v_mfma_f32_16x16x32_bf16 v[28:31], v[120:123], v[24:27], v[28:31]
    ds_read_b128 v[20:23], v11 offset:256
    v_mfma_f32_16x16x32_bf16 v[32:35], v[124:127], v[24:27], v[32:35]
    v_mfma_f32_16x16x32_bf16 v[36:39], v[128:131], v[24:27], v[36:39]
    s_waitcnt lgkmcnt(1)
    v_mfma_f32_16x16x32_bf16 v[28:31], v[132:135], v[16:19], v[28:31]
    ds_read_b128 v[24:27], v11 offset:320
    v_mfma_f32_16x16x32_bf16 v[32:35], v[136:139], v[16:19], v[32:35]
    buffer_load_dwordx2 v[40:41], v6, s[36:39], s59 offen offset:0 sc1
    v_mfma_f32_16x16x32_bf16 v[36:39], v[140:143], v[16:19], v[36:39]
    s_waitcnt lgkmcnt(1)
    v_mfma_f32_16x16x32_bf16 v[28:31], v[144:147], v[20:23], v[28:31]
    ds_read_b128 v[16:19], v11 offset:384
    v_mfma_f32_16x16x32_bf16 v[32:35], v[148:151], v[20:23], v[32:35]
    v_mfma_f32_16x16x32_bf16 v[36:39], v[152:155], v[20:23], v[36:39]
    s_waitcnt lgkmcnt(1)
    v_mfma_f32_16x16x32_bf16 v[28:31], v[156:159], v[24:27], v[28:31]
    ds_read_b128 v[20:23], v11 offset:448
    v_mfma_f32_16x16x32_bf16 v[32:35], v[160:163], v[24:27], v[32:35]
    v_mfma_f32_16x16x32_bf16 v[36:39], v[164:167], v[24:27], v[36:39]
    s_waitcnt lgkmcnt(1)
    v_mfma_f32_16x16x32_bf16 v[28:31], v[168:171], v[16:19], v[28:31]
    v_mfma_f32_16x16x32_bf16 v[32:35], v[172:175], v[16:19], v[32:35]
    v_mfma_f32_16x16x32_bf16 v[36:39], v[176:179], v[16:19], v[36:39]
    s_waitcnt lgkmcnt(0)
    v_mfma_f32_16x16x32_bf16 v[28:31], v[180:183], v[20:23], v[28:31]
    v_mfma_f32_16x16x32_bf16 v[32:35], v[184:187], v[20:23], v[32:35]
    v_mfma_f32_16x16x32_bf16 v[36:39], v[188:191], v[20:23], v[36:39]
    s_mov_b32 s58, 8388608
    s_waitcnt vmcnt(0)
    s_branch L_adaLN_cond__grouped_kv_mqa__dense_activation_silu__prompt_kernel_pobc_43
L_adaLN_cond__grouped_kv_mqa__dense_activation_silu__prompt_kernel_pob_42:
    buffer_load_dwordx2 v[40:41], v6, s[36:39], s59 offen offset:0 sc1
    s_sub_u32 s58, s58, 1
    s_cbranch_scc1 L_adaLN_cond__grouped_kv_mqa__dense_activation_silu__prompt_kernel_pobd_44
    s_waitcnt vmcnt(0)
L_adaLN_cond__grouped_kv_mqa__dense_activation_silu__prompt_kernel_pobc_43:
    v_cmp_ne_u64 vcc, s[32:33], v[40:41]
    s_cbranch_vccz L_adaLN_cond__grouped_kv_mqa__dense_activation_silu__prompt_kernel_pobd_44
    s_sleep 1
    s_branch L_adaLN_cond__grouped_kv_mqa__dense_activation_silu__prompt_kernel_pob_42
L_adaLN_cond__grouped_kv_mqa__dense_activation_silu__prompt_kernel_pobd_44:
    buffer_load_dwordx4 a[80:83], v4, s[36:39], s64 offen offset:0 sc1
    buffer_load_dwordx4 a[84:87], v4, s[36:39], s64 offen offset:1024 sc1
    ds_read_b128 v[24:27], v11 offset:512
    ds_read_b128 v[16:19], v11 offset:576
    s_waitcnt lgkmcnt(1)
    v_mfma_f32_16x16x32_bf16 v[28:31], v[192:195], v[24:27], v[28:31]
    ds_read_b128 v[20:23], v11 offset:640
    v_mfma_f32_16x16x32_bf16 v[32:35], v[196:199], v[24:27], v[32:35]
    buffer_load_dwordx4 a[88:91], v4, s[36:39], s64 offen offset:2048 sc1
    v_mfma_f32_16x16x32_bf16 v[36:39], v[200:203], v[24:27], v[36:39]
    s_waitcnt lgkmcnt(1)
    v_mfma_f32_16x16x32_bf16 v[28:31], v[204:207], v[16:19], v[28:31]
    ds_read_b128 v[24:27], v11 offset:704
    v_mfma_f32_16x16x32_bf16 v[32:35], v[208:211], v[16:19], v[32:35]
    buffer_load_dwordx4 a[92:95], v4, s[36:39], s64 offen offset:3072 sc1
    v_mfma_f32_16x16x32_bf16 v[36:39], v[212:215], v[16:19], v[36:39]
    s_waitcnt lgkmcnt(1)
    v_mfma_f32_16x16x32_bf16 v[28:31], v[216:219], v[20:23], v[28:31]
    ds_read_b128 v[16:19], v11 offset:768
    v_mfma_f32_16x16x32_bf16 v[32:35], v[220:223], v[20:23], v[32:35]
    s_add_u32 s64, s64, 4096
    buffer_load_dwordx4 a[96:99], v4, s[36:39], s64 offen offset:0 sc1
    v_mfma_f32_16x16x32_bf16 v[36:39], v[224:227], v[20:23], v[36:39]
    s_waitcnt lgkmcnt(1)
    v_mfma_f32_16x16x32_bf16 v[28:31], v[228:231], v[24:27], v[28:31]
    ds_read_b128 v[20:23], v11 offset:832
    v_mfma_f32_16x16x32_bf16 v[32:35], v[232:235], v[24:27], v[32:35]
    buffer_load_dwordx4 a[100:103], v4, s[36:39], s64 offen offset:1024 sc1
    v_mfma_f32_16x16x32_bf16 v[36:39], v[236:239], v[24:27], v[36:39]
    s_waitcnt lgkmcnt(1)
    v_mfma_f32_16x16x32_bf16 v[28:31], v[240:243], v[16:19], v[28:31]
    ds_read_b128 v[24:27], v11 offset:896
    v_mfma_f32_16x16x32_bf16 v[32:35], v[244:247], v[16:19], v[32:35]
    buffer_load_dwordx4 a[104:107], v4, s[36:39], s64 offen offset:2048 sc1
    v_mfma_f32_16x16x32_bf16 v[36:39], v[248:251], v[16:19], v[36:39]
    s_waitcnt lgkmcnt(1)
    v_mfma_f32_16x16x32_bf16 v[28:31], v[252:255], v[20:23], v[28:31]
    ds_read_b128 v[16:19], v11 offset:960
    v_mfma_f32_16x16x32_bf16 v[32:35], a[0:3], v[20:23], v[32:35]
    buffer_load_dwordx4 a[108:111], v4, s[36:39], s64 offen offset:3072 sc1
    v_mfma_f32_16x16x32_bf16 v[36:39], a[4:7], v[20:23], v[36:39]
    s_waitcnt lgkmcnt(1)
    v_mfma_f32_16x16x32_bf16 v[28:31], a[8:11], v[24:27], v[28:31]
    ds_read_b128 v[20:23], v11 offset:1024
    v_mfma_f32_16x16x32_bf16 v[32:35], a[12:15], v[24:27], v[32:35]
    v_mfma_f32_16x16x32_bf16 v[36:39], a[16:19], v[24:27], v[36:39]
    s_waitcnt lgkmcnt(1)
    v_mfma_f32_16x16x32_bf16 v[28:31], a[20:23], v[16:19], v[28:31]
    ds_read_b128 v[24:27], v11 offset:1088
    v_mfma_f32_16x16x32_bf16 v[32:35], a[24:27], v[16:19], v[32:35]
    v_mfma_f32_16x16x32_bf16 v[36:39], a[28:31], v[16:19], v[36:39]
    s_waitcnt lgkmcnt(1)
    v_mfma_f32_16x16x32_bf16 v[28:31], a[32:35], v[20:23], v[28:31]
    ds_read_b128 v[16:19], v11 offset:1152
    v_mfma_f32_16x16x32_bf16 v[32:35], a[36:39], v[20:23], v[32:35]
    v_mfma_f32_16x16x32_bf16 v[36:39], a[40:43], v[20:23], v[36:39]
    s_waitcnt lgkmcnt(1)
    v_mfma_f32_16x16x32_bf16 v[28:31], a[44:47], v[24:27], v[28:31]
    ds_read_b128 v[20:23], v11 offset:1216
    v_mfma_f32_16x16x32_bf16 v[32:35], a[48:51], v[24:27], v[32:35]
    v_mfma_f32_16x16x32_bf16 v[36:39], a[52:55], v[24:27], v[36:39]
    s_waitcnt lgkmcnt(1)
    v_mfma_f32_16x16x32_bf16 v[28:31], a[56:59], v[16:19], v[28:31]
    v_mfma_f32_16x16x32_bf16 v[32:35], a[60:63], v[16:19], v[32:35]
    v_mfma_f32_16x16x32_bf16 v[36:39], a[64:67], v[16:19], v[36:39]
    s_waitcnt lgkmcnt(0)
    v_mfma_f32_16x16x32_bf16 v[28:31], a[68:71], v[20:23], v[28:31]
    v_mfma_f32_16x16x32_bf16 v[32:35], a[72:75], v[20:23], v[32:35]
    v_mfma_f32_16x16x32_bf16 v[36:39], a[76:79], v[20:23], v[36:39]
    s_mul_i32 s53, s30, 384
    s_add_u32 s53, s53, 157120
    v_min_u32 v13, 1, v2
    v_mul_u32_u24 v13, 192, v13
    v_add3_u32 v13, v13, v7, s53
    v_cmp_eq_u32 vcc, 1, v2
    v_mov_b32 v12, 0xbfb8aa3b
    s_nop 0
    v_cndmask_b32 v12, 1.0, v12, vcc
    s_nop 0
    v_mul_f32 v28, v12, v28
    v_mul_f32 v29, v12, v29
    v_mul_f32 v30, v12, v30
    v_mul_f32 v31, v12, v31
    v_mul_f32 v32, v12, v32
    v_mul_f32 v33, v12, v33
    v_mul_f32 v34, v12, v34
    v_mul_f32 v35, v12, v35
    v_mul_f32 v36, v12, v36
    v_mul_f32 v37, v12, v37
    v_mul_f32 v38, v12, v38
    v_mul_f32 v39, v12, v39
    s_mov_b32 exec_lo, 196611
    s_mov_b32 exec_hi, 196611
    ds_write_b128 v13, v[28:31] offset:0
    ds_write_b128 v13, v[32:35] offset:64
    ds_write_b128 v13, v[36:39] offset:128
    s_mov_b64 exec, -1
    s_waitcnt lgkmcnt(0)
L_oearly:
    v_mov_b32 v8, v95
    v_add_u32 v9, 156160, v7
    ds_read_b128 v[36:39], v4 offset:0
    ds_read_b128 v[40:43], v4 offset:1024
    ds_read_b128 v[44:47], v4 offset:2048
    ds_read_b128 v[48:51], v4 offset:3072
    ds_read_b128 v[52:55], v4 offset:4096
    ds_read_b128 v[56:59], v4 offset:5120
    ds_read_b128 v[60:63], v4 offset:6144
    ds_read_b128 v[64:67], v4 offset:7168
    s_waitcnt lgkmcnt(5)
    s_waitcnt vmcnt(6)
    v_mfma_f32_16x16x32_bf16 v[16:19], v[36:39], a[80:83], 0
    ds_read_b128 v[68:71], v4 offset:8192
    v_mfma_f32_16x16x32_bf16 v[20:23], v[40:43], a[80:83], 0
    ds_read_b128 v[72:75], v4 offset:9216
    v_mfma_f32_16x16x32_bf16 v[24:27], v[44:47], a[80:83], 0
    ds_read_b128 v[36:39], v4 offset:10240
    s_add_u32 s64, s64, 4096
    buffer_load_dwordx4 a[192:195], v4, s[36:39], s64 offen offset:0 sc1
    buffer_load_dwordx4 a[196:199], v4, s[36:39], s64 offen offset:1024 sc1
    s_waitcnt lgkmcnt(5)
    v_mfma_f32_16x16x32_bf16 v[28:31], v[48:51], a[80:83], 0
    ds_read_b128 v[40:43], v4 offset:11264
    v_mfma_f32_16x16x32_bf16 v[32:35], v[52:55], a[80:83], 0
    ds_read_b128 v[44:47], v4 offset:12288
    v_and_b32 v10, 1, v3
    v_lshlrev_b32 v10, 9, v10
    v_mfma_f32_16x16x32_bf16 v[16:19], v[56:59], a[84:87], v[16:19]
    ds_read_b128 v[48:51], v4 offset:13312
    s_waitcnt lgkmcnt(5)
    v_mfma_f32_16x16x32_bf16 v[20:23], v[60:63], a[84:87], v[20:23]
    ds_read_b128 v[52:55], v4 offset:14336
    v_mfma_f32_16x16x32_bf16 v[24:27], v[64:67], a[84:87], v[24:27]
    ds_read_b128 v[56:59], v4 offset:15360
    buffer_load_dwordx4 a[200:203], v4, s[36:39], s64 offen offset:2048 sc1
    buffer_load_dwordx4 a[204:207], v4, s[36:39], s64 offen offset:3072 sc1
    v_mfma_f32_16x16x32_bf16 v[28:31], v[68:71], a[84:87], v[28:31]
    ds_read_b128 v[60:63], v4 offset:16384
    s_waitcnt lgkmcnt(5)
    v_mfma_f32_16x16x32_bf16 v[32:35], v[72:75], a[84:87], v[32:35]
    ds_read_b128 v[64:67], v4 offset:17408
    v_lshrrev_b32 v11, 1, v3
    v_lshl_add_u32 v10, v11, 8, v10
    s_waitcnt vmcnt(8)
    v_mfma_f32_16x16x32_bf16 v[16:19], v[36:39], a[88:91], v[16:19]
    ds_read_b128 v[68:71], v4 offset:18432
    v_mfma_f32_16x16x32_bf16 v[20:23], v[40:43], a[88:91], v[20:23]
    ds_read_b128 v[72:75], v4 offset:19456
    s_waitcnt lgkmcnt(5)
    v_mfma_f32_16x16x32_bf16 v[24:27], v[44:47], a[88:91], v[24:27]
    ds_read_b128 v[36:39], v4 offset:20480
    s_add_u32 s64, s64, 4096
    buffer_load_dwordx4 a[208:211], v4, s[36:39], s64 offen offset:0 sc1
    buffer_load_dwordx4 a[212:215], v4, s[36:39], s64 offen offset:1024 sc1
    v_mfma_f32_16x16x32_bf16 v[28:31], v[48:51], a[88:91], v[28:31]
    ds_read_b128 v[40:43], v4 offset:21504
    v_mfma_f32_16x16x32_bf16 v[32:35], v[52:55], a[88:91], v[32:35]
    ds_read_b128 v[44:47], v4 offset:22528
    v_lshl_add_u32 v10, v2, 4, v10
    s_mul_i32 s3, s29, 2560
    s_waitcnt lgkmcnt(5)
    v_mfma_f32_16x16x32_bf16 v[16:19], v[56:59], a[92:95], v[16:19]
    ds_read_b128 v[48:51], v4 offset:23552
    v_mfma_f32_16x16x32_bf16 v[20:23], v[60:63], a[92:95], v[20:23]
    ds_read_b128 v[52:55], v4 offset:24576
    v_mfma_f32_16x16x32_bf16 v[24:27], v[64:67], a[92:95], v[24:27]
    ds_read_b128 v[56:59], v4 offset:25600
    buffer_load_dwordx4 a[216:219], v4, s[36:39], s64 offen offset:2048 sc1
    buffer_load_dwordx4 a[220:223], v4, s[36:39], s64 offen offset:3072 sc1
    s_waitcnt lgkmcnt(5)
    v_mfma_f32_16x16x32_bf16 v[28:31], v[68:71], a[92:95], v[28:31]
    ds_read_b128 v[60:63], v4 offset:26624
    v_mfma_f32_16x16x32_bf16 v[32:35], v[72:75], a[92:95], v[32:35]
    ds_read_b128 v[64:67], v4 offset:27648
    s_cmp_ge_u32 s30, 2
    s_cbranch_scc1 L_nobm
    s_barrier
L_nobm:
    s_waitcnt vmcnt(10)
    v_mfma_f32_16x16x32_bf16 v[16:19], v[36:39], a[96:99], v[16:19]
    ds_read_b128 v[68:71], v4 offset:28672
    s_waitcnt lgkmcnt(5)
    v_mfma_f32_16x16x32_bf16 v[20:23], v[40:43], a[96:99], v[20:23]
    ds_read_b128 v[72:75], v4 offset:29696
    v_mfma_f32_16x16x32_bf16 v[24:27], v[44:47], a[96:99], v[24:27]
    ds_read_b128 v[36:39], v4 offset:30720
    s_add_u32 s64, s64, 4096
    buffer_load_dwordx4 a[224:227], v4, s[36:39], s64 offen offset:0 sc1
    buffer_load_dwordx4 a[228:231], v4, s[36:39], s64 offen offset:1024 sc1
    v_mfma_f32_16x16x32_bf16 v[28:31], v[48:51], a[96:99], v[28:31]
    ds_read_b128 v[40:43], v4 offset:31744
    s_waitcnt lgkmcnt(5)
    v_mfma_f32_16x16x32_bf16 v[32:35], v[52:55], a[96:99], v[32:35]
    ds_read_b128 v[44:47], v4 offset:32768
    s_add_u32 s3, s63, s3
    s_add_u32 s3, s3, 4194304
    v_mfma_f32_16x16x32_bf16 v[16:19], v[56:59], a[100:103], v[16:19]
    ds_read_b128 v[48:51], v4 offset:33792
    v_mfma_f32_16x16x32_bf16 v[20:23], v[60:63], a[100:103], v[20:23]
    ds_read_b128 v[52:55], v4 offset:34816
    s_waitcnt lgkmcnt(5)
    v_mfma_f32_16x16x32_bf16 v[24:27], v[64:67], a[100:103], v[24:27]
    ds_read_b128 v[56:59], v4 offset:35840
    buffer_load_dwordx4 a[232:235], v4, s[36:39], s64 offen offset:2048 sc1
    buffer_load_dwordx4 a[236:239], v4, s[36:39], s64 offen offset:3072 sc1
    v_mfma_f32_16x16x32_bf16 v[28:31], v[68:71], a[100:103], v[28:31]
    ds_read_b128 v[60:63], v4 offset:36864
    v_mfma_f32_16x16x32_bf16 v[32:35], v[72:75], a[100:103], v[32:35]
    ds_read_b128 v[64:67], v4 offset:37888
    v_mov_b32 v12, 0
    v_mov_b32 v13, 0
    s_waitcnt lgkmcnt(5)
    s_waitcnt vmcnt(12)
    v_mfma_f32_16x16x32_bf16 v[16:19], v[36:39], a[104:107], v[16:19]
    ds_read_b128 v[68:71], v4 offset:38912
    v_mfma_f32_16x16x32_bf16 v[20:23], v[40:43], a[104:107], v[20:23]
    ds_read_b128 v[72:75], v4 offset:39936
    v_mfma_f32_16x16x32_bf16 v[24:27], v[44:47], a[104:107], v[24:27]
    ds_read_b128 v[36:39], v4 offset:40960
    s_waitcnt lgkmcnt(5)
    v_mfma_f32_16x16x32_bf16 v[28:31], v[48:51], a[104:107], v[28:31]
    ds_read_b128 v[40:43], v4 offset:41984
    v_mfma_f32_16x16x32_bf16 v[32:35], v[52:55], a[104:107], v[32:35]
    ds_read_b128 v[44:47], v4 offset:43008
    s_lshl_b32 s65, s31, 6
    s_lshl_b32 s53, s29, 3
    v_mfma_f32_16x16x32_bf16 v[16:19], v[56:59], a[108:111], v[16:19]
    ds_read_b128 v[48:51], v4 offset:44032
    s_waitcnt lgkmcnt(5)
    v_mfma_f32_16x16x32_bf16 v[20:23], v[60:63], a[108:111], v[20:23]
    ds_read_b128 v[52:55], v4 offset:45056
    v_mfma_f32_16x16x32_bf16 v[24:27], v[64:67], a[108:111], v[24:27]
    ds_read_b128 v[56:59], v4 offset:46080
    v_mfma_f32_16x16x32_bf16 v[28:31], v[68:71], a[108:111], v[28:31]
    ds_read_b128 v[60:63], v4 offset:47104
    s_waitcnt lgkmcnt(5)
    v_mfma_f32_16x16x32_bf16 v[32:35], v[72:75], a[108:111], v[32:35]
    ds_read_b128 v[64:67], v4 offset:48128
    s_add_u32 s65, s65, s53
    s_add_u32 s65, s65, 65536
    s_waitcnt vmcnt(10)
    v_mfma_f32_16x16x32_bf16 v[16:19], v[36:39], a[192:195], v[16:19]
    ds_read_b128 v[68:71], v4 offset:49152
    v_mfma_f32_16x16x32_bf16 v[20:23], v[40:43], a[192:195], v[20:23]
    ds_read_b128 v[72:75], v4 offset:50176
    s_waitcnt lgkmcnt(5)
    v_mfma_f32_16x16x32_bf16 v[24:27], v[44:47], a[192:195], v[24:27]
    ds_read_b128 v[36:39], v4 offset:51200
    v_mfma_f32_16x16x32_bf16 v[28:31], v[48:51], a[192:195], v[28:31]
    ds_read_b128 v[40:43], v4 offset:52224
    v_mfma_f32_16x16x32_bf16 v[32:35], v[52:55], a[192:195], v[32:35]
    ds_read_b128 v[44:47], v4 offset:53248
    s_mov_b32 s55, 0x3f803f80
    s_lshl_b32 s53, s28, 5
    s_waitcnt lgkmcnt(5)
    v_mfma_f32_16x16x32_bf16 v[16:19], v[56:59], a[196:199], v[16:19]
    ds_read_b128 v[48:51], v4 offset:54272
    v_mfma_f32_16x16x32_bf16 v[20:23], v[60:63], a[196:199], v[20:23]
    ds_read_b128 v[52:55], v4 offset:55296
    v_mfma_f32_16x16x32_bf16 v[24:27], v[64:67], a[196:199], v[24:27]
    ds_read_b128 v[56:59], v4 offset:56320
    s_waitcnt lgkmcnt(5)
    v_mfma_f32_16x16x32_bf16 v[28:31], v[68:71], a[196:199], v[28:31]
    ds_read_b128 v[60:63], v4 offset:57344
    v_mfma_f32_16x16x32_bf16 v[32:35], v[72:75], a[196:199], v[32:35]
    ds_read_b128 v[64:67], v4 offset:58368
    s_lshl_b32 s66, s29, 2
    s_add_u32 s66, s66, s53
    s_waitcnt vmcnt(8)
    v_mfma_f32_16x16x32_bf16 v[16:19], v[36:39], a[200:203], v[16:19]
    ds_read_b128 v[68:71], v4 offset:59392
    s_waitcnt lgkmcnt(5)
    v_mfma_f32_16x16x32_bf16 v[20:23], v[40:43], a[200:203], v[20:23]
    ds_read_b128 v[72:75], v4 offset:60416
    v_mfma_f32_16x16x32_bf16 v[24:27], v[44:47], a[200:203], v[24:27]
    ds_read_b128 v[36:39], v4 offset:61440
    s_add_u32 s52, s73, 20480
    buffer_load_dwordx4 a[192:195], v4, s[36:39], s52 offen offset:0 sc1
    buffer_load_dwordx4 a[196:199], v4, s[36:39], s52 offen offset:1024 sc1
    v_mfma_f32_16x16x32_bf16 v[28:31], v[48:51], a[200:203], v[28:31]
    ds_read_b128 v[40:43], v4 offset:62464
    s_waitcnt lgkmcnt(5)
    v_mfma_f32_16x16x32_bf16 v[32:35], v[52:55], a[200:203], v[32:35]
    ds_read_b128 v[44:47], v4 offset:63488
    s_add_u32 s66, s66, s30
    s_lshl_b32 s66, s66, 3
    v_mfma_f32_16x16x32_bf16 v[16:19], v[56:59], a[204:207], v[16:19]
    ds_read_b128 v[48:51], v4 offset:64512
    v_mfma_f32_16x16x32_bf16 v[20:23], v[60:63], a[204:207], v[20:23]
    ds_read_b128 v[52:55], v8 offset:0
    s_waitcnt lgkmcnt(5)
    v_mfma_f32_16x16x32_bf16 v[24:27], v[64:67], a[204:207], v[24:27]
    ds_read_b128 v[56:59], v8 offset:1024
    v_mfma_f32_16x16x32_bf16 v[28:31], v[68:71], a[204:207], v[28:31]
    ds_read_b128 v[60:63], v8 offset:2048
    v_mfma_f32_16x16x32_bf16 v[32:35], v[72:75], a[204:207], v[32:35]
    ds_read_b128 v[64:67], v8 offset:3072
    s_add_u32 s62, s66, 36864
    s_add_u32 s66, s66, 45056
    s_waitcnt lgkmcnt(5)
    s_waitcnt vmcnt(8)
    v_mfma_f32_16x16x32_bf16 v[16:19], v[36:39], a[208:211], v[16:19]
    ds_read_b128 v[68:71], v8 offset:4096
    v_mfma_f32_16x16x32_bf16 v[20:23], v[40:43], a[208:211], v[20:23]
    ds_read_b128 v[72:75], v8 offset:5120
    v_mfma_f32_16x16x32_bf16 v[24:27], v[44:47], a[208:211], v[24:27]
    ds_read_b128 v[36:39], v8 offset:6144
    s_add_u32 s52, s73, 22528
    buffer_load_dwordx4 a[200:203], v4, s[36:39], s52 offen offset:0 sc1
    buffer_load_dwordx4 a[204:207], v4, s[36:39], s52 offen offset:1024 sc1
    s_waitcnt lgkmcnt(5)
    v_mfma_f32_16x16x32_bf16 v[28:31], v[48:51], a[208:211], v[28:31]
    ds_read_b128 v[40:43], v8 offset:7168
    v_mfma_f32_16x16x32_bf16 v[32:35], v[52:55], a[208:211], v[32:35]
    ds_read_b128 v[44:47], v8 offset:8192
    s_mul_i32 s60, s28, 81920
    s_mul_i32 s61, s30, 5120
    v_mfma_f32_16x16x32_bf16 v[16:19], v[56:59], a[212:215], v[16:19]
    ds_read_b128 v[48:51], v8 offset:9216
    s_waitcnt lgkmcnt(5)
    v_mfma_f32_16x16x32_bf16 v[20:23], v[60:63], a[212:215], v[20:23]
    ds_read_b128 v[52:55], v8 offset:10240
    v_mfma_f32_16x16x32_bf16 v[24:27], v[64:67], a[212:215], v[24:27]
    ds_read_b128 v[56:59], v8 offset:11264
    v_mfma_f32_16x16x32_bf16 v[28:31], v[68:71], a[212:215], v[28:31]
    ds_read_b128 v[60:63], v8 offset:12288
    s_waitcnt lgkmcnt(5)
    v_mfma_f32_16x16x32_bf16 v[32:35], v[72:75], a[212:215], v[32:35]
    ds_read_b128 v[64:67], v8 offset:13312
    ds_read_b128 v[76:79], v9 offset:0
    s_waitcnt vmcnt(8)
    v_mfma_f32_16x16x32_bf16 v[16:19], v[36:39], a[216:219], v[16:19]
    ds_read_b128 v[68:71], v8 offset:14336
    v_mfma_f32_16x16x32_bf16 v[20:23], v[40:43], a[216:219], v[20:23]
    ds_read_b128 v[72:75], v8 offset:15360
    s_waitcnt lgkmcnt(6)
    v_mfma_f32_16x16x32_bf16 v[24:27], v[44:47], a[216:219], v[24:27]
    ds_read_b128 v[36:39], v8 offset:16384
    s_add_u32 s52, s73, 24576
    buffer_load_dwordx4 a[208:211], v4, s[36:39], s52 offen offset:0 sc1
    buffer_load_dwordx4 a[212:215], v4, s[36:39], s52 offen offset:1024 sc1
    v_mfma_f32_16x16x32_bf16 v[28:31], v[48:51], a[216:219], v[28:31]
    ds_read_b128 v[40:43], v8 offset:17408
    v_mfma_f32_16x16x32_bf16 v[32:35], v[52:55], a[216:219], v[32:35]
    ds_read_b128 v[44:47], v8 offset:18432
    ds_read_b128 v[80:83], v9 offset:64
    s_waitcnt lgkmcnt(7)
    v_mfma_f32_16x16x32_bf16 v[16:19], v[56:59], a[220:223], v[16:19]
    ds_read_b128 v[48:51], v8 offset:19456
    v_mfma_f32_16x16x32_bf16 v[20:23], v[60:63], a[220:223], v[20:23]
    ds_read_b128 v[52:55], v8 offset:20480
    v_mfma_f32_16x16x32_bf16 v[24:27], v[64:67], a[220:223], v[24:27]
    ds_read_b128 v[56:59], v8 offset:21504
    s_waitcnt lgkmcnt(6)
    v_mfma_f32_16x16x32_bf16 v[28:31], v[68:71], a[220:223], v[28:31]
    ds_read_b128 v[60:63], v8 offset:22528
    v_mfma_f32_16x16x32_bf16 v[32:35], v[72:75], a[220:223], v[32:35]
    ds_read_b128 v[64:67], v8 offset:23552
    ds_read_b128 v[84:87], v9 offset:128
    s_waitcnt vmcnt(8)
    v_mfma_f32_16x16x32_bf16 v[16:19], v[36:39], a[224:227], v[16:19]
    ds_read_b128 v[68:71], v8 offset:24576
    s_waitcnt lgkmcnt(6)
    v_mfma_f32_16x16x32_bf16 v[20:23], v[40:43], a[224:227], v[20:23]
    ds_read_b128 v[72:75], v8 offset:25600
    v_mfma_f32_16x16x32_bf16 v[24:27], v[44:47], a[224:227], v[24:27]
    ds_read_b128 v[36:39], v8 offset:26624
    s_add_u32 s52, s73, 26624
    buffer_load_dwordx4 a[216:219], v4, s[36:39], s52 offen offset:0 sc1
    buffer_load_dwordx4 a[220:223], v4, s[36:39], s52 offen offset:1024 sc1
    v_mfma_f32_16x16x32_bf16 v[28:31], v[48:51], a[224:227], v[28:31]
    ds_read_b128 v[40:43], v8 offset:27648
    s_waitcnt lgkmcnt(6)
    v_mfma_f32_16x16x32_bf16 v[32:35], v[52:55], a[224:227], v[32:35]
    ds_read_b128 v[44:47], v8 offset:28672
    ds_read_b128 v[88:91], v9 offset:192
    v_mfma_f32_16x16x32_bf16 v[16:19], v[56:59], a[228:231], v[16:19]
    ds_read_b128 v[48:51], v8 offset:29696
    v_mfma_f32_16x16x32_bf16 v[20:23], v[60:63], a[228:231], v[20:23]
    ds_read_b128 v[52:55], v8 offset:30720
    s_waitcnt lgkmcnt(6)
    v_mfma_f32_16x16x32_bf16 v[24:27], v[64:67], a[228:231], v[24:27]
    ds_read_b128 v[56:59], v8 offset:31744
    v_mfma_f32_16x16x32_bf16 v[28:31], v[68:71], a[228:231], v[28:31]
    ds_read_b128 v[60:63], v8 offset:32768
    v_mfma_f32_16x16x32_bf16 v[32:35], v[72:75], a[228:231], v[32:35]
    ds_read_b128 v[64:67], v8 offset:33792
    ds_read_b128 v[92:95], v9 offset:256
    s_waitcnt lgkmcnt(7)
    s_waitcnt vmcnt(8)
    v_mfma_f32_16x16x32_bf16 v[16:19], v[36:39], a[232:235], v[16:19]
    ds_read_b128 v[68:71], v8 offset:34816
    v_mfma_f32_16x16x32_bf16 v[20:23], v[40:43], a[232:235], v[20:23]
    ds_read_b128 v[72:75], v8 offset:35840
    v_mfma_f32_16x16x32_bf16 v[24:27], v[44:47], a[232:235], v[24:27]
    s_add_u32 s52, s73, 28672
    buffer_load_dwordx4 a[224:227], v4, s[36:39], s52 offen offset:0 sc1
    buffer_load_dwordx4 a[228:231], v4, s[36:39], s52 offen offset:1024 sc1
    s_waitcnt lgkmcnt(5)
    v_mfma_f32_16x16x32_bf16 v[28:31], v[48:51], a[232:235], v[28:31]
    v_mfma_f32_16x16x32_bf16 v[32:35], v[52:55], a[232:235], v[32:35]
    s_add_u32 s60, s60, s61
    s_add_u32 s60, s60, 4194304
    v_mfma_f32_16x16x32_bf16 v[16:19], v[56:59], a[236:239], v[16:19]
    ds_read_b128 v[36:39], v9 offset:320
    s_waitcnt lgkmcnt(2)
    v_mfma_f32_16x16x32_bf16 v[20:23], v[60:63], a[236:239], v[20:23]
    ds_read_b128 v[40:43], v9 offset:384
    v_mfma_f32_16x16x32_bf16 v[24:27], v[64:67], a[236:239], v[24:27]
    ds_read_b128 v[44:47], v9 offset:448
    v_mfma_f32_16x16x32_bf16 v[28:31], v[68:71], a[236:239], v[28:31]
    ds_read_b128 v[48:51], v9 offset:512
    s_waitcnt lgkmcnt(4)
    v_mfma_f32_16x16x32_bf16 v[32:35], v[72:75], a[236:239], v[32:35]
    ds_read_b128 v[52:55], v9 offset:576
    s_lshl_b32 s71, s28, 8
    s_add_u32 s59, s71, 36864
    v_min_u32 v75, 15, v1
    v_lshrrev_b32 v74, 1, v75
    v_and_b32 v75, 1, v75
    v_lshlrev_b32 v75, 3, v75
    v_lshl_add_u32 v75, v74, 5, v75
    v_accvgpr_read_b32 v56, a240
    v_accvgpr_read_b32 v57, a241
    v_accvgpr_read_b32 v58, a242
    v_accvgpr_read_b32 v59, a243
    v_accvgpr_read_b32 v60, a244
    v_accvgpr_read_b32 v61, a245
    v_accvgpr_read_b32 v62, a246
    v_accvgpr_read_b32 v63, a247
    v_accvgpr_read_b32 v64, a248
    v_accvgpr_read_b32 v65, a249
    v_accvgpr_read_b32 v66, a250
    v_accvgpr_read_b32 v67, a251
    v_permlane16_swap_b32 v56, v58
    v_permlane16_swap_b32 v57, v59
    v_permlane16_swap_b32 v60, v62
    v_permlane16_swap_b32 v61, v63
    v_permlane16_swap_b32 v64, v66
    v_permlane16_swap_b32 v65, v67
    s_waitcnt lgkmcnt(0)
    v_lshlrev_b32 v68, 16, v56
    v_and_b32 v69, s91, v56
    v_lshlrev_b32 v70, 16, v57
    v_and_b32 v71, s91, v57
    v_pk_fma_f32 v[68:69], v[76:77], v[16:17], v[68:69]
    v_pk_fma_f32 v[70:71], v[78:79], v[18:19], v[70:71]
    v_pk_mul_f32 v[16:17], v[68:69], v[36:37]
    v_pk_mul_f32 v[18:19], v[70:71], v[38:39]
    v_cvt_pk_bf16_f32 v76, v16, v17
    v_cvt_pk_bf16_f32 v77, v18, v19
    v_cvt_pk_bf16_f32 v56, v68, v69
    v_cvt_pk_bf16_f32 v57, v70, v71
    v_lshlrev_b32 v68, 16, v58
    v_and_b32 v69, s91, v58
    v_lshlrev_b32 v70, 16, v59
    v_and_b32 v71, s91, v59
    v_pk_fma_f32 v[68:69], v[80:81], v[20:21], v[68:69]
    v_pk_fma_f32 v[70:71], v[82:83], v[22:23], v[70:71]
    v_pk_mul_f32 v[20:21], v[68:69], v[40:41]
    v_pk_mul_f32 v[22:23], v[70:71], v[42:43]
    v_cvt_pk_bf16_f32 v78, v20, v21
    v_cvt_pk_bf16_f32 v79, v22, v23
    v_cvt_pk_bf16_f32 v58, v68, v69
    v_cvt_pk_bf16_f32 v59, v70, v71
    v_permlane16_swap_b32 v76, v78
    v_permlane16_swap_b32 v77, v79
    s_cmp_eq_u32 s92, 0
    s_cbranch_scc1 L_adaLN_cond__grouped_kv_mqa__dense_activation_silu__prompt_kernel_wt_45
    buffer_store_dwordx4 v[76:79], v10, s[36:39], s3 offen offset:0
    s_branch L_adaLN_cond__grouped_kv_mqa__dense_activation_silu__prompt_kernel_wd_46
L_adaLN_cond__grouped_kv_mqa__dense_activation_silu__prompt_kernel_wt_45:
    buffer_store_dwordx4 v[76:79], v10, s[36:39], s3 offen offset:0 sc1
L_adaLN_cond__grouped_kv_mqa__dense_activation_silu__prompt_kernel_wd_46:
    v_lshlrev_b32 v68, 16, v60
    v_and_b32 v69, s91, v60
    v_lshlrev_b32 v70, 16, v61
    v_and_b32 v71, s91, v61
    v_pk_fma_f32 v[68:69], v[84:85], v[24:25], v[68:69]
    v_pk_fma_f32 v[70:71], v[86:87], v[26:27], v[70:71]
    v_pk_mul_f32 v[24:25], v[68:69], v[44:45]
    v_pk_mul_f32 v[26:27], v[70:71], v[46:47]
    v_cvt_pk_bf16_f32 v84, v24, v25
    v_cvt_pk_bf16_f32 v85, v26, v27
    v_cvt_pk_bf16_f32 v60, v68, v69
    v_cvt_pk_bf16_f32 v61, v70, v71
    v_lshlrev_b32 v68, 16, v62
    v_and_b32 v69, s91, v62
    v_lshlrev_b32 v70, 16, v63
    v_and_b32 v71, s91, v63
    v_pk_fma_f32 v[68:69], v[88:89], v[28:29], v[68:69]
    v_pk_fma_f32 v[70:71], v[90:91], v[30:31], v[70:71]
    v_pk_mul_f32 v[28:29], v[68:69], v[48:49]
    v_pk_mul_f32 v[30:31], v[70:71], v[50:51]
    v_cvt_pk_bf16_f32 v86, v28, v29
    v_cvt_pk_bf16_f32 v87, v30, v31
    v_cvt_pk_bf16_f32 v62, v68, v69
    v_cvt_pk_bf16_f32 v63, v70, v71
    v_permlane16_swap_b32 v84, v86
    v_permlane16_swap_b32 v85, v87
    s_cmp_eq_u32 s92, 0
    s_cbranch_scc1 L_adaLN_cond__grouped_kv_mqa__dense_activation_silu__prompt_kernel_wt_47
    buffer_store_dwordx4 v[84:87], v10, s[36:39], s3 offen offset:1024
    s_branch L_adaLN_cond__grouped_kv_mqa__dense_activation_silu__prompt_kernel_wd_48
L_adaLN_cond__grouped_kv_mqa__dense_activation_silu__prompt_kernel_wt_47:
    buffer_store_dwordx4 v[84:87], v10, s[36:39], s3 offen offset:1024 sc1
L_adaLN_cond__grouped_kv_mqa__dense_activation_silu__prompt_kernel_wd_48:
    v_lshlrev_b32 v68, 16, v64
    v_and_b32 v69, s91, v64
    v_lshlrev_b32 v70, 16, v65
    v_and_b32 v71, s91, v65
    v_pk_fma_f32 v[68:69], v[92:93], v[32:33], v[68:69]
    v_pk_fma_f32 v[70:71], v[94:95], v[34:35], v[70:71]
    v_pk_mul_f32 v[32:33], v[68:69], v[52:53]
    v_pk_mul_f32 v[34:35], v[70:71], v[54:55]
    v_cvt_pk_bf16_f32 v92, v32, v33
    v_cvt_pk_bf16_f32 v93, v34, v35
    v_mov_b32 v94, v92
    v_mov_b32 v95, v93
    v_cvt_pk_bf16_f32 v64, v68, v69
    v_cvt_pk_bf16_f32 v65, v70, v71
    v_permlane16_swap_b32 v92, v94
    v_permlane16_swap_b32 v93, v95
    buffer_load_dwordx2 v[72:73], v75, s[36:39], s59 offen offset:0 sc1
    v_dot2_f32_bf16 v12, v56, s55, v12
    v_dot2_f32_bf16 v13, v56, v56, v13
    v_dot2_f32_bf16 v12, v57, s55, v12
    v_dot2_f32_bf16 v13, v57, v57, v13
    v_dot2_f32_bf16 v12, v58, s55, v12
    v_dot2_f32_bf16 v13, v58, v58, v13
    v_dot2_f32_bf16 v12, v59, s55, v12
    v_dot2_f32_bf16 v13, v59, v59, v13
    v_dot2_f32_bf16 v12, v60, s55, v12
    v_dot2_f32_bf16 v13, v60, v60, v13
    v_dot2_f32_bf16 v12, v61, s55, v12
    v_dot2_f32_bf16 v13, v61, v61, v13
    v_dot2_f32_bf16 v12, v62, s55, v12
    v_dot2_f32_bf16 v13, v62, v62, v13
    v_dot2_f32_bf16 v12, v63, s55, v12
    v_dot2_f32_bf16 v13, v63, v63, v13
    v_dot2_f32_bf16 v12, v64, s55, v12
    v_dot2_f32_bf16 v13, v64, v64, v13
    v_dot2_f32_bf16 v12, v65, s55, v12
    v_dot2_f32_bf16 v13, v65, v65, v13
    v_lshlrev_b32 v68, 6, v2
    s_nop 1
    v_mov_b32 v11, v12
    v_mov_b32 v9, v13
    s_nop 0
    v_permlane16_swap_b32 v12, v11
    v_permlane16_swap_b32 v13, v9
    v_add_f32 v12, v12, v11
    v_add_f32 v13, v13, v9
    v_mov_b32 v11, v12
    v_mov_b32 v9, v13
    s_nop 0
    v_permlane32_swap_b32 v12, v11
    v_permlane32_swap_b32 v13, v9
    v_add_f32 v12, v12, v11
    v_add_f32 v13, v13, v9
    s_cmp_eq_u32 s92, 0
    s_cbranch_scc1 L_adaLN_cond__grouped_kv_mqa__dense_activation_silu__prompt_kernel_wt_49
    s_mov_b32 exec_lo, 0xffff
    s_mov_b32 exec_hi, 0xffff
    buffer_store_dwordx4 v[92:95], v10, s[36:39], s3 offen offset:2048
    s_mov_b32 exec_hi, 0
    buffer_store_dwordx2 v[12:13], v68, s[36:39], s65 offen
    s_branch L_adaLN_cond__grouped_kv_mqa__dense_activation_silu__prompt_kernel_wd_50
L_adaLN_cond__grouped_kv_mqa__dense_activation_silu__prompt_kernel_wt_49:
    s_mov_b32 exec_lo, 0xffff
    s_mov_b32 exec_hi, 0xffff
    buffer_store_dwordx4 v[92:95], v10, s[36:39], s3 offen offset:2048 sc1
    s_mov_b32 exec_hi, 0
    buffer_store_dwordx2 v[12:13], v68, s[36:39], s65 offen sc1
L_adaLN_cond__grouped_kv_mqa__dense_activation_silu__prompt_kernel_wd_50:
    s_mov_b64 exec, -1
    s_add_u32 s52, s73, 30720
    buffer_load_dwordx4 a[232:235], v4, s[36:39], s52 offen offset:0 sc1
    v_accvgpr_write_b32 a102, v56
    v_accvgpr_write_b32 a103, v57
    v_accvgpr_write_b32 a104, v58
    v_accvgpr_write_b32 a105, v59
    v_accvgpr_write_b32 a106, v60
    v_accvgpr_write_b32 a107, v61
    v_accvgpr_write_b32 a108, v62
    v_accvgpr_write_b32 a109, v63
    v_accvgpr_write_b32 a110, v64
    v_accvgpr_write_b32 a111, v65
    s_add_u32 s52, s73, 31744
    buffer_load_dwordx4 a[236:239], v4, s[36:39], s52 offen offset:0 sc1
    v_lshlrev_b32 v9, 6, v2
    v_add_u32 v9, v9, v7
    s_lshl_b32 s55, s28, 12
    s_add_u32 s55, s55, 65536
    s_cmp_ge_u32 s30, 2
    s_cbranch_scc1 L_ylate
    v_min_u32 v11, 1, v2
    v_mul_u32_u24 v11, 1280, v11
    v_add_u32 v11, v11, v7
    v_add_u32 v11, 153600, v11
    ds_read_b128 v[16:19], v11 offset:0
    ds_read_b128 v[20:23], v11 offset:64
    s_waitcnt lgkmcnt(1)
    v_mfma_f32_16x16x32_bf16 v[28:31], v[96:99], v[16:19], 0
    ds_read_b128 v[24:27], v11 offset:128
    v_mfma_f32_16x16x32_bf16 v[32:35], v[100:103], v[16:19], 0
    v_mfma_f32_16x16x32_bf16 v[36:39], v[104:107], v[16:19], 0
    s_waitcnt lgkmcnt(1)
    v_mfma_f32_16x16x32_bf16 v[28:31], v[108:111], v[20:23], v[28:31]
    ds_read_b128 v[16:19], v11 offset:192
    v_mfma_f32_16x16x32_bf16 v[32:35], v[112:115], v[20:23], v[32:35]
    v_mfma_f32_16x16x32_bf16 v[36:39], v[116:119], v[20:23], v[36:39]
    s_waitcnt lgkmcnt(1)
    v_mfma_f32_16x16x32_bf16 v[28:31], v[120:123], v[24:27], v[28:31]
    ds_read_b128 v[20:23], v11 offset:256
    v_mfma_f32_16x16x32_bf16 v[32:35], v[124:127], v[24:27], v[32:35]
    v_mfma_f32_16x16x32_bf16 v[36:39], v[128:131], v[24:27], v[36:39]
    s_waitcnt lgkmcnt(1)
    v_mfma_f32_16x16x32_bf16 v[28:31], v[132:135], v[16:19], v[28:31]
    ds_read_b128 v[24:27], v11 offset:320
    v_mfma_f32_16x16x32_bf16 v[32:35], v[136:139], v[16:19], v[32:35]
    v_mfma_f32_16x16x32_bf16 v[36:39], v[140:143], v[16:19], v[36:39]
    s_waitcnt lgkmcnt(1)
    v_mfma_f32_16x16x32_bf16 v[28:31], v[144:147], v[20:23], v[28:31]
    ds_read_b128 v[16:19], v11 offset:384
    v_mfma_f32_16x16x32_bf16 v[32:35], v[148:151], v[20:23], v[32:35]
    v_mfma_f32_16x16x32_bf16 v[36:39], v[152:155], v[20:23], v[36:39]
    s_waitcnt lgkmcnt(1)
    v_mfma_f32_16x16x32_bf16 v[28:31], v[156:159], v[24:27], v[28:31]
    v_mfma_f32_16x16x32_bf16 v[32:35], v[160:163], v[24:27], v[32:35]
    v_mfma_f32_16x16x32_bf16 v[36:39], v[164:167], v[24:27], v[36:39]
    s_waitcnt lgkmcnt(0)
    v_mfma_f32_16x16x32_bf16 v[28:31], v[168:171], v[16:19], v[28:31]
    v_mfma_f32_16x16x32_bf16 v[32:35], v[172:175], v[16:19], v[32:35]
    v_mfma_f32_16x16x32_bf16 v[36:39], v[176:179], v[16:19], v[36:39]
    s_waitcnt vmcnt(2)
    v_mov_b32 v40, s32
    v_mov_b32 v41, s33
    v_mov_b32 v42, 0
    s_mov_b64 exec, 1
    s_cmp_eq_u32 s92, 0
    s_cbranch_scc1 L_adaLN_cond__grouped_kv_mqa__dense_activation_silu__prompt_kernel_wt_51
    buffer_store_dwordx2 v[40:41], v42, s[36:39], s62 offen
    s_branch L_adaLN_cond__grouped_kv_mqa__dense_activation_silu__prompt_kernel_wd_52
L_adaLN_cond__grouped_kv_mqa__dense_activation_silu__prompt_kernel_wt_51:
    buffer_store_dwordx2 v[40:41], v42, s[36:39], s62 offen sc1
    s_mov_b64 exec, -1
    v_mul_u32_u24 v40, 3277, v1
    v_lshrrev_b32 v40, 16, v40
    v_mul_u32_u24 v41, 20, v40
    v_sub_u32 v41, v1, v41
    v_mul_u32_u24 v40, 0, v40
    v_lshl_add_u32 v40, v41, 7, v40
    s_mov_b32 exec_lo, 0xfffff
    s_mov_b32 exec_hi, 0x0
    buffer_load_dword v14, v40, s[36:39], s3 offen sc1
L_adaLN_cond__grouped_kv_mqa__dense_activation_silu__prompt_kernel_wd_52:
    s_mov_b64 exec, -1
    ds_read_b128 v[20:23], v11 offset:448
    ds_read_b128 v[24:27], v11 offset:512
    s_waitcnt lgkmcnt(1)
    v_mfma_f32_16x16x32_bf16 v[28:31], v[180:183], v[20:23], v[28:31]
    ds_read_b128 v[16:19], v11 offset:576
    v_mfma_f32_16x16x32_bf16 v[32:35], v[184:187], v[20:23], v[32:35]
    v_mfma_f32_16x16x32_bf16 v[36:39], v[188:191], v[20:23], v[36:39]
    s_waitcnt lgkmcnt(1)
    v_mfma_f32_16x16x32_bf16 v[28:31], v[192:195], v[24:27], v[28:31]
    ds_read_b128 v[20:23], v11 offset:640
    v_mfma_f32_16x16x32_bf16 v[32:35], v[196:199], v[24:27], v[32:35]
    v_mfma_f32_16x16x32_bf16 v[36:39], v[200:203], v[24:27], v[36:39]
    s_waitcnt lgkmcnt(1)
    v_mfma_f32_16x16x32_bf16 v[28:31], v[204:207], v[16:19], v[28:31]
    ds_read_b128 v[24:27], v11 offset:704
    v_mfma_f32_16x16x32_bf16 v[32:35], v[208:211], v[16:19], v[32:35]
    v_mfma_f32_16x16x32_bf16 v[36:39], v[212:215], v[16:19], v[36:39]
    s_waitcnt lgkmcnt(1)
    v_mfma_f32_16x16x32_bf16 v[28:31], v[216:219], v[20:23], v[28:31]
    ds_read_b128 v[16:19], v11 offset:768
    v_mfma_f32_16x16x32_bf16 v[32:35], v[220:223], v[20:23], v[32:35]
    v_mfma_f32_16x16x32_bf16 v[36:39], v[224:227], v[20:23], v[36:39]
    s_waitcnt lgkmcnt(1)
    v_mfma_f32_16x16x32_bf16 v[28:31], v[228:231], v[24:27], v[28:31]
    ds_read_b128 v[20:23], v11 offset:832
    v_mfma_f32_16x16x32_bf16 v[32:35], v[232:235], v[24:27], v[32:35]
    buffer_load_dwordx2 v[40:41], v75, s[36:39], s59 offen offset:0 sc1
    v_mfma_f32_16x16x32_bf16 v[36:39], v[236:239], v[24:27], v[36:39]
    s_waitcnt lgkmcnt(1)
    v_mfma_f32_16x16x32_bf16 v[28:31], v[240:243], v[16:19], v[28:31]
    ds_read_b128 v[24:27], v11 offset:896
    v_mfma_f32_16x16x32_bf16 v[32:35], v[244:247], v[16:19], v[32:35]
    v_mfma_f32_16x16x32_bf16 v[36:39], v[248:251], v[16:19], v[36:39]
    s_waitcnt lgkmcnt(1)
    v_mfma_f32_16x16x32_bf16 v[28:31], v[252:255], v[20:23], v[28:31]
    ds_read_b128 v[16:19], v11 offset:960
    v_mfma_f32_16x16x32_bf16 v[32:35], a[0:3], v[20:23], v[32:35]
    v_mfma_f32_16x16x32_bf16 v[36:39], a[4:7], v[20:23], v[36:39]
    s_waitcnt lgkmcnt(1)
    v_mfma_f32_16x16x32_bf16 v[28:31], a[8:11], v[24:27], v[28:31]
    v_mfma_f32_16x16x32_bf16 v[32:35], a[12:15], v[24:27], v[32:35]
    v_mfma_f32_16x16x32_bf16 v[36:39], a[16:19], v[24:27], v[36:39]
    s_waitcnt lgkmcnt(0)
    v_mfma_f32_16x16x32_bf16 v[28:31], a[20:23], v[16:19], v[28:31]
    v_mfma_f32_16x16x32_bf16 v[32:35], a[24:27], v[16:19], v[32:35]
    v_mfma_f32_16x16x32_bf16 v[36:39], a[28:31], v[16:19], v[36:39]
    s_mov_b32 s58, 8388608
    s_waitcnt vmcnt(0)
    s_branch L_adaLN_cond__grouped_kv_mqa__dense_activation_silu__prompt_kernel_pyac_54
L_adaLN_cond__grouped_kv_mqa__dense_activation_silu__prompt_kernel_pya_53:
    buffer_load_dwordx2 v[40:41], v75, s[36:39], s59 offen offset:0 sc1
    s_sub_u32 s58, s58, 1
    s_cbranch_scc1 L_adaLN_cond__grouped_kv_mqa__dense_activation_silu__prompt_kernel_pyad_55
    s_waitcnt vmcnt(0)
L_adaLN_cond__grouped_kv_mqa__dense_activation_silu__prompt_kernel_pyac_54:
    v_cmp_ne_u64 vcc, s[32:33], v[40:41]
    s_cbranch_vccz L_adaLN_cond__grouped_kv_mqa__dense_activation_silu__prompt_kernel_pyad_55
    s_sleep 1
    s_branch L_adaLN_cond__grouped_kv_mqa__dense_activation_silu__prompt_kernel_pya_53
L_adaLN_cond__grouped_kv_mqa__dense_activation_silu__prompt_kernel_pyad_55:
    s_mul_i32 s53, s30, 20480
    s_mul_i32 s54, s28, 81920
    s_add_u32 s54, s54, s53
    s_add_u32 s54, s54, 4194304
    s_add_u32 m0, s53, 102400
    s_nop 0
    buffer_load_dwordx4 v4, s[36:39], s54 offen offset:0 sc1 lds
    buffer_load_dwordx4 v4, s[36:39], s54 offen offset:1024 sc1 lds
    buffer_load_dwordx4 v4, s[36:39], s54 offen offset:2048 sc1 lds
    buffer_load_dwordx4 v4, s[36:39], s54 offen offset:3072 sc1 lds
    s_add_u32 m0, m0, 4096
    s_add_u32 s54, s54, 4096
    buffer_load_dwordx4 v4, s[36:39], s54 offen offset:0 sc1 lds
    buffer_load_dwordx4 v4, s[36:39], s54 offen offset:1024 sc1 lds
    buffer_load_dwordx4 v[44:47], v9, s[36:39], s55 offen offset:0 sc1
    buffer_load_dwordx4 v[48:51], v9, s[36:39], s55 offen offset:1024 sc1
    ds_read_b128 v[20:23], v11 offset:1024
    ds_read_b128 v[24:27], v11 offset:1088
    s_waitcnt lgkmcnt(1)
    v_mfma_f32_16x16x32_bf16 v[28:31], a[32:35], v[20:23], v[28:31]
    ds_read_b128 v[16:19], v11 offset:1152
    v_mfma_f32_16x16x32_bf16 v[32:35], a[36:39], v[20:23], v[32:35]
    v_mfma_f32_16x16x32_bf16 v[36:39], a[40:43], v[20:23], v[36:39]
    s_waitcnt lgkmcnt(1)
    v_mfma_f32_16x16x32_bf16 v[28:31], a[44:47], v[24:27], v[28:31]
    ds_read_b128 v[20:23], v11 offset:1216
    v_mfma_f32_16x16x32_bf16 v[32:35], a[48:51], v[24:27], v[32:35]
    v_mfma_f32_16x16x32_bf16 v[36:39], a[52:55], v[24:27], v[36:39]
    s_waitcnt lgkmcnt(1)
    v_mfma_f32_16x16x32_bf16 v[28:31], a[56:59], v[16:19], v[28:31]
    v_mfma_f32_16x16x32_bf16 v[32:35], a[60:63], v[16:19], v[32:35]
    v_mfma_f32_16x16x32_bf16 v[36:39], a[64:67], v[16:19], v[36:39]
    s_waitcnt lgkmcnt(0)
    v_mfma_f32_16x16x32_bf16 v[28:31], a[68:71], v[20:23], v[28:31]
    v_mfma_f32_16x16x32_bf16 v[32:35], a[72:75], v[20:23], v[32:35]
    v_mfma_f32_16x16x32_bf16 v[36:39], a[76:79], v[20:23], v[36:39]
    s_mul_i32 s53, s30, 384
    s_add_u32 s53, s53, 157120
    v_min_u32 v13, 1, v2
    v_mul_u32_u24 v13, 192, v13
    v_add3_u32 v13, v13, v7, s53
    v_cmp_eq_u32 vcc, 1, v2
    v_mov_b32 v12, 0xbfb8aa3b
    s_nop 0
    v_cndmask_b32 v12, 1.0, v12, vcc
    s_nop 0
    v_mul_f32 v28, v12, v28
    v_mul_f32 v29, v12, v29
    v_mul_f32 v30, v12, v30
    v_mul_f32 v31, v12, v31
    v_mul_f32 v32, v12, v32
    v_mul_f32 v33, v12, v33
    v_mul_f32 v34, v12, v34
    v_mul_f32 v35, v12, v35
    v_mul_f32 v36, v12, v36
    v_mul_f32 v37, v12, v37
    v_mul_f32 v38, v12, v38
    v_mul_f32 v39, v12, v39
    s_mov_b32 exec_lo, 196611
    s_mov_b32 exec_hi, 196611
    ds_write_b128 v13, v[28:31] offset:0
    ds_write_b128 v13, v[32:35] offset:64
    ds_write_b128 v13, v[36:39] offset:128
    s_mov_b64 exec, -1
    s_waitcnt lgkmcnt(0)
    s_branch L_yjoin
L_ylate:
    s_mov_b32 s58, 8388608
    s_waitcnt vmcnt(4)
    s_branch L_adaLN_cond__grouped_kv_mqa__dense_activation_silu__prompt_kernel_pya2c_57
L_adaLN_cond__grouped_kv_mqa__dense_activation_silu__prompt_kernel_pya2_56:
    buffer_load_dwordx2 v[72:73], v75, s[36:39], s59 offen offset:0 sc1
    s_sub_u32 s58, s58, 1
    s_cbranch_scc1 L_adaLN_cond__grouped_kv_mqa__dense_activation_silu__prompt_kernel_pya2d_58
    s_waitcnt vmcnt(0)
L_adaLN_cond__grouped_kv_mqa__dense_activation_silu__prompt_kernel_pya2c_57:
    v_cmp_ne_u64 vcc, s[32:33], v[72:73]
    s_cbranch_vccz L_adaLN_cond__grouped_kv_mqa__dense_activation_silu__prompt_kernel_pya2d_58
    s_sleep 1
    s_branch L_adaLN_cond__grouped_kv_mqa__dense_activation_silu__prompt_kernel_pya2_56
L_adaLN_cond__grouped_kv_mqa__dense_activation_silu__prompt_kernel_pya2d_58:
    buffer_load_dwordx4 v[44:47], v9, s[36:39], s55 offen offset:0 sc1
    buffer_load_dwordx4 v[48:51], v9, s[36:39], s55 offen offset:1024 sc1
L_yjoin:
    v_mov_b32 v11, v75
    s_lshr_b32 s53, s30, 1
    s_lshl_b32 s53, s53, 10
    s_and_b32 s54, s30, 1
    s_mul_i32 s54, s54, 20480
    s_add_u32 s53, s53, s54
    s_add_u32 s53, s53, 6144
    s_mul_i32 s54, s28, 81920
    s_add_u32 s54, s54, s53
    s_add_u32 s54, s54, 4194304
    s_add_u32 m0, s53, 102400
    v_add_u32 v8, 102400, v4
    buffer_load_dwordx4 v4, s[36:39], s54 offen offset:0 sc1 lds
    buffer_load_dwordx4 v4, s[36:39], s54 offen offset:2048 sc1 lds
    v_and_b32 v10, 1, v3
    v_lshrrev_b32 v12, 1, v3
    v_lshlrev_b32 v12, 8, v12
    v_lshl_add_u32 v12, v2, 4, v12
    s_mul_i32 s75, s28, 81920
    s_mul_i32 s76, s28, 49152
    s_add_u32 s76, s76, 7340032
    s_lshl_b32 s53, s29, 2
    s_add_u32 s53, s53, s30
    s_mul_i32 s53, s53, 1536
    s_add_u32 s64, s75, s53
    s_add_u32 s65, s64, 4194304
    s_add_u32 s64, s64, 1048576
    s_add_u32 s53, s53, s76
    s_sub_u32 s53, s53, 36864
    s_add_u32 s77, s53, 24576
    s_cmp_ge_u32 s29, 6
    s_cselect_b32 s64, s53, s64
    s_cselect_b32 s65, s77, s65
    s_cselect_b32 s77, 3, 10
    s_lshl_b32 s77, s77, 12
    v_mul_u32_u24 v10, s77, v10
    v_add_u32 v10, v10, v12
    s_mul_i32 s53, s30, 384
    s_add_u32 s53, s53, 157120
    v_add_u32 v7, s53, v7
    s_waitcnt vmcnt(2)
    v_add_f32 v44, v44, v46
    v_add_f32 v45, v45, v47
    v_add_f32 v48, v48, v50
    v_add_f32 v49, v49, v51
    v_mov_b32 v46, v44
    v_mov_b32 v47, v45
    v_mov_b32 v50, v48
    v_mov_b32 v51, v49
    s_nop 0
    v_permlane16_swap_b32 v44, v46
    v_permlane16_swap_b32 v45, v47
    v_permlane16_swap_b32 v48, v50
    v_permlane16_swap_b32 v49, v51
    v_add_f32 v44, v44, v46
    v_add_f32 v45, v45, v47
    v_add_f32 v48, v48, v50
    v_add_f32 v49, v49, v51
    v_mov_b32 v46, v44
    v_mov_b32 v47, v45
    v_mov_b32 v50, v48
    v_mov_b32 v51, v49
    s_nop 0
    v_permlane32_swap_b32 v44, v46
    v_permlane32_swap_b32 v45, v47
    v_permlane32_swap_b32 v48, v50
    v_permlane32_swap_b32 v49, v51
    v_add_f32 v44, v44, v46
    v_add_f32 v45, v45, v47
    v_add_f32 v48, v48, v50
    v_add_f32 v49, v49, v51
    v_mul_f32 v44, 0x3acccccd, v44
    v_mul_f32 v45, 0x3acccccd, v45
    v_mul_f32 v48, 0x3acccccd, v48
    v_mul_f32 v49, 0x3acccccd, v49
    v_fma_f32 v45, -v44, v44, v45
    v_fma_f32 v49, -v48, v48, v49
    v_max_f32 v45, 0, v45
    v_max_f32 v49, 0, v49
    v_add_f32 v45, 0x3727c5ac, v45
    v_add_f32 v49, 0x3727c5ac, v49
    v_rsq_f32 v45, v45
    v_rsq_f32 v49, v49
    s_nop 0
    v_mul_f32 v64, 0xbfb8aa3b, v45
    v_mul_f32 v66, 0xbfb8aa3b, v49
    v_mul_f32 v65, -v44, v64
    v_mul_f32 v67, -v48, v66
    s_cmp_ge_u32 s30, 2
    s_cbranch_scc1 L_noy0
    s_waitcnt vmcnt(2)
L_noy0:
    s_waitcnt lgkmcnt(0)
    s_barrier
    ds_read_b128 a[80:83], v8 offset:0
    ds_read_b128 a[84:87], v8 offset:20480
    s_waitcnt lgkmcnt(1)
    v_mfma_f32_16x16x32_bf16 v[16:19], v[96:99], a[80:83], 0
    ds_read_b128 a[88:91], v8 offset:1024
    v_mfma_f32_16x16x32_bf16 v[24:27], v[100:103], a[80:83], 0
    s_add_u32 s53, s74, 40960
    v_add_u32 v13, s53, v4
    v_mfma_f32_16x16x32_bf16 v[32:35], v[104:107], a[80:83], 0
    s_add_u32 m0, m0, 4096
    s_add_u32 s54, s54, 4096
    buffer_load_dwordx4 v4, s[36:39], s54 offen offset:0 sc1 lds
    s_waitcnt lgkmcnt(1)
    v_mfma_f32_16x16x32_bf16 v[20:23], v[96:99], a[84:87], 0
    ds_read_b128 a[92:95], v8 offset:21504
    v_mfma_f32_16x16x32_bf16 v[28:31], v[100:103], a[84:87], 0
    s_xor_b32 s80, s30, 1
    v_mfma_f32_16x16x32_bf16 v[36:39], v[104:107], a[84:87], 0
    s_cmp_lt_u32 s30, 2
    s_cselect_b32 s80, s80, 0
    s_waitcnt lgkmcnt(1)
    v_mfma_f32_16x16x32_bf16 v[16:19], v[108:111], a[88:91], v[16:19]
    ds_read_b128 a[80:83], v8 offset:2048
    v_mfma_f32_16x16x32_bf16 v[24:27], v[112:115], a[88:91], v[24:27]
    s_cmp_lt_u32 s30, 2
    s_cselect_b32 s81, s30, 1
    v_mfma_f32_16x16x32_bf16 v[32:35], v[116:119], a[88:91], v[32:35]
    buffer_load_dwordx4 v4, s[36:39], s54 offen offset:2048 sc1 lds
    s_waitcnt lgkmcnt(1)
    v_mfma_f32_16x16x32_bf16 v[20:23], v[108:111], a[92:95], v[20:23]
    ds_read_b128 a[84:87], v8 offset:22528
    v_mfma_f32_16x16x32_bf16 v[28:31], v[112:115], a[92:95], v[28:31]
    s_add_u32 s82, s30, 2
    s_sub_u32 s83, 5, s30
    v_mfma_f32_16x16x32_bf16 v[36:39], v[116:119], a[92:95], v[36:39]
    s_cmp_lt_u32 s30, 2
    s_cselect_b32 s82, s82, s83
    s_cmp_lt_u32 s30, 2
    s_cbranch_scc1 L_yfdone
    s_waitcnt vmcnt(8)
    v_mov_b32 v92, s32
    v_mov_b32 v93, s33
    v_mov_b32 v94, 0
    s_mov_b64 exec, 1
    s_cmp_eq_u32 s92, 0
    s_cbranch_scc1 L_adaLN_cond__grouped_kv_mqa__dense_activation_silu__prompt_kernel_wt_59
    buffer_store_dwordx2 v[92:93], v94, s[36:39], s62 offen
    s_branch L_adaLN_cond__grouped_kv_mqa__dense_activation_silu__prompt_kernel_wd_60
L_adaLN_cond__grouped_kv_mqa__dense_activation_silu__prompt_kernel_wt_59:
    buffer_store_dwordx2 v[92:93], v94, s[36:39], s62 offen sc1
    s_mov_b64 exec, -1
    v_mul_u32_u24 v92, 3277, v1
    v_lshrrev_b32 v92, 16, v92
    v_mul_u32_u24 v93, 20, v92
    v_sub_u32 v93, v1, v93
    v_mul_u32_u24 v92, 0, v92
    v_lshl_add_u32 v92, v93, 7, v92
    s_mov_b32 exec_lo, 0xfffff
    s_mov_b32 exec_hi, 0x0
    buffer_load_dword v14, v92, s[36:39], s3 offen sc1
L_adaLN_cond__grouped_kv_mqa__dense_activation_silu__prompt_kernel_wd_60:
    s_mov_b64 exec, -1
L_yfdone:
    s_waitcnt lgkmcnt(1)
    v_mfma_f32_16x16x32_bf16 v[16:19], v[120:123], a[80:83], v[16:19]
    ds_read_b128 a[88:91], v8 offset:3072
    v_mfma_f32_16x16x32_bf16 v[24:27], v[124:127], a[80:83], v[24:27]
    s_sub_u32 s83, 3, s30
    v_mfma_f32_16x16x32_bf16 v[32:35], v[128:131], a[80:83], v[32:35]
    s_add_u32 m0, m0, 4096
    s_add_u32 s54, s54, 4096
    buffer_load_dwordx4 v4, s[36:39], s54 offen offset:0 sc1 lds
    s_waitcnt lgkmcnt(1)
    v_mfma_f32_16x16x32_bf16 v[20:23], v[120:123], a[84:87], v[20:23]
    ds_read_b128 a[92:95], v8 offset:23552
    v_mfma_f32_16x16x32_bf16 v[28:31], v[124:127], a[84:87], v[28:31]
    s_cmp_lt_u32 s30, 2
    s_cselect_b32 s83, s83, s30
    v_mfma_f32_16x16x32_bf16 v[36:39], v[128:131], a[84:87], v[36:39]
    s_mul_i32 s70, s30, 12288
    s_add_u32 s70, s70, s75
    s_waitcnt lgkmcnt(1)
    v_mfma_f32_16x16x32_bf16 v[16:19], v[132:135], a[88:91], v[16:19]
    ds_read_b128 a[80:83], v8 offset:4096
    v_mfma_f32_16x16x32_bf16 v[24:27], v[136:139], a[88:91], v[24:27]
    s_and_b32 s84, s80, 1
    s_mul_i32 s84, s84, 40960
    v_mfma_f32_16x16x32_bf16 v[32:35], v[140:143], a[88:91], v[32:35]
    buffer_load_dwordx4 v4, s[36:39], s54 offen offset:2048 sc1 lds
    s_waitcnt lgkmcnt(1)
    v_mfma_f32_16x16x32_bf16 v[20:23], v[132:135], a[92:95], v[20:23]
    ds_read_b128 a[84:87], v8 offset:24576
    v_mfma_f32_16x16x32_bf16 v[28:31], v[136:139], a[92:95], v[28:31]
    s_add_u32 s84, s84, s70
    s_add_u32 s84, s84, 1048576
    v_mfma_f32_16x16x32_bf16 v[36:39], v[140:143], a[92:95], v[36:39]
    s_mul_i32 s53, s80, 12288
    s_add_u32 s53, s53, s76
    s_waitcnt lgkmcnt(1)
    v_mfma_f32_16x16x32_bf16 v[16:19], v[144:147], a[80:83], v[16:19]
    ds_read_b128 a[88:91], v8 offset:5120
    v_mfma_f32_16x16x32_bf16 v[24:27], v[148:151], a[80:83], v[24:27]
    s_cmp_eq_u32 s30, 3
    s_cselect_b32 s84, s53, s84
    v_mfma_f32_16x16x32_bf16 v[32:35], v[152:155], a[80:83], v[32:35]
    s_add_u32 m0, m0, 4096
    s_add_u32 s54, s54, 4096
    buffer_load_dwordx4 v4, s[36:39], s54 offen offset:0 sc1 lds
    s_waitcnt lgkmcnt(1)
    v_mfma_f32_16x16x32_bf16 v[20:23], v[144:147], a[84:87], v[20:23]
    ds_read_b128 a[92:95], v8 offset:25600
    v_mfma_f32_16x16x32_bf16 v[28:31], v[148:151], a[84:87], v[28:31]
    s_and_b32 s85, s81, 1
    s_mul_i32 s85, s85, 40960
    v_mfma_f32_16x16x32_bf16 v[36:39], v[152:155], a[84:87], v[36:39]
    s_add_u32 s85, s85, s70
    s_add_u32 s85, s85, 1048576
    s_waitcnt vmcnt(4)
    s_barrier
    s_waitcnt lgkmcnt(1)
    v_mfma_f32_16x16x32_bf16 v[16:19], v[156:159], a[88:91], v[16:19]
    ds_read_b128 a[80:83], v8 offset:6144
    v_mfma_f32_16x16x32_bf16 v[24:27], v[160:163], a[88:91], v[24:27]
    s_mul_i32 s53, s81, 12288
    s_add_u32 s53, s53, s76
    v_mfma_f32_16x16x32_bf16 v[32:35], v[164:167], a[88:91], v[32:35]
    s_cmp_eq_u32 s30, 3
    s_cselect_b32 s85, s53, s85
    s_waitcnt lgkmcnt(1)
    v_mfma_f32_16x16x32_bf16 v[20:23], v[156:159], a[92:95], v[20:23]
    ds_read_b128 a[84:87], v8 offset:26624
    v_mfma_f32_16x16x32_bf16 v[28:31], v[160:163], a[92:95], v[28:31]
    s_and_b32 s86, s82, 1
    s_mul_i32 s86, s86, 40960
    v_mfma_f32_16x16x32_bf16 v[36:39], v[164:167], a[92:95], v[36:39]
    s_add_u32 s86, s86, s70
    s_add_u32 s86, s86, 4194304
    s_waitcnt lgkmcnt(1)
    v_mfma_f32_16x16x32_bf16 v[16:19], v[168:171], a[80:83], v[16:19]
    ds_read_b128 a[88:91], v8 offset:7168
    v_mfma_f32_16x16x32_bf16 v[24:27], v[172:175], a[80:83], v[24:27]
    s_mul_i32 s53, s82, 12288
    s_add_u32 s53, s53, s76
    v_mfma_f32_16x16x32_bf16 v[32:35], v[176:179], a[80:83], v[32:35]
    s_cmp_eq_u32 s30, 3
    s_cselect_b32 s86, s53, s86
    s_waitcnt lgkmcnt(1)
    v_mfma_f32_16x16x32_bf16 v[20:23], v[168:171], a[84:87], v[20:23]
    ds_read_b128 a[92:95], v8 offset:27648
    v_mfma_f32_16x16x32_bf16 v[28:31], v[172:175], a[84:87], v[28:31]
    s_and_b32 s87, s83, 1
    s_mul_i32 s87, s87, 40960
    v_mfma_f32_16x16x32_bf16 v[36:39], v[176:179], a[84:87], v[36:39]
    s_add_u32 s87, s87, s70
    s_add_u32 s87, s87, 4194304
    s_waitcnt lgkmcnt(1)
    v_mfma_f32_16x16x32_bf16 v[16:19], v[180:183], a[88:91], v[16:19]
    ds_read_b128 a[80:83], v8 offset:8192
    v_mfma_f32_16x16x32_bf16 v[24:27], v[184:187], a[88:91], v[24:27]
    s_mul_i32 s53, s83, 12288
    s_add_u32 s53, s53, s76
    v_mfma_f32_16x16x32_bf16 v[32:35], v[188:191], a[88:91], v[32:35]
    s_cmp_eq_u32 s30, 3
    s_cselect_b32 s87, s53, s87
    s_waitcnt lgkmcnt(1)
    v_mfma_f32_16x16x32_bf16 v[20:23], v[180:183], a[92:95], v[20:23]
    ds_read_b128 a[84:87], v8 offset:28672
    v_mfma_f32_16x16x32_bf16 v[28:31], v[184:187], a[92:95], v[28:31]
    s_sub_u32 s53, s30, 2
    v_mfma_f32_16x16x32_bf16 v[36:39], v[188:191], a[92:95], v[36:39]
    s_cmp_lt_u32 s30, 2
    s_cselect_b32 s88, 2, s53
    s_mov_b32 s58, 8388608
L_adaLN_cond__grouped_kv_mqa__dense_activation_silu__prompt_kernel_pyb_61:
    buffer_load_dwordx2 v[92:93], v11, s[36:39], s59 offen offset:16 sc1
    s_sub_u32 s58, s58, 1
    s_cbranch_scc1 L_adaLN_cond__grouped_kv_mqa__dense_activation_silu__prompt_kernel_pybd_63
    s_waitcnt vmcnt(0)
L_adaLN_cond__grouped_kv_mqa__dense_activation_silu__prompt_kernel_pybc_62:
    v_cmp_ne_u64 vcc, s[32:33], v[92:93]
    s_cbranch_vccz L_adaLN_cond__grouped_kv_mqa__dense_activation_silu__prompt_kernel_pybd_63
    s_sleep 1
    s_branch L_adaLN_cond__grouped_kv_mqa__dense_activation_silu__prompt_kernel_pyb_61
L_adaLN_cond__grouped_kv_mqa__dense_activation_silu__prompt_kernel_pybd_63:
    s_waitcnt lgkmcnt(1)
    v_mfma_f32_16x16x32_bf16 v[16:19], v[192:195], a[80:83], v[16:19]
    ds_read_b128 a[88:91], v8 offset:9216
    v_mfma_f32_16x16x32_bf16 v[24:27], v[196:199], a[80:83], v[24:27]
    s_add_u32 m0, s61, 0
    s_add_u32 s54, s60, 40960
    v_mfma_f32_16x16x32_bf16 v[32:35], v[200:203], a[80:83], v[32:35]
    buffer_load_dwordx4 v4, s[36:39], s54 offen offset:0 sc1 lds
    s_waitcnt lgkmcnt(1)
    v_mfma_f32_16x16x32_bf16 v[20:23], v[192:195], a[84:87], v[20:23]
    ds_read_b128 a[92:95], v8 offset:29696
    v_mfma_f32_16x16x32_bf16 v[28:31], v[196:199], a[84:87], v[28:31]
    s_mul_i32 s88, s88, 5120
    s_and_b32 s80, s80, 1
    v_mfma_f32_16x16x32_bf16 v[36:39], v[200:203], a[84:87], v[36:39]
    buffer_load_dwordx4 v4, s[36:39], s54 offen offset:1024 sc1 lds
    s_waitcnt lgkmcnt(1)
    v_mfma_f32_16x16x32_bf16 v[16:19], v[204:207], a[88:91], v[16:19]
    ds_read_b128 a[80:83], v8 offset:10240
    v_mfma_f32_16x16x32_bf16 v[24:27], v[208:211], a[88:91], v[24:27]
    s_mul_i32 s80, s80, 15360
    s_add_u32 s88, s88, s80
    v_mfma_f32_16x16x32_bf16 v[32:35], v[212:215], a[88:91], v[32:35]
    buffer_load_dwordx4 v4, s[36:39], s54 offen offset:2048 sc1 lds
    s_waitcnt lgkmcnt(1)
    v_mfma_f32_16x16x32_bf16 v[20:23], v[204:207], a[92:95], v[20:23]
    ds_read_b128 a[84:87], v8 offset:30720
    v_mfma_f32_16x16x32_bf16 v[28:31], v[208:211], a[92:95], v[28:31]
    s_add_u32 s88, s88, 102400
    v_mfma_f32_16x16x32_bf16 v[36:39], v[212:215], a[92:95], v[36:39]
    buffer_load_dwordx4 v4, s[36:39], s54 offen offset:3072 sc1 lds
    s_waitcnt lgkmcnt(1)
    v_mfma_f32_16x16x32_bf16 v[16:19], v[216:219], a[80:83], v[16:19]
    ds_read_b128 a[88:91], v8 offset:11264
    v_mfma_f32_16x16x32_bf16 v[24:27], v[220:223], a[80:83], v[24:27]
    s_add_u32 m0, s61, 4096
    s_add_u32 s54, s60, 45056
    v_mfma_f32_16x16x32_bf16 v[32:35], v[224:227], a[80:83], v[32:35]
    buffer_load_dwordx4 v4, s[36:39], s54 offen offset:0 sc1 lds
    s_waitcnt lgkmcnt(1)
    v_mfma_f32_16x16x32_bf16 v[20:23], v[216:219], a[84:87], v[20:23]
    ds_read_b128 a[92:95], v8 offset:31744
    v_mfma_f32_16x16x32_bf16 v[28:31], v[220:223], a[84:87], v[28:31]
    s_add_u32 m0, s61, 20480
    s_add_u32 s54, s60, 61440
    v_mfma_f32_16x16x32_bf16 v[36:39], v[224:227], a[84:87], v[36:39]
    buffer_load_dwordx4 v4, s[36:39], s54 offen offset:0 sc1 lds
    s_waitcnt vmcnt(7)
    s_barrier
    s_waitcnt lgkmcnt(1)
    v_mfma_f32_16x16x32_bf16 v[16:19], v[228:231], a[88:91], v[16:19]
    ds_read_b128 a[80:83], v8 offset:12288
    v_mfma_f32_16x16x32_bf16 v[24:27], v[232:235], a[88:91], v[24:27]
    s_cmp_lt_u32 s30, 2
    s_cselect_b32 s89, 0, s53
    v_mfma_f32_16x16x32_bf16 v[32:35], v[236:239], a[88:91], v[32:35]
    buffer_load_dwordx4 v4, s[36:39], s54 offen offset:1024 sc1 lds
    s_waitcnt lgkmcnt(1)
    v_mfma_f32_16x16x32_bf16 v[20:23], v[228:231], a[92:95], v[20:23]
    ds_read_b128 a[84:87], v8 offset:32768
    v_mfma_f32_16x16x32_bf16 v[28:31], v[232:235], a[92:95], v[28:31]
    s_mul_i32 s89, s89, 5120
    s_and_b32 s81, s81, 1
    v_mfma_f32_16x16x32_bf16 v[36:39], v[236:239], a[92:95], v[36:39]
    buffer_load_dwordx4 v4, s[36:39], s54 offen offset:2048 sc1 lds
    s_waitcnt lgkmcnt(1)
    v_mfma_f32_16x16x32_bf16 v[16:19], v[240:243], a[80:83], v[16:19]
    ds_read_b128 a[88:91], v8 offset:13312
    v_mfma_f32_16x16x32_bf16 v[24:27], v[244:247], a[80:83], v[24:27]
    s_mul_i32 s81, s81, 15360
    s_add_u32 s89, s89, s81
    v_mfma_f32_16x16x32_bf16 v[32:35], v[248:251], a[80:83], v[32:35]
    buffer_load_dwordx4 v4, s[36:39], s54 offen offset:3072 sc1 lds
    s_waitcnt lgkmcnt(1)
    v_mfma_f32_16x16x32_bf16 v[20:23], v[240:243], a[84:87], v[20:23]
    ds_read_b128 a[92:95], v8 offset:33792
    v_mfma_f32_16x16x32_bf16 v[28:31], v[244:247], a[84:87], v[28:31]
    s_add_u32 m0, s61, 24576
    s_add_u32 s54, s60, 65536
    v_mfma_f32_16x16x32_bf16 v[36:39], v[248:251], a[84:87], v[36:39]
    buffer_load_dwordx4 v4, s[36:39], s54 offen offset:0 sc1 lds
    s_waitcnt lgkmcnt(1)
    v_mfma_f32_16x16x32_bf16 v[16:19], v[252:255], a[88:91], v[16:19]
    ds_read_b128 a[80:83], v8 offset:14336
    v_mfma_f32_16x16x32_bf16 v[24:27], a[0:3], a[88:91], v[24:27]
    s_add_u32 s89, s89, 102400
    v_mfma_f32_16x16x32_bf16 v[32:35], a[4:7], a[88:91], v[32:35]
    buffer_load_dwordx4 v[84:87], v9, s[36:39], s55 offen offset:2048 sc1
    buffer_load_dwordx4 v[88:91], v9, s[36:39], s55 offen offset:3072 sc1
    s_waitcnt lgkmcnt(1)
    v_mfma_f32_16x16x32_bf16 v[20:23], v[252:255], a[92:95], v[20:23]
    ds_read_b128 a[84:87], v8 offset:34816
    v_mfma_f32_16x16x32_bf16 v[28:31], a[0:3], a[92:95], v[28:31]
    s_add_u32 m0, s74, 40960
    s_add_u32 s54, s73, 36864
    v_mfma_f32_16x16x32_bf16 v[36:39], a[4:7], a[92:95], v[36:39]
    buffer_load_dwordx4 v4, s[36:39], s54 offen offset:0 sc1 lds
    s_waitcnt lgkmcnt(1)
    v_mfma_f32_16x16x32_bf16 v[16:19], a[8:11], a[80:83], v[16:19]
    ds_read_b128 a[88:91], v8 offset:15360
    v_mfma_f32_16x16x32_bf16 v[24:27], a[12:15], a[80:83], v[24:27]
    s_cmp_lt_u32 s30, 2
    s_cselect_b32 s90, 1, 0
    v_mfma_f32_16x16x32_bf16 v[32:35], a[16:19], a[80:83], v[32:35]
    buffer_load_dwordx4 v4, s[36:39], s54 offen offset:1024 sc1 lds
    s_waitcnt lgkmcnt(1)
    v_mfma_f32_16x16x32_bf16 v[20:23], a[8:11], a[84:87], v[20:23]
    ds_read_b128 a[92:95], v8 offset:35840
    v_mfma_f32_16x16x32_bf16 v[28:31], a[12:15], a[84:87], v[28:31]
    s_mul_i32 s90, s90, 5120
    s_and_b32 s82, s82, 1
    v_mfma_f32_16x16x32_bf16 v[36:39], a[16:19], a[84:87], v[36:39]
    buffer_load_dwordx4 v4, s[36:39], s54 offen offset:2048 sc1 lds
    s_waitcnt lgkmcnt(1)
    v_mfma_f32_16x16x32_bf16 v[16:19], a[20:23], a[88:91], v[16:19]
    ds_read_b128 a[80:83], v8 offset:16384
    v_mfma_f32_16x16x32_bf16 v[24:27], a[24:27], a[88:91], v[24:27]
    s_mul_i32 s82, s82, 15360
    s_add_u32 s90, s90, s82
    v_mfma_f32_16x16x32_bf16 v[32:35], a[28:31], a[88:91], v[32:35]
    buffer_load_dwordx4 v4, s[36:39], s54 offen offset:3072 sc1 lds
    s_waitcnt lgkmcnt(1)
    v_mfma_f32_16x16x32_bf16 v[20:23], a[20:23], a[92:95], v[20:23]
    ds_read_b128 a[84:87], v8 offset:36864
    v_mfma_f32_16x16x32_bf16 v[28:31], a[24:27], a[92:95], v[28:31]
    s_add_u32 m0, s74, 45056
    s_add_u32 s54, s73, 40960
    v_mfma_f32_16x16x32_bf16 v[36:39], a[28:31], a[92:95], v[36:39]
    buffer_load_dwordx4 v4, s[36:39], s54 offen offset:0 sc1 lds
    s_waitcnt lgkmcnt(1)
    v_mfma_f32_16x16x32_bf16 v[16:19], a[32:35], a[80:83], v[16:19]
    ds_read_b128 a[88:91], v8 offset:17408
    v_mfma_f32_16x16x32_bf16 v[24:27], a[36:39], a[80:83], v[24:27]
    s_cmp_lt_u32 s30, 2
    s_cselect_b32 s93, 2, 0
    v_mfma_f32_16x16x32_bf16 v[32:35], a[40:43], a[80:83], v[32:35]
    buffer_load_dwordx4 v4, s[36:39], s54 offen offset:1024 sc1 lds
    s_waitcnt lgkmcnt(1)
    v_mfma_f32_16x16x32_bf16 v[20:23], a[32:35], a[84:87], v[20:23]
    ds_read_b128 a[92:95], v8 offset:37888
    v_mfma_f32_16x16x32_bf16 v[28:31], a[36:39], a[84:87], v[28:31]
    s_mul_i32 s93, s93, 5120
    s_and_b32 s83, s83, 1
    v_mfma_f32_16x16x32_bf16 v[36:39], a[40:43], a[84:87], v[36:39]
    buffer_load_dwordx4 v4, s[36:39], s54 offen offset:2048 sc1 lds
    s_waitcnt lgkmcnt(1)
    v_mfma_f32_16x16x32_bf16 v[16:19], a[44:47], a[88:91], v[16:19]
    ds_read_b128 a[80:83], v8 offset:18432
    v_mfma_f32_16x16x32_bf16 v[24:27], a[48:51], a[88:91], v[24:27]
    s_mul_i32 s83, s83, 15360
    s_add_u32 s93, s93, s83
    v_mfma_f32_16x16x32_bf16 v[32:35], a[52:55], a[88:91], v[32:35]
    buffer_load_dwordx4 v4, s[36:39], s54 offen offset:3072 sc1 lds
    s_waitcnt lgkmcnt(1)
    v_mfma_f32_16x16x32_bf16 v[20:23], a[44:47], a[92:95], v[20:23]
    ds_read_b128 a[84:87], v8 offset:38912
    v_mfma_f32_16x16x32_bf16 v[28:31], a[48:51], a[92:95], v[28:31]
    s_add_u32 m0, s74, 49152
    s_add_u32 s54, s73, 45056
    v_mfma_f32_16x16x32_bf16 v[36:39], a[52:55], a[92:95], v[36:39]
    buffer_load_dwordx4 v4, s[36:39], s54 offen offset:0 sc1 lds
    s_waitcnt lgkmcnt(1)
    v_mfma_f32_16x16x32_bf16 v[16:19], a[56:59], a[80:83], v[16:19]
    ds_read_b128 a[88:91], v8 offset:19456
    v_mfma_f32_16x16x32_bf16 v[24:27], a[60:63], a[80:83], v[24:27]
    s_waitcnt vmcnt(9)
    v_add_f32 v84, v84, v86
    v_mfma_f32_16x16x32_bf16 v[32:35], a[64:67], a[80:83], v[32:35]
    buffer_load_dwordx4 v4, s[36:39], s54 offen offset:1024 sc1 lds
    s_waitcnt lgkmcnt(1)
    v_mfma_f32_16x16x32_bf16 v[20:23], a[56:59], a[84:87], v[20:23]
    ds_read_b128 a[92:95], v8 offset:39936
    v_mfma_f32_16x16x32_bf16 v[28:31], a[60:63], a[84:87], v[28:31]
    v_add_f32 v85, v85, v87
    v_add_f32 v88, v88, v90
    v_mfma_f32_16x16x32_bf16 v[36:39], a[64:67], a[84:87], v[36:39]
    buffer_load_dwordx4 v4, s[36:39], s54 offen offset:2048 sc1 lds
    s_waitcnt lgkmcnt(1)
    v_mfma_f32_16x16x32_bf16 v[16:19], a[68:71], a[88:91], v[16:19]
    v_add_f32 v89, v89, v91
    v_mov_b32 v86, v84
    v_mfma_f32_16x16x32_bf16 v[24:27], a[72:75], a[88:91], v[24:27]
    v_mov_b32 v87, v85
    v_mov_b32 v90, v88
    v_mfma_f32_16x16x32_bf16 v[32:35], a[76:79], a[88:91], v[32:35]
    buffer_load_dwordx4 v4, s[36:39], s54 offen offset:3072 sc1 lds
    s_waitcnt lgkmcnt(0)
    v_mfma_f32_16x16x32_bf16 v[20:23], a[68:71], a[92:95], v[20:23]
    v_mov_b32 v91, v89
    s_nop 0
    v_mfma_f32_16x16x32_bf16 v[28:31], a[72:75], a[92:95], v[28:31]
    s_add_u32 m0, s74, 53248
    s_add_u32 s54, s73, 49152
    v_mfma_f32_16x16x32_bf16 v[36:39], a[76:79], a[92:95], v[36:39]
    buffer_load_dwordx4 v4, s[36:39], s54 offen offset:0 sc1 lds
    s_waitcnt vmcnt(15)
    s_barrier
    ds_read_b128 a[80:83], v4 offset:0
    ds_read_b128 a[84:87], v4 offset:20480
    v_permlane16_swap_b32 v84, v86
    v_permlane16_swap_b32 v85, v87
    v_permlane16_swap_b32 v88, v90
    v_permlane16_swap_b32 v89, v91
    v_add_f32 v84, v84, v86
    v_add_f32 v85, v85, v87
    v_add_f32 v88, v88, v90
    v_add_f32 v89, v89, v91
    v_mov_b32 v86, v84
    v_mov_b32 v87, v85
    v_mov_b32 v90, v88
    v_mov_b32 v91, v89
    s_nop 0
    v_permlane32_swap_b32 v84, v86
    v_permlane32_swap_b32 v85, v87
    v_permlane32_swap_b32 v88, v90
    v_permlane32_swap_b32 v89, v91
    v_add_f32 v84, v84, v86
    v_add_f32 v85, v85, v87
    v_add_f32 v88, v88, v90
    v_add_f32 v89, v89, v91
    v_mul_f32 v84, 0x3acccccd, v84
    v_mul_f32 v85, 0x3acccccd, v85
    v_mul_f32 v88, 0x3acccccd, v88
    v_mul_f32 v89, 0x3acccccd, v89
    v_fma_f32 v85, -v84, v84, v85
    v_fma_f32 v89, -v88, v88, v89
    v_max_f32 v85, 0, v85
    v_max_f32 v89, 0, v89
    v_add_f32 v85, 0x3727c5ac, v85
    v_add_f32 v89, 0x3727c5ac, v89
    v_rsq_f32 v85, v85
    v_rsq_f32 v89, v89
    s_nop 0
    v_mul_f32 v68, 0xbfb8aa3b, v85
    v_mul_f32 v70, 0xbfb8aa3b, v89
    v_mul_f32 v69, -v84, v68
    v_mul_f32 v71, -v88, v70
    s_waitcnt lgkmcnt(1)
    v_mfma_f32_16x16x32_bf16 v[40:43], v[96:99], a[80:83], 0
    ds_read_b128 a[88:91], v4 offset:1024
    ds_read_b128 v[72:75], v7 offset:0
    ds_read_b128 v[76:79], v7 offset:192
    v_mfma_f32_16x16x32_bf16 v[48:51], v[100:103], a[80:83], 0
    v_mfma_f32_16x16x32_bf16 v[56:59], v[104:107], a[80:83], 0
    buffer_load_dwordx4 v4, s[36:39], s54 offen offset:1024 sc1 lds
    s_waitcnt lgkmcnt(0)
    v_fma_f32 v80, v72, v65, v76
    v_fma_f32 v81, v73, v65, v77
    v_fma_f32 v82, v74, v65, v78
    s_waitcnt lgkmcnt(3)
    v_mfma_f32_16x16x32_bf16 v[44:47], v[96:99], a[84:87], 0
    ds_read_b128 a[92:95], v4 offset:21504
    v_fma_f32 v83, v75, v65, v79
    v_fma_f32 v84, v72, v67, v76
    v_fma_f32 v85, v73, v67, v77
    v_fma_f32 v86, v74, v67, v78
    v_mfma_f32_16x16x32_bf16 v[52:55], v[100:103], a[84:87], 0
    v_fma_f32 v87, v75, v67, v79
    v_fma_f32 v16, v16, v64, v80
    v_fma_f32 v17, v17, v64, v81
    v_fma_f32 v18, v18, v64, v82
    v_fma_f32 v19, v19, v64, v83
    v_fma_f32 v20, v20, v66, v84
    v_mfma_f32_16x16x32_bf16 v[60:63], v[104:107], a[84:87], 0
    v_fma_f32 v21, v21, v66, v85
    v_fma_f32 v22, v22, v66, v86
    v_fma_f32 v23, v23, v66, v87
    v_exp_f32 v80, v16
    s_waitcnt lgkmcnt(3)
    v_mfma_f32_16x16x32_bf16 v[40:43], v[108:111], a[88:91], v[40:43]
    ds_read_b128 a[80:83], v4 offset:2048
    v_exp_f32 v81, v17
    v_exp_f32 v82, v18
    v_mfma_f32_16x16x32_bf16 v[48:51], v[112:115], a[88:91], v[48:51]
    v_exp_f32 v83, v19
    v_exp_f32 v84, v20
    v_exp_f32 v85, v21
    v_mfma_f32_16x16x32_bf16 v[56:59], v[116:119], a[88:91], v[56:59]
    buffer_load_dwordx4 v4, s[36:39], s54 offen offset:2048 sc1 lds
    v_exp_f32 v86, v22
    v_exp_f32 v87, v23
    s_waitcnt lgkmcnt(1)
    v_mfma_f32_16x16x32_bf16 v[44:47], v[108:111], a[92:95], v[44:47]
    ds_read_b128 a[84:87], v4 offset:22528
    v_add_f32 v80, 1.0, v80
    v_add_f32 v81, 1.0, v81
    v_add_f32 v82, 1.0, v82
    v_add_f32 v83, 1.0, v83
    v_mfma_f32_16x16x32_bf16 v[52:55], v[112:115], a[92:95], v[52:55]
    v_add_f32 v84, 1.0, v84
    v_add_f32 v85, 1.0, v85
    v_add_f32 v86, 1.0, v86
    v_add_f32 v87, 1.0, v87
    v_rcp_f32 v80, v80
    v_mfma_f32_16x16x32_bf16 v[60:63], v[116:119], a[92:95], v[60:63]
    v_rcp_f32 v81, v81
    v_rcp_f32 v82, v82
    v_rcp_f32 v83, v83
    s_waitcnt lgkmcnt(1)
    v_mfma_f32_16x16x32_bf16 v[40:43], v[120:123], a[80:83], v[40:43]
    ds_read_b128 a[88:91], v4 offset:3072
    v_rcp_f32 v84, v84
    v_rcp_f32 v85, v85
    v_mfma_f32_16x16x32_bf16 v[48:51], v[124:127], a[80:83], v[48:51]
    s_add_u32 s54, s73, 32768
    v_rcp_f32 v86, v86
    v_rcp_f32 v87, v87
    v_mfma_f32_16x16x32_bf16 v[56:59], v[128:131], a[80:83], v[56:59]
    buffer_load_dwordx4 a[240:243], v4, s[36:39], s54 offen offset:0 sc1
    v_mul_f32 v16, v16, v80
    v_mul_f32 v17, v17, v81
    v_mul_f32 v18, v18, v82
    v_mul_f32 v19, v19, v83
    s_waitcnt lgkmcnt(1)
    v_mfma_f32_16x16x32_bf16 v[44:47], v[120:123], a[84:87], v[44:47]
    ds_read_b128 a[92:95], v4 offset:23552
    v_mul_f32 v20, v20, v84
    v_mul_f32 v21, v21, v85
    v_mul_f32 v22, v22, v86
    v_mul_f32 v23, v23, v87
    v_mfma_f32_16x16x32_bf16 v[52:55], v[124:127], a[84:87], v[52:55]
    v_cvt_pk_bf16_f32 v88, v16, v17
    v_cvt_pk_bf16_f32 v89, v18, v19
    v_cvt_pk_bf16_f32 v90, v20, v21
    v_cvt_pk_bf16_f32 v91, v22, v23
    s_nop 1
    v_mfma_f32_16x16x32_bf16 v[60:63], v[128:131], a[84:87], v[60:63]
    v_permlane16_swap_b32 v88, v90
    v_permlane16_swap_b32 v89, v91
    s_waitcnt lgkmcnt(1)
    v_mfma_f32_16x16x32_bf16 v[40:43], v[132:135], a[88:91], v[40:43]
    ds_read_b128 a[80:83], v4 offset:4096
    v_mfma_f32_16x16x32_bf16 v[48:51], v[136:139], a[88:91], v[48:51]
    s_cmp_eq_u32 s92, 0
    s_cbranch_scc1 L_adaLN_cond__grouped_kv_mqa__dense_activation_silu__prompt_kernel_wt_64
    buffer_store_dwordx4 v[88:91], v10, s[36:39], s64 offen offset:0
    s_branch L_adaLN_cond__grouped_kv_mqa__dense_activation_silu__prompt_kernel_wd_65
L_adaLN_cond__grouped_kv_mqa__dense_activation_silu__prompt_kernel_wt_64:
    buffer_store_dwordx4 v[88:91], v10, s[36:39], s64 offen offset:0 sc1
L_adaLN_cond__grouped_kv_mqa__dense_activation_silu__prompt_kernel_wd_65:
    v_mfma_f32_16x16x32_bf16 v[56:59], v[140:143], a[88:91], v[56:59]
    buffer_load_dwordx4 a[244:247], v4, s[36:39], s54 offen offset:1024 sc1
    ds_read_b128 v[72:75], v7 offset:64
    ds_read_b128 v[76:79], v7 offset:256
    s_waitcnt lgkmcnt(3)
    v_mfma_f32_16x16x32_bf16 v[44:47], v[132:135], a[92:95], v[44:47]
    ds_read_b128 a[84:87], v4 offset:24576
    s_waitcnt lgkmcnt(1)
    v_fma_f32 v80, v72, v65, v76
    v_fma_f32 v81, v73, v65, v77
    v_fma_f32 v82, v74, v65, v78
    v_mfma_f32_16x16x32_bf16 v[52:55], v[136:139], a[92:95], v[52:55]
    v_fma_f32 v83, v75, v65, v79
    v_fma_f32 v84, v72, v67, v76
    v_fma_f32 v85, v73, v67, v77
    v_fma_f32 v86, v74, v67, v78
    v_fma_f32 v87, v75, v67, v79
    v_fma_f32 v24, v24, v64, v80
    v_mfma_f32_16x16x32_bf16 v[60:63], v[140:143], a[92:95], v[60:63]
    v_fma_f32 v25, v25, v64, v81
    v_fma_f32 v26, v26, v64, v82
    v_fma_f32 v27, v27, v64, v83
    v_fma_f32 v28, v28, v66, v84
    v_fma_f32 v29, v29, v66, v85
    v_fma_f32 v30, v30, v66, v86
    s_waitcnt lgkmcnt(3)
    v_mfma_f32_16x16x32_bf16 v[40:43], v[144:147], a[80:83], v[40:43]
    ds_read_b128 a[88:91], v4 offset:5120
    v_fma_f32 v31, v31, v66, v87
    v_exp_f32 v80, v24
    v_mfma_f32_16x16x32_bf16 v[48:51], v[148:151], a[80:83], v[48:51]
    v_exp_f32 v81, v25
    v_exp_f32 v82, v26
    v_exp_f32 v83, v27
    v_mfma_f32_16x16x32_bf16 v[56:59], v[152:155], a[80:83], v[56:59]
    buffer_load_dwordx4 a[248:251], v4, s[36:39], s54 offen offset:2048 sc1
    v_exp_f32 v84, v28
    v_exp_f32 v85, v29
    s_waitcnt lgkmcnt(1)
    v_mfma_f32_16x16x32_bf16 v[44:47], v[144:147], a[84:87], v[44:47]
    ds_read_b128 a[92:95], v4 offset:25600
    v_exp_f32 v86, v30
    v_exp_f32 v87, v31
    v_mfma_f32_16x16x32_bf16 v[52:55], v[148:151], a[84:87], v[52:55]
    v_add_f32 v80, 1.0, v80
    v_add_f32 v81, 1.0, v81
    v_add_f32 v82, 1.0, v82
    v_add_f32 v83, 1.0, v83
    v_add_f32 v84, 1.0, v84
    v_add_f32 v85, 1.0, v85
    v_mfma_f32_16x16x32_bf16 v[60:63], v[152:155], a[84:87], v[60:63]
    v_add_f32 v86, 1.0, v86
    v_add_f32 v87, 1.0, v87
    v_rcp_f32 v80, v80
    v_rcp_f32 v81, v81
    s_waitcnt lgkmcnt(1)
    v_mfma_f32_16x16x32_bf16 v[40:43], v[156:159], a[88:91], v[40:43]
    ds_read_b128 a[80:83], v4 offset:6144
    v_rcp_f32 v82, v82
    v_rcp_f32 v83, v83
    v_mfma_f32_16x16x32_bf16 v[48:51], v[160:163], a[88:91], v[48:51]
    v_rcp_f32 v84, v84
    v_rcp_f32 v85, v85
    v_rcp_f32 v86, v86
    v_mfma_f32_16x16x32_bf16 v[56:59], v[164:167], a[88:91], v[56:59]
    buffer_load_dwordx4 a[252:255], v4, s[36:39], s54 offen offset:3072 sc1
    v_rcp_f32 v87, v87
    v_mul_f32 v24, v24, v80
    v_mul_f32 v25, v25, v81
    s_waitcnt lgkmcnt(1)
    v_mfma_f32_16x16x32_bf16 v[44:47], v[156:159], a[92:95], v[44:47]
    ds_read_b128 a[84:87], v4 offset:26624
    v_mul_f32 v26, v26, v82
    v_mul_f32 v27, v27, v83
    v_mul_f32 v28, v28, v84
    v_mul_f32 v29, v29, v85
    v_mfma_f32_16x16x32_bf16 v[52:55], v[160:163], a[92:95], v[52:55]
    v_mul_f32 v30, v30, v86
    v_mul_f32 v31, v31, v87
    v_cvt_pk_bf16_f32 v88, v24, v25
    v_cvt_pk_bf16_f32 v89, v26, v27
    v_cvt_pk_bf16_f32 v90, v28, v29
    v_cvt_pk_bf16_f32 v91, v30, v31
    v_mfma_f32_16x16x32_bf16 v[60:63], v[164:167], a[92:95], v[60:63]
    s_nop 1
    v_permlane16_swap_b32 v88, v90
    v_permlane16_swap_b32 v89, v91
    s_waitcnt lgkmcnt(1)
    v_mfma_f32_16x16x32_bf16 v[40:43], v[168:171], a[80:83], v[40:43]
    ds_read_b128 a[88:91], v4 offset:7168
    v_mfma_f32_16x16x32_bf16 v[48:51], v[172:175], a[80:83], v[48:51]
    s_add_u32 s54, s73, 52224
    v_mfma_f32_16x16x32_bf16 v[56:59], v[176:179], a[80:83], v[56:59]
    buffer_load_dwordx4 a[96:99], v4, s[36:39], s54 offen sc1
    s_waitcnt lgkmcnt(1)
    v_mfma_f32_16x16x32_bf16 v[44:47], v[168:171], a[84:87], v[44:47]
    ds_read_b128 a[92:95], v4 offset:27648
    v_mfma_f32_16x16x32_bf16 v[52:55], v[172:175], a[84:87], v[52:55]
    s_cmp_eq_u32 s92, 0
    s_cbranch_scc1 L_adaLN_cond__grouped_kv_mqa__dense_activation_silu__prompt_kernel_wt_66
    buffer_store_dwordx4 v[88:91], v10, s[36:39], s64 offen offset:512
    s_branch L_adaLN_cond__grouped_kv_mqa__dense_activation_silu__prompt_kernel_wd_67
L_adaLN_cond__grouped_kv_mqa__dense_activation_silu__prompt_kernel_wt_66:
    buffer_store_dwordx4 v[88:91], v10, s[36:39], s64 offen offset:512 sc1
L_adaLN_cond__grouped_kv_mqa__dense_activation_silu__prompt_kernel_wd_67:
    v_mfma_f32_16x16x32_bf16 v[60:63], v[176:179], a[84:87], v[60:63]
    ds_read_b128 v[72:75], v7 offset:128
    ds_read_b128 v[76:79], v7 offset:320
    s_waitcnt lgkmcnt(0)
    v_fma_f32 v80, v72, v65, v76
    s_waitcnt lgkmcnt(3)
    v_mfma_f32_16x16x32_bf16 v[40:43], v[180:183], a[88:91], v[40:43]
    ds_read_b128 a[80:83], v4 offset:8192
    v_fma_f32 v81, v73, v65, v77
    v_fma_f32 v82, v74, v65, v78
    v_fma_f32 v83, v75, v65, v79
    v_fma_f32 v84, v72, v67, v76
    v_fma_f32 v85, v73, v67, v77
    v_fma_f32 v86, v74, v67, v78
    v_mfma_f32_16x16x32_bf16 v[48:51], v[184:187], a[88:91], v[48:51]
    v_fma_f32 v87, v75, v67, v79
    v_fma_f32 v32, v32, v64, v80
    v_fma_f32 v33, v33, v64, v81
    v_fma_f32 v34, v34, v64, v82
    v_fma_f32 v35, v35, v64, v83
    v_fma_f32 v36, v36, v66, v84
    v_fma_f32 v37, v37, v66, v85
    v_fma_f32 v38, v38, v66, v86
    v_mfma_f32_16x16x32_bf16 v[56:59], v[188:191], a[88:91], v[56:59]
    v_fma_f32 v39, v39, v66, v87
    v_exp_f32 v80, v32
    v_exp_f32 v81, v33
    v_exp_f32 v82, v34
    s_waitcnt lgkmcnt(3)
    v_mfma_f32_16x16x32_bf16 v[44:47], v[180:183], a[92:95], v[44:47]
    ds_read_b128 a[84:87], v4 offset:28672
    v_exp_f32 v83, v35
    v_exp_f32 v84, v36
    v_exp_f32 v85, v37
    v_mfma_f32_16x16x32_bf16 v[52:55], v[184:187], a[92:95], v[52:55]
    v_exp_f32 v86, v38
    v_exp_f32 v87, v39
    v_add_f32 v80, 1.0, v80
    v_add_f32 v81, 1.0, v81
    v_add_f32 v82, 1.0, v82
    v_add_f32 v83, 1.0, v83
    v_mfma_f32_16x16x32_bf16 v[60:63], v[188:191], a[92:95], v[60:63]
    v_add_f32 v84, 1.0, v84
    v_add_f32 v85, 1.0, v85
    v_add_f32 v86, 1.0, v86
    v_add_f32 v87, 1.0, v87
    v_rcp_f32 v80, v80
    v_rcp_f32 v81, v81
    s_waitcnt lgkmcnt(1)
    v_mfma_f32_16x16x32_bf16 v[40:43], v[192:195], a[80:83], v[40:43]
    ds_read_b128 a[88:91], v4 offset:9216
    v_rcp_f32 v82, v82
    v_rcp_f32 v83, v83
    v_mfma_f32_16x16x32_bf16 v[48:51], v[196:199], a[80:83], v[48:51]
    v_rcp_f32 v84, v84
    v_rcp_f32 v85, v85
    v_rcp_f32 v86, v86
    v_mfma_f32_16x16x32_bf16 v[56:59], v[200:203], a[80:83], v[56:59]
    v_rcp_f32 v87, v87
    v_mul_f32 v32, v32, v80
    v_mul_f32 v33, v33, v81
    v_mul_f32 v34, v34, v82
    v_mul_f32 v35, v35, v83
    v_mul_f32 v36, v36, v84
    s_waitcnt lgkmcnt(1)
    v_mfma_f32_16x16x32_bf16 v[44:47], v[192:195], a[84:87], v[44:47]
    ds_read_b128 a[92:95], v4 offset:29696
    v_mul_f32 v37, v37, v85
    v_mul_f32 v38, v38, v86
    v_mul_f32 v39, v39, v87
    v_cvt_pk_bf16_f32 v88, v32, v33
    v_cvt_pk_bf16_f32 v89, v34, v35
    v_mfma_f32_16x16x32_bf16 v[52:55], v[196:199], a[84:87], v[52:55]
    v_cvt_pk_bf16_f32 v90, v36, v37
    v_cvt_pk_bf16_f32 v91, v38, v39
    s_nop 1
    v_permlane16_swap_b32 v88, v90
    v_permlane16_swap_b32 v89, v91
    v_mfma_f32_16x16x32_bf16 v[60:63], v[200:203], a[84:87], v[60:63]
    s_cmp_eq_u32 s92, 0
    s_cbranch_scc1 L_adaLN_cond__grouped_kv_mqa__dense_activation_silu__prompt_kernel_wt_68
    buffer_store_dwordx4 v[88:91], v10, s[36:39], s64 offen offset:1024
    s_branch L_adaLN_cond__grouped_kv_mqa__dense_activation_silu__prompt_kernel_wd_69
L_adaLN_cond__grouped_kv_mqa__dense_activation_silu__prompt_kernel_wt_68:
    buffer_store_dwordx4 v[88:91], v10, s[36:39], s64 offen offset:1024 sc1
L_adaLN_cond__grouped_kv_mqa__dense_activation_silu__prompt_kernel_wd_69:
    s_waitcnt lgkmcnt(1)
    v_mfma_f32_16x16x32_bf16 v[40:43], v[204:207], a[88:91], v[40:43]
    ds_read_b128 a[80:83], v4 offset:10240
    v_mfma_f32_16x16x32_bf16 v[48:51], v[208:211], a[88:91], v[48:51]
    v_mfma_f32_16x16x32_bf16 v[56:59], v[212:215], a[88:91], v[56:59]
    s_waitcnt lgkmcnt(1)
    v_mfma_f32_16x16x32_bf16 v[44:47], v[204:207], a[92:95], v[44:47]
    ds_read_b128 a[84:87], v4 offset:30720
    v_mfma_f32_16x16x32_bf16 v[52:55], v[208:211], a[92:95], v[52:55]
    v_mfma_f32_16x16x32_bf16 v[60:63], v[212:215], a[92:95], v[60:63]
    s_waitcnt lgkmcnt(1)
    v_mfma_f32_16x16x32_bf16 v[40:43], v[216:219], a[80:83], v[40:43]
    ds_read_b128 a[88:91], v4 offset:11264
    v_mfma_f32_16x16x32_bf16 v[48:51], v[220:223], a[80:83], v[48:51]
    v_mfma_f32_16x16x32_bf16 v[56:59], v[224:227], a[80:83], v[56:59]
    s_waitcnt lgkmcnt(1)
    v_mfma_f32_16x16x32_bf16 v[44:47], v[216:219], a[84:87], v[44:47]
    ds_read_b128 a[92:95], v4 offset:31744
    v_mfma_f32_16x16x32_bf16 v[52:55], v[220:223], a[84:87], v[52:55]
    v_mfma_f32_16x16x32_bf16 v[60:63], v[224:227], a[84:87], v[60:63]
    s_waitcnt vmcnt(0)
    v_mov_b32 v72, s32
    v_mov_b32 v73, s33
    v_mov_b32 v74, 0
    s_mov_b64 exec, 1
    s_cmp_eq_u32 s92, 0
    s_cbranch_scc1 L_adaLN_cond__grouped_kv_mqa__dense_activation_silu__prompt_kernel_wt_70
    buffer_store_dwordx2 v[72:73], v74, s[36:39], s66 offen
    s_branch L_adaLN_cond__grouped_kv_mqa__dense_activation_silu__prompt_kernel_wd_71
L_adaLN_cond__grouped_kv_mqa__dense_activation_silu__prompt_kernel_wt_70:
    buffer_store_dwordx2 v[72:73], v74, s[36:39], s66 offen sc1
    s_mov_b64 exec, -1
    v_mul_u32_u24 v72, 5462, v1
    v_lshrrev_b32 v72, 16, v72
    v_mul_u32_u24 v73, 12, v72
    v_sub_u32 v73, v1, v73
    v_mul_u32_u24 v72, s77, v72
    v_lshl_add_u32 v72, v73, 7, v72
    s_mov_b32 exec_lo, 0xffffff
    s_mov_b32 exec_hi, 0x0
    buffer_load_dword v14, v72, s[36:39], s64 offen sc1
L_adaLN_cond__grouped_kv_mqa__dense_activation_silu__prompt_kernel_wd_71:
    s_mov_b64 exec, -1
    s_waitcnt lgkmcnt(1)
    v_mfma_f32_16x16x32_bf16 v[40:43], v[228:231], a[88:91], v[40:43]
    ds_read_b128 a[80:83], v4 offset:12288
    v_mfma_f32_16x16x32_bf16 v[48:51], v[232:235], a[88:91], v[48:51]
    v_mfma_f32_16x16x32_bf16 v[56:59], v[236:239], a[88:91], v[56:59]
    s_waitcnt lgkmcnt(1)
    v_mfma_f32_16x16x32_bf16 v[44:47], v[228:231], a[92:95], v[44:47]
    ds_read_b128 a[84:87], v4 offset:32768
    v_mfma_f32_16x16x32_bf16 v[52:55], v[232:235], a[92:95], v[52:55]
    v_mfma_f32_16x16x32_bf16 v[60:63], v[236:239], a[92:95], v[60:63]
    s_waitcnt lgkmcnt(1)
    v_mfma_f32_16x16x32_bf16 v[40:43], v[240:243], a[80:83], v[40:43]
    ds_read_b128 a[88:91], v4 offset:13312
    v_mfma_f32_16x16x32_bf16 v[48:51], v[244:247], a[80:83], v[48:51]
    v_mfma_f32_16x16x32_bf16 v[56:59], v[248:251], a[80:83], v[56:59]
    s_waitcnt lgkmcnt(1)
    v_mfma_f32_16x16x32_bf16 v[44:47], v[240:243], a[84:87], v[44:47]
    ds_read_b128 a[92:95], v4 offset:33792
    v_mfma_f32_16x16x32_bf16 v[52:55], v[244:247], a[84:87], v[52:55]
    v_mfma_f32_16x16x32_bf16 v[60:63], v[248:251], a[84:87], v[60:63]
    s_waitcnt lgkmcnt(1)
    v_mfma_f32_16x16x32_bf16 v[40:43], v[252:255], a[88:91], v[40:43]
    ds_read_b128 a[80:83], v4 offset:14336
    v_mfma_f32_16x16x32_bf16 v[48:51], a[0:3], a[88:91], v[48:51]
    v_mfma_f32_16x16x32_bf16 v[56:59], a[4:7], a[88:91], v[56:59]
    s_waitcnt lgkmcnt(1)
    v_mfma_f32_16x16x32_bf16 v[44:47], v[252:255], a[92:95], v[44:47]
    ds_read_b128 a[84:87], v4 offset:34816
    v_mfma_f32_16x16x32_bf16 v[52:55], a[0:3], a[92:95], v[52:55]
    v_mfma_f32_16x16x32_bf16 v[60:63], a[4:7], a[92:95], v[60:63]
    s_add_u32 s59, s71, 45056
    s_mov_b32 s58, 8388608
L_adaLN_cond__grouped_kv_mqa__dense_activation_silu__prompt_kernel_ph0_72:
    buffer_load_dwordx2 v[72:73], v6, s[36:39], s59 offen offset:0 sc1
    s_sub_u32 s58, s58, 1
    s_cbranch_scc1 L_adaLN_cond__grouped_kv_mqa__dense_activation_silu__prompt_kernel_ph0d_74
    s_waitcnt vmcnt(0)
L_adaLN_cond__grouped_kv_mqa__dense_activation_silu__prompt_kernel_ph0c_73:
    v_cmp_ne_u64 vcc, s[32:33], v[72:73]
    s_cbranch_vccz L_adaLN_cond__grouped_kv_mqa__dense_activation_silu__prompt_kernel_ph0d_74
    s_sleep 1
    s_branch L_adaLN_cond__grouped_kv_mqa__dense_activation_silu__prompt_kernel_ph0_72
L_adaLN_cond__grouped_kv_mqa__dense_activation_silu__prompt_kernel_ph0d_74:
    s_waitcnt lgkmcnt(1)
    v_mfma_f32_16x16x32_bf16 v[40:43], a[8:11], a[80:83], v[40:43]
    ds_read_b128 a[88:91], v4 offset:15360
    v_mfma_f32_16x16x32_bf16 v[48:51], a[12:15], a[80:83], v[48:51]
    buffer_load_dwordx4 v[96:99], v4, s[36:39], s84 offen offset:0 sc1
    buffer_load_dwordx4 v[100:103], v4, s[36:39], s84 offen offset:1024 sc1
    buffer_load_dwordx4 v[104:107], v4, s[36:39], s84 offen offset:2048 sc1
    v_mfma_f32_16x16x32_bf16 v[56:59], a[16:19], a[80:83], v[56:59]
    s_waitcnt lgkmcnt(1)
    v_mfma_f32_16x16x32_bf16 v[44:47], a[8:11], a[84:87], v[44:47]
    ds_read_b128 a[92:95], v4 offset:35840
    v_mfma_f32_16x16x32_bf16 v[52:55], a[12:15], a[84:87], v[52:55]
    v_mfma_f32_16x16x32_bf16 v[60:63], a[16:19], a[84:87], v[60:63]
    s_waitcnt lgkmcnt(1)
    v_mfma_f32_16x16x32_bf16 v[40:43], a[20:23], a[88:91], v[40:43]
    ds_read_b128 a[80:83], v4 offset:16384
    v_mfma_f32_16x16x32_bf16 v[48:51], a[24:27], a[88:91], v[48:51]
    buffer_load_dwordx4 v[108:111], v4, s[36:39], s84 offen offset:3072 sc1
    s_add_u32 s84, s84, 4096
    buffer_load_dwordx4 v[112:115], v4, s[36:39], s84 offen offset:0 sc1
    buffer_load_dwordx4 v[116:119], v4, s[36:39], s84 offen offset:1024 sc1
    v_mfma_f32_16x16x32_bf16 v[56:59], a[28:31], a[88:91], v[56:59]
    s_waitcnt lgkmcnt(1)
    v_mfma_f32_16x16x32_bf16 v[44:47], a[20:23], a[92:95], v[44:47]
    ds_read_b128 a[84:87], v4 offset:36864
    v_mfma_f32_16x16x32_bf16 v[52:55], a[24:27], a[92:95], v[52:55]
    v_mfma_f32_16x16x32_bf16 v[60:63], a[28:31], a[92:95], v[60:63]
    s_waitcnt lgkmcnt(1)
    v_mfma_f32_16x16x32_bf16 v[40:43], a[32:35], a[80:83], v[40:43]
    ds_read_b128 a[88:91], v4 offset:17408
    v_mfma_f32_16x16x32_bf16 v[48:51], a[36:39], a[80:83], v[48:51]
    buffer_load_dwordx4 v[120:123], v4, s[36:39], s84 offen offset:2048 sc1
    buffer_load_dwordx4 v[124:127], v4, s[36:39], s84 offen offset:3072 sc1
    s_add_u32 s84, s84, 4096
    buffer_load_dwordx4 v[128:131], v4, s[36:39], s84 offen offset:0 sc1
    v_mfma_f32_16x16x32_bf16 v[56:59], a[40:43], a[80:83], v[56:59]
    s_waitcnt lgkmcnt(1)
    v_mfma_f32_16x16x32_bf16 v[44:47], a[32:35], a[84:87], v[44:47]
    ds_read_b128 a[92:95], v4 offset:37888
    v_mfma_f32_16x16x32_bf16 v[52:55], a[36:39], a[84:87], v[52:55]
    v_mfma_f32_16x16x32_bf16 v[60:63], a[40:43], a[84:87], v[60:63]
    s_waitcnt lgkmcnt(1)
    v_mfma_f32_16x16x32_bf16 v[40:43], a[44:47], a[88:91], v[40:43]
    ds_read_b128 a[80:83], v4 offset:18432
    v_mfma_f32_16x16x32_bf16 v[48:51], a[48:51], a[88:91], v[48:51]
    buffer_load_dwordx4 v[132:135], v4, s[36:39], s84 offen offset:1024 sc1
    buffer_load_dwordx4 v[136:139], v4, s[36:39], s84 offen offset:2048 sc1
    buffer_load_dwordx4 v[140:143], v4, s[36:39], s84 offen offset:3072 sc1
    v_mfma_f32_16x16x32_bf16 v[56:59], a[52:55], a[88:91], v[56:59]
    s_waitcnt lgkmcnt(1)
    v_mfma_f32_16x16x32_bf16 v[44:47], a[44:47], a[92:95], v[44:47]
    ds_read_b128 a[84:87], v4 offset:38912
    v_mfma_f32_16x16x32_bf16 v[52:55], a[48:51], a[92:95], v[52:55]
    v_mfma_f32_16x16x32_bf16 v[60:63], a[52:55], a[92:95], v[60:63]
    s_waitcnt lgkmcnt(1)
    v_mfma_f32_16x16x32_bf16 v[40:43], a[56:59], a[80:83], v[40:43]
    ds_read_b128 a[88:91], v4 offset:19456
    v_mfma_f32_16x16x32_bf16 v[48:51], a[60:63], a[80:83], v[48:51]
    buffer_load_dwordx4 v[144:147], v4, s[36:39], s85 offen offset:0 sc1
    buffer_load_dwordx4 v[148:151], v4, s[36:39], s85 offen offset:1024 sc1
    buffer_load_dwordx4 v[152:155], v4, s[36:39], s85 offen offset:2048 sc1
    v_mfma_f32_16x16x32_bf16 v[56:59], a[64:67], a[80:83], v[56:59]
    s_waitcnt lgkmcnt(1)
    v_mfma_f32_16x16x32_bf16 v[44:47], a[56:59], a[84:87], v[44:47]
    ds_read_b128 a[92:95], v4 offset:39936
    v_mfma_f32_16x16x32_bf16 v[52:55], a[60:63], a[84:87], v[52:55]
    v_mfma_f32_16x16x32_bf16 v[60:63], a[64:67], a[84:87], v[60:63]
    s_waitcnt lgkmcnt(1)
    v_mfma_f32_16x16x32_bf16 v[40:43], a[68:71], a[88:91], v[40:43]
    v_mfma_f32_16x16x32_bf16 v[48:51], a[72:75], a[88:91], v[48:51]
    buffer_load_dwordx4 v[156:159], v4, s[36:39], s85 offen offset:3072 sc1
    s_add_u32 s85, s85, 4096
    buffer_load_dwordx4 v[160:163], v4, s[36:39], s85 offen offset:0 sc1
    buffer_load_dwordx4 v[164:167], v4, s[36:39], s85 offen offset:1024 sc1
    v_mfma_f32_16x16x32_bf16 v[56:59], a[76:79], a[88:91], v[56:59]
    s_waitcnt lgkmcnt(0)
    v_mfma_f32_16x16x32_bf16 v[44:47], a[68:71], a[92:95], v[44:47]
    v_mfma_f32_16x16x32_bf16 v[52:55], a[72:75], a[92:95], v[52:55]
    v_mfma_f32_16x16x32_bf16 v[60:63], a[76:79], a[92:95], v[60:63]
    ds_read_b128 v[16:19], v7 offset:0
    ds_read_b128 v[20:23], v7 offset:192
    ds_read_b128 v[24:27], v7 offset:64
    ds_read_b128 v[28:31], v7 offset:256
    ds_read_b128 v[32:35], v7 offset:128
    ds_read_b128 v[36:39], v7 offset:320
    s_add_u32 s66, s66, 8192
    s_lshl_b32 s59, s30, 6
    s_add_u32 s59, s59, s71
    s_add_u32 s59, s59, 53248
    v_min_u32 v6, 56, v6
    s_barrier
    s_waitcnt lgkmcnt(4)
    v_pk_fma_f32 v[72:73], v[16:17], v[68:69], v[20:21] op_sel:[0,1,0] op_sel_hi:[1,1,1]
    v_pk_fma_f32 v[74:75], v[18:19], v[68:69], v[22:23] op_sel:[0,1,0] op_sel_hi:[1,1,1]
    v_pk_fma_f32 v[76:77], v[16:17], v[70:71], v[20:21] op_sel:[0,1,0] op_sel_hi:[1,1,1]
    v_pk_fma_f32 v[78:79], v[18:19], v[70:71], v[22:23] op_sel:[0,1,0] op_sel_hi:[1,1,1]
    v_pk_fma_f32 v[40:41], v[40:41], v[68:69], v[72:73] op_sel:[0,0,0] op_sel_hi:[1,0,1]
    v_pk_fma_f32 v[42:43], v[42:43], v[68:69], v[74:75] op_sel:[0,0,0] op_sel_hi:[1,0,1]
    v_pk_fma_f32 v[44:45], v[44:45], v[70:71], v[76:77] op_sel:[0,0,0] op_sel_hi:[1,0,1]
    v_pk_fma_f32 v[46:47], v[46:47], v[70:71], v[78:79] op_sel:[0,0,0] op_sel_hi:[1,0,1]
    v_exp_f32 v72, v40
    v_exp_f32 v73, v41
    v_exp_f32 v74, v42
    v_exp_f32 v75, v43
    v_exp_f32 v76, v44
    v_exp_f32 v77, v45
    v_exp_f32 v78, v46
    v_exp_f32 v79, v47
    v_pk_add_f32 v[72:73], v[72:73], 1.0 op_sel_hi:[1,0]
    v_pk_add_f32 v[74:75], v[74:75], 1.0 op_sel_hi:[1,0]
    v_pk_add_f32 v[76:77], v[76:77], 1.0 op_sel_hi:[1,0]
    v_pk_add_f32 v[78:79], v[78:79], 1.0 op_sel_hi:[1,0]
    v_rcp_f32 v72, v72
    v_rcp_f32 v73, v73
    v_rcp_f32 v74, v74
    v_rcp_f32 v75, v75
    v_rcp_f32 v76, v76
    v_rcp_f32 v77, v77
    v_rcp_f32 v78, v78
    v_rcp_f32 v79, v79
    v_pk_mul_f32 v[40:41], v[40:41], v[72:73]
    v_pk_mul_f32 v[42:43], v[42:43], v[74:75]
    v_pk_mul_f32 v[44:45], v[44:45], v[76:77]
    v_pk_mul_f32 v[46:47], v[46:47], v[78:79]
    v_cvt_pk_bf16_f32 v80, v40, v41
    v_cvt_pk_bf16_f32 v81, v42, v43
    v_cvt_pk_bf16_f32 v82, v44, v45
    v_cvt_pk_bf16_f32 v83, v46, v47
    s_nop 1
    v_permlane16_swap_b32 v80, v82
    v_permlane16_swap_b32 v81, v83
    s_cmp_eq_u32 s92, 0
    s_cbranch_scc1 L_adaLN_cond__grouped_kv_mqa__dense_activation_silu__prompt_kernel_wt_75
    buffer_store_dwordx4 v[80:83], v10, s[36:39], s65 offen offset:0
    s_branch L_adaLN_cond__grouped_kv_mqa__dense_activation_silu__prompt_kernel_wd_76
L_adaLN_cond__grouped_kv_mqa__dense_activation_silu__prompt_kernel_wt_75:
    buffer_store_dwordx4 v[80:83], v10, s[36:39], s65 offen offset:0 sc1
L_adaLN_cond__grouped_kv_mqa__dense_activation_silu__prompt_kernel_wd_76:
    s_waitcnt lgkmcnt(2)
    v_pk_fma_f32 v[72:73], v[24:25], v[68:69], v[28:29] op_sel:[0,1,0] op_sel_hi:[1,1,1]
    v_pk_fma_f32 v[74:75], v[26:27], v[68:69], v[30:31] op_sel:[0,1,0] op_sel_hi:[1,1,1]
    v_pk_fma_f32 v[76:77], v[24:25], v[70:71], v[28:29] op_sel:[0,1,0] op_sel_hi:[1,1,1]
    v_pk_fma_f32 v[78:79], v[26:27], v[70:71], v[30:31] op_sel:[0,1,0] op_sel_hi:[1,1,1]
    v_pk_fma_f32 v[48:49], v[48:49], v[68:69], v[72:73] op_sel:[0,0,0] op_sel_hi:[1,0,1]
    v_pk_fma_f32 v[50:51], v[50:51], v[68:69], v[74:75] op_sel:[0,0,0] op_sel_hi:[1,0,1]
    v_pk_fma_f32 v[52:53], v[52:53], v[70:71], v[76:77] op_sel:[0,0,0] op_sel_hi:[1,0,1]
    v_pk_fma_f32 v[54:55], v[54:55], v[70:71], v[78:79] op_sel:[0,0,0] op_sel_hi:[1,0,1]
    v_exp_f32 v72, v48
    v_exp_f32 v73, v49
    v_exp_f32 v74, v50
    v_exp_f32 v75, v51
    v_exp_f32 v76, v52
    v_exp_f32 v77, v53
    v_exp_f32 v78, v54
    v_exp_f32 v79, v55
    v_pk_add_f32 v[72:73], v[72:73], 1.0 op_sel_hi:[1,0]
    v_pk_add_f32 v[74:75], v[74:75], 1.0 op_sel_hi:[1,0]
    v_pk_add_f32 v[76:77], v[76:77], 1.0 op_sel_hi:[1,0]
    v_pk_add_f32 v[78:79], v[78:79], 1.0 op_sel_hi:[1,0]
    v_rcp_f32 v72, v72
    v_rcp_f32 v73, v73
    v_rcp_f32 v74, v74
    v_rcp_f32 v75, v75
    v_rcp_f32 v76, v76
    v_rcp_f32 v77, v77
    v_rcp_f32 v78, v78
    v_rcp_f32 v79, v79
    v_pk_mul_f32 v[48:49], v[48:49], v[72:73]
    v_pk_mul_f32 v[50:51], v[50:51], v[74:75]
    v_pk_mul_f32 v[52:53], v[52:53], v[76:77]
    v_pk_mul_f32 v[54:55], v[54:55], v[78:79]
    v_cvt_pk_bf16_f32 v84, v48, v49
    v_cvt_pk_bf16_f32 v85, v50, v51
    v_cvt_pk_bf16_f32 v86, v52, v53
    v_cvt_pk_bf16_f32 v87, v54, v55
    s_nop 1
    v_permlane16_swap_b32 v84, v86
    v_permlane16_swap_b32 v85, v87
    s_cmp_eq_u32 s92, 0
    s_cbranch_scc1 L_adaLN_cond__grouped_kv_mqa__dense_activation_silu__prompt_kernel_wt_77
    buffer_store_dwordx4 v[84:87], v10, s[36:39], s65 offen offset:512
    s_branch L_adaLN_cond__grouped_kv_mqa__dense_activation_silu__prompt_kernel_wd_78
L_adaLN_cond__grouped_kv_mqa__dense_activation_silu__prompt_kernel_wt_77:
    buffer_store_dwordx4 v[84:87], v10, s[36:39], s65 offen offset:512 sc1
L_adaLN_cond__grouped_kv_mqa__dense_activation_silu__prompt_kernel_wd_78:
    s_waitcnt lgkmcnt(0)
    v_pk_fma_f32 v[72:73], v[32:33], v[68:69], v[36:37] op_sel:[0,1,0] op_sel_hi:[1,1,1]
    v_pk_fma_f32 v[74:75], v[34:35], v[68:69], v[38:39] op_sel:[0,1,0] op_sel_hi:[1,1,1]
    v_pk_fma_f32 v[76:77], v[32:33], v[70:71], v[36:37] op_sel:[0,1,0] op_sel_hi:[1,1,1]
    v_pk_fma_f32 v[78:79], v[34:35], v[70:71], v[38:39] op_sel:[0,1,0] op_sel_hi:[1,1,1]
    v_pk_fma_f32 v[56:57], v[56:57], v[68:69], v[72:73] op_sel:[0,0,0] op_sel_hi:[1,0,1]
    v_pk_fma_f32 v[58:59], v[58:59], v[68:69], v[74:75] op_sel:[0,0,0] op_sel_hi:[1,0,1]
    v_pk_fma_f32 v[60:61], v[60:61], v[70:71], v[76:77] op_sel:[0,0,0] op_sel_hi:[1,0,1]
    v_pk_fma_f32 v[62:63], v[62:63], v[70:71], v[78:79] op_sel:[0,0,0] op_sel_hi:[1,0,1]
    v_exp_f32 v72, v56
    v_exp_f32 v73, v57
    v_exp_f32 v74, v58
    v_exp_f32 v75, v59
    v_exp_f32 v76, v60
    v_exp_f32 v77, v61
    v_exp_f32 v78, v62
    v_exp_f32 v79, v63
    v_pk_add_f32 v[72:73], v[72:73], 1.0 op_sel_hi:[1,0]
    v_pk_add_f32 v[74:75], v[74:75], 1.0 op_sel_hi:[1,0]
    v_pk_add_f32 v[76:77], v[76:77], 1.0 op_sel_hi:[1,0]
    v_pk_add_f32 v[78:79], v[78:79], 1.0 op_sel_hi:[1,0]
    v_rcp_f32 v72, v72
    v_rcp_f32 v73, v73
    v_rcp_f32 v74, v74
    v_rcp_f32 v75, v75
    v_rcp_f32 v76, v76
    v_rcp_f32 v77, v77
    v_rcp_f32 v78, v78
    v_rcp_f32 v79, v79
    v_pk_mul_f32 v[56:57], v[56:57], v[72:73]
    v_pk_mul_f32 v[58:59], v[58:59], v[74:75]
    v_pk_mul_f32 v[60:61], v[60:61], v[76:77]
    v_pk_mul_f32 v[62:63], v[62:63], v[78:79]
    v_cvt_pk_bf16_f32 v80, v56, v57
    v_cvt_pk_bf16_f32 v81, v58, v59
    v_cvt_pk_bf16_f32 v82, v60, v61
    v_cvt_pk_bf16_f32 v83, v62, v63
    s_nop 1
    v_permlane16_swap_b32 v80, v82
    v_permlane16_swap_b32 v81, v83
    s_cmp_eq_u32 s92, 0
    s_cbranch_scc1 L_adaLN_cond__grouped_kv_mqa__dense_activation_silu__prompt_kernel_wt_79
    buffer_store_dwordx4 v[80:83], v10, s[36:39], s65 offen offset:1024
    s_branch L_adaLN_cond__grouped_kv_mqa__dense_activation_silu__prompt_kernel_wd_80
L_adaLN_cond__grouped_kv_mqa__dense_activation_silu__prompt_kernel_wt_79:
    buffer_store_dwordx4 v[80:83], v10, s[36:39], s65 offen offset:1024 sc1
L_adaLN_cond__grouped_kv_mqa__dense_activation_silu__prompt_kernel_wd_80:
    buffer_load_dwordx4 v[168:171], v4, s[36:39], s85 offen offset:2048 sc1
    buffer_load_dwordx4 v[172:175], v4, s[36:39], s85 offen offset:3072 sc1
    s_add_u32 s85, s85, 4096
    buffer_load_dwordx4 v[176:179], v4, s[36:39], s85 offen offset:0 sc1
    buffer_load_dwordx4 v[180:183], v4, s[36:39], s85 offen offset:1024 sc1
    v_mov_b32 v9, v13
    v_add_u32 v10, s88, v4
    v_add_u32 v11, s89, v4
    v_add_u32 v12, s90, v4
    v_add_u32 v13, s93, v4
    s_and_b32 s53, s30, 1
    s_mul_i32 s53, s53, 15360
    s_cmp_lt_u32 s30, 2
    s_cselect_b32 s54, 102400, 0
    s_add_u32 s53, s53, s54
    v_add_u32 v8, s53, v4
    s_waitcnt vmcnt(24)
    v_mfma_f32_16x16x32_bf16 v[16:19], a[112:115], v[96:99], 0
    v_mfma_f32_16x16x32_bf16 v[20:23], a[116:119], v[96:99], 0
    buffer_load_dwordx4 v[184:187], v4, s[36:39], s85 offen offset:2048 sc1
    buffer_load_dwordx4 v[188:191], v4, s[36:39], s85 offen offset:3072 sc1
    v_mfma_f32_16x16x32_bf16 v[24:27], a[120:123], v[96:99], 0
    v_mfma_f32_16x16x32_bf16 v[28:31], a[124:127], v[96:99], 0
    v_mfma_f32_16x16x32_bf16 v[32:35], a[128:131], v[96:99], 0
    s_waitcnt vmcnt(25)
    v_mfma_f32_16x16x32_bf16 v[16:19], a[132:135], v[100:103], v[16:19]
    v_mfma_f32_16x16x32_bf16 v[20:23], a[136:139], v[100:103], v[20:23]
    v_mfma_f32_16x16x32_bf16 v[24:27], a[140:143], v[100:103], v[24:27]
    v_mfma_f32_16x16x32_bf16 v[28:31], a[144:147], v[100:103], v[28:31]
    v_mfma_f32_16x16x32_bf16 v[32:35], a[148:151], v[100:103], v[32:35]
    s_waitcnt vmcnt(24)
    v_mfma_f32_16x16x32_bf16 v[16:19], a[152:155], v[104:107], v[16:19]
    v_mfma_f32_16x16x32_bf16 v[20:23], a[156:159], v[104:107], v[20:23]
    v_mfma_f32_16x16x32_bf16 v[24:27], a[160:163], v[104:107], v[24:27]
    v_mfma_f32_16x16x32_bf16 v[28:31], a[164:167], v[104:107], v[28:31]
    v_mfma_f32_16x16x32_bf16 v[32:35], a[168:171], v[104:107], v[32:35]
    s_waitcnt vmcnt(6)
    v_mov_b32 v80, s32
    v_mov_b32 v81, s33
    v_mov_b32 v82, 0
    s_mov_b64 exec, 1
    s_cmp_eq_u32 s92, 0
    s_cbranch_scc1 L_adaLN_cond__grouped_kv_mqa__dense_activation_silu__prompt_kernel_wt_81
    buffer_store_dwordx2 v[80:81], v82, s[36:39], s66 offen
    s_branch L_adaLN_cond__grouped_kv_mqa__dense_activation_silu__prompt_kernel_wd_82
L_adaLN_cond__grouped_kv_mqa__dense_activation_silu__prompt_kernel_wt_81:
    buffer_store_dwordx2 v[80:81], v82, s[36:39], s66 offen sc1
    s_mov_b64 exec, -1
    v_mul_u32_u24 v80, 5462, v1
    v_lshrrev_b32 v80, 16, v80
    v_mul_u32_u24 v81, 12, v80
    v_sub_u32 v81, v1, v81
    v_mul_u32_u24 v80, s77, v80
    v_lshl_add_u32 v80, v81, 7, v80
    s_mov_b32 exec_lo, 0xffffff
    s_mov_b32 exec_hi, 0x0
    buffer_load_dword v14, v80, s[36:39], s65 offen sc1
L_adaLN_cond__grouped_kv_mqa__dense_activation_silu__prompt_kernel_wd_82:
    s_mov_b64 exec, -1
    s_waitcnt vmcnt(24)
    v_mfma_f32_16x16x32_bf16 v[16:19], a[172:175], v[108:111], v[16:19]
    v_mfma_f32_16x16x32_bf16 v[20:23], a[176:179], v[108:111], v[20:23]
    v_mfma_f32_16x16x32_bf16 v[24:27], a[180:183], v[108:111], v[24:27]
    s_add_u32 s52, s73, 53248
    buffer_load_dwordx4 a[48:51], v4, s[36:39], s52 offen offset:0 sc1
    s_add_u32 s52, s73, 54272
    buffer_load_dwordx4 a[52:55], v4, s[36:39], s52 offen offset:0 sc1
    v_mfma_f32_16x16x32_bf16 v[28:31], a[184:187], v[108:111], v[28:31]
    v_mfma_f32_16x16x32_bf16 v[32:35], a[188:191], v[108:111], v[32:35]
    s_waitcnt vmcnt(25)
    v_mfma_f32_16x16x32_bf16 v[16:19], a[192:195], v[112:115], v[16:19]
    v_mfma_f32_16x16x32_bf16 v[20:23], a[196:199], v[112:115], v[20:23]
    v_mfma_f32_16x16x32_bf16 v[24:27], a[200:203], v[112:115], v[24:27]
    s_add_u32 s52, s73, 55296
    buffer_load_dwordx4 a[56:59], v4, s[36:39], s52 offen offset:0 sc1
    s_add_u32 s52, s73, 56320
    buffer_load_dwordx4 a[60:63], v4, s[36:39], s52 offen offset:0 sc1
    v_mfma_f32_16x16x32_bf16 v[28:31], a[204:207], v[112:115], v[28:31]
    v_mfma_f32_16x16x32_bf16 v[32:35], a[208:211], v[112:115], v[32:35]
    s_waitcnt vmcnt(26)
    v_mfma_f32_16x16x32_bf16 v[16:19], a[212:215], v[116:119], v[16:19]
    v_mfma_f32_16x16x32_bf16 v[20:23], a[216:219], v[116:119], v[20:23]
    v_mfma_f32_16x16x32_bf16 v[24:27], a[220:223], v[116:119], v[24:27]
    s_add_u32 s52, s73, 57344
    buffer_load_dwordx4 a[64:67], v4, s[36:39], s52 offen offset:0 sc1
    s_add_u32 s52, s73, 58368
    buffer_load_dwordx4 a[68:71], v4, s[36:39], s52 offen offset:0 sc1
    v_mfma_f32_16x16x32_bf16 v[28:31], a[224:227], v[116:119], v[28:31]
    v_mfma_f32_16x16x32_bf16 v[32:35], a[228:231], v[116:119], v[32:35]
    ds_read_b128 v[240:243], v9 offset:0
    s_waitcnt vmcnt(27)
    v_mfma_f32_16x16x32_bf16 v[16:19], a[232:235], v[120:123], v[16:19]
    ds_read_b128 v[244:247], v9 offset:1024
    v_mfma_f32_16x16x32_bf16 v[20:23], a[236:239], v[120:123], v[20:23]
    ds_read_b128 v[248:251], v9 offset:2048
    v_mfma_f32_16x16x32_bf16 v[24:27], a[240:243], v[120:123], v[24:27]
    ds_read_b128 v[252:255], v9 offset:3072
    s_add_u32 s52, s73, 59392
    buffer_load_dwordx4 a[72:75], v4, s[36:39], s52 offen offset:0 sc1
    s_add_u32 s52, s73, 60416
    buffer_load_dwordx4 a[76:79], v4, s[36:39], s52 offen offset:0 sc1
    v_mfma_f32_16x16x32_bf16 v[28:31], a[244:247], v[120:123], v[28:31]
    ds_read_b128 a[80:83], v9 offset:4096
    v_mfma_f32_16x16x32_bf16 v[32:35], a[248:251], v[120:123], v[32:35]
    ds_read_b128 a[84:87], v9 offset:5120
    s_waitcnt vmcnt(28)
    v_mfma_f32_16x16x32_bf16 v[16:19], a[252:255], v[124:127], v[16:19]
    ds_read_b128 a[88:91], v9 offset:6144
    s_waitcnt lgkmcnt(4)
    v_mfma_f32_16x16x32_bf16 v[20:23], v[240:243], v[124:127], v[20:23]
    ds_read_b128 a[92:95], v9 offset:7168
    v_mfma_f32_16x16x32_bf16 v[24:27], v[244:247], v[124:127], v[24:27]
    ds_read_b128 v[240:243], v9 offset:8192
    v_mfma_f32_16x16x32_bf16 v[28:31], v[248:251], v[124:127], v[28:31]
    ds_read_b128 v[244:247], v9 offset:9216
    s_waitcnt lgkmcnt(4)
    v_mfma_f32_16x16x32_bf16 v[32:35], v[252:255], v[124:127], v[32:35]
    ds_read_b128 v[248:251], v9 offset:10240
    s_waitcnt vmcnt(27)
    v_mfma_f32_16x16x32_bf16 v[16:19], a[80:83], v[128:131], v[16:19]
    ds_read_b128 v[252:255], v9 offset:11264
    v_mfma_f32_16x16x32_bf16 v[20:23], a[84:87], v[128:131], v[20:23]
    ds_read_b128 a[80:83], v9 offset:12288
    s_waitcnt lgkmcnt(4)
    v_mfma_f32_16x16x32_bf16 v[24:27], a[88:91], v[128:131], v[24:27]
    ds_read_b128 a[84:87], v9 offset:13312
    v_mfma_f32_16x16x32_bf16 v[28:31], a[92:95], v[128:131], v[28:31]
    ds_read_b128 a[88:91], v9 offset:14336
    v_mfma_f32_16x16x32_bf16 v[32:35], v[240:243], v[128:131], v[32:35]
    s_waitcnt vmcnt(26)
    s_waitcnt lgkmcnt(3)
    v_mfma_f32_16x16x32_bf16 v[16:19], v[244:247], v[132:135], v[16:19]
    v_mfma_f32_16x16x32_bf16 v[20:23], v[248:251], v[132:135], v[20:23]
    v_mfma_f32_16x16x32_bf16 v[24:27], v[252:255], v[132:135], v[24:27]
    s_waitcnt lgkmcnt(0)
    v_mfma_f32_16x16x32_bf16 v[28:31], a[80:83], v[132:135], v[28:31]
    v_mfma_f32_16x16x32_bf16 v[32:35], a[84:87], v[132:135], v[32:35]
    s_mov_b32 s58, 8388608
L_adaLN_cond__grouped_kv_mqa__dense_activation_silu__prompt_kernel_ph1_83:
    buffer_load_dwordx2 v[80:81], v6, s[36:39], s59 offen offset:0 sc1
    s_sub_u32 s58, s58, 1
    s_cbranch_scc1 L_adaLN_cond__grouped_kv_mqa__dense_activation_silu__prompt_kernel_ph1d_85
    s_waitcnt vmcnt(0)
L_adaLN_cond__grouped_kv_mqa__dense_activation_silu__prompt_kernel_ph1c_84:
    v_cmp_ne_u64 vcc, s[32:33], v[80:81]
    s_cbranch_vccz L_adaLN_cond__grouped_kv_mqa__dense_activation_silu__prompt_kernel_ph1d_85
    s_sleep 1
    s_branch L_adaLN_cond__grouped_kv_mqa__dense_activation_silu__prompt_kernel_ph1_83
L_adaLN_cond__grouped_kv_mqa__dense_activation_silu__prompt_kernel_ph1d_85:
    buffer_load_dwordx4 v[192:195], v4, s[36:39], s86 offen offset:0 sc1
    buffer_load_dwordx4 v[196:199], v4, s[36:39], s86 offen offset:1024 sc1
    buffer_load_dwordx4 v[200:203], v4, s[36:39], s86 offen offset:2048 sc1
    s_waitcnt vmcnt(29)
    v_mfma_f32_16x16x32_bf16 v[16:19], a[88:91], v[136:139], v[16:19]
    v_mfma_f32_16x16x32_bf16 v[20:23], a[96:99], v[136:139], v[20:23]
    buffer_load_dwordx4 v[204:207], v4, s[36:39], s86 offen offset:3072 sc1
    s_add_u32 s86, s86, 4096
    buffer_load_dwordx4 v[208:211], v4, s[36:39], s86 offen offset:0 sc1
    s_waitcnt vmcnt(6)
    v_mfma_f32_16x16x32_bf16 v[24:27], a[48:51], v[136:139], v[24:27]
    v_mfma_f32_16x16x32_bf16 v[28:31], a[52:55], v[136:139], v[28:31]
    v_mfma_f32_16x16x32_bf16 v[32:35], a[56:59], v[136:139], v[32:35]
    s_waitcnt vmcnt(30)
    v_mfma_f32_16x16x32_bf16 v[16:19], a[60:63], v[140:143], v[16:19]
    v_mfma_f32_16x16x32_bf16 v[20:23], a[64:67], v[140:143], v[20:23]
    buffer_load_dwordx4 v[212:215], v4, s[36:39], s86 offen offset:1024 sc1
    buffer_load_dwordx4 v[216:219], v4, s[36:39], s86 offen offset:2048 sc1
    v_mfma_f32_16x16x32_bf16 v[24:27], a[68:71], v[140:143], v[24:27]
    v_mfma_f32_16x16x32_bf16 v[28:31], a[72:75], v[140:143], v[28:31]
    v_mfma_f32_16x16x32_bf16 v[32:35], a[76:79], v[140:143], v[32:35]
    s_waitcnt vmcnt(31)
    v_mfma_f32_16x16x32_bf16 v[36:39], a[112:115], v[144:147], 0
    v_mfma_f32_16x16x32_bf16 v[40:43], a[116:119], v[144:147], 0
    buffer_load_dwordx4 v[220:223], v4, s[36:39], s86 offen offset:3072 sc1
    s_add_u32 s86, s86, 4096
    buffer_load_dwordx4 v[224:227], v4, s[36:39], s86 offen offset:0 sc1
    v_mfma_f32_16x16x32_bf16 v[44:47], a[120:123], v[144:147], 0
    v_mfma_f32_16x16x32_bf16 v[48:51], a[124:127], v[144:147], 0
    v_mfma_f32_16x16x32_bf16 v[52:55], a[128:131], v[144:147], 0
    s_waitcnt vmcnt(32)
    v_mfma_f32_16x16x32_bf16 v[36:39], a[132:135], v[148:151], v[36:39]
    v_mfma_f32_16x16x32_bf16 v[40:43], a[136:139], v[148:151], v[40:43]
    buffer_load_dwordx4 v[228:231], v4, s[36:39], s86 offen offset:1024 sc1
    buffer_load_dwordx4 v[232:235], v4, s[36:39], s86 offen offset:2048 sc1
    v_mfma_f32_16x16x32_bf16 v[44:47], a[140:143], v[148:151], v[44:47]
    v_mfma_f32_16x16x32_bf16 v[48:51], a[144:147], v[148:151], v[48:51]
    ds_write_b128 v10, v[16:19] offset:0
    v_mfma_f32_16x16x32_bf16 v[52:55], a[148:151], v[148:151], v[52:55]
    s_waitcnt vmcnt(33)
    v_mfma_f32_16x16x32_bf16 v[36:39], a[152:155], v[152:155], v[36:39]
    ds_write_b128 v10, v[20:23] offset:1024
    v_mfma_f32_16x16x32_bf16 v[40:43], a[156:159], v[152:155], v[40:43]
    buffer_load_dwordx4 v[236:239], v4, s[36:39], s86 offen offset:3072 sc1
    buffer_load_dwordx4 a[0:3], v4, s[36:39], s87 offen offset:0 sc1
    v_mfma_f32_16x16x32_bf16 v[44:47], a[160:163], v[152:155], v[44:47]
    ds_write_b128 v10, v[24:27] offset:2048
    v_mfma_f32_16x16x32_bf16 v[48:51], a[164:167], v[152:155], v[48:51]
    v_mfma_f32_16x16x32_bf16 v[52:55], a[168:171], v[152:155], v[52:55]
    ds_write_b128 v10, v[28:31] offset:3072
    s_waitcnt vmcnt(34)
    v_mfma_f32_16x16x32_bf16 v[36:39], a[172:175], v[156:159], v[36:39]
    v_mfma_f32_16x16x32_bf16 v[40:43], a[176:179], v[156:159], v[40:43]
    buffer_load_dwordx4 a[4:7], v4, s[36:39], s87 offen offset:1024 sc1
    buffer_load_dwordx4 a[8:11], v4, s[36:39], s87 offen offset:2048 sc1
    ds_write_b128 v10, v[32:35] offset:4096
    v_mfma_f32_16x16x32_bf16 v[44:47], a[180:183], v[156:159], v[44:47]
    v_mfma_f32_16x16x32_bf16 v[48:51], a[184:187], v[156:159], v[48:51]
    v_mfma_f32_16x16x32_bf16 v[52:55], a[188:191], v[156:159], v[52:55]
    s_waitcnt vmcnt(35)
    v_mfma_f32_16x16x32_bf16 v[36:39], a[192:195], v[160:163], v[36:39]
    v_mfma_f32_16x16x32_bf16 v[40:43], a[196:199], v[160:163], v[40:43]
    buffer_load_dwordx4 a[12:15], v4, s[36:39], s87 offen offset:3072 sc1
    s_add_u32 s87, s87, 4096
    buffer_load_dwordx4 a[16:19], v4, s[36:39], s87 offen offset:0 sc1
    v_mfma_f32_16x16x32_bf16 v[44:47], a[200:203], v[160:163], v[44:47]
    v_mfma_f32_16x16x32_bf16 v[48:51], a[204:207], v[160:163], v[48:51]
    v_mfma_f32_16x16x32_bf16 v[52:55], a[208:211], v[160:163], v[52:55]
    s_waitcnt vmcnt(36)
    v_mfma_f32_16x16x32_bf16 v[36:39], a[212:215], v[164:167], v[36:39]
    v_mfma_f32_16x16x32_bf16 v[40:43], a[216:219], v[164:167], v[40:43]
    buffer_load_dwordx4 a[20:23], v4, s[36:39], s87 offen offset:1024 sc1
    buffer_load_dwordx4 a[24:27], v4, s[36:39], s87 offen offset:2048 sc1
    v_mfma_f32_16x16x32_bf16 v[44:47], a[220:223], v[164:167], v[44:47]
    v_mfma_f32_16x16x32_bf16 v[48:51], a[224:227], v[164:167], v[48:51]
    v_mfma_f32_16x16x32_bf16 v[52:55], a[228:231], v[164:167], v[52:55]
    ds_read_b128 v[240:243], v9 offset:0
    s_waitcnt vmcnt(34)
    v_mfma_f32_16x16x32_bf16 v[36:39], a[232:235], v[168:171], v[36:39]
    ds_read_b128 v[244:247], v9 offset:1024
    v_mfma_f32_16x16x32_bf16 v[40:43], a[236:239], v[168:171], v[40:43]
    ds_read_b128 v[248:251], v9 offset:2048
    buffer_load_dwordx4 a[28:31], v4, s[36:39], s87 offen offset:3072 sc1
    s_add_u32 s87, s87, 4096
    buffer_load_dwordx4 a[32:35], v4, s[36:39], s87 offen offset:0 sc1
    v_mfma_f32_16x16x32_bf16 v[44:47], a[240:243], v[168:171], v[44:47]
    ds_read_b128 v[252:255], v9 offset:3072
    v_mfma_f32_16x16x32_bf16 v[48:51], a[244:247], v[168:171], v[48:51]
    ds_read_b128 a[80:83], v9 offset:4096
    v_mfma_f32_16x16x32_bf16 v[52:55], a[248:251], v[168:171], v[52:55]
    ds_read_b128 a[84:87], v9 offset:5120
    s_waitcnt vmcnt(35)
    v_mfma_f32_16x16x32_bf16 v[36:39], a[252:255], v[172:175], v[36:39]
    ds_read_b128 a[88:91], v9 offset:6144
    s_waitcnt lgkmcnt(4)
    v_mfma_f32_16x16x32_bf16 v[40:43], v[240:243], v[172:175], v[40:43]
    ds_read_b128 a[92:95], v9 offset:7168
    buffer_load_dwordx4 a[36:39], v4, s[36:39], s87 offen offset:1024 sc1
    buffer_load_dwordx4 a[40:43], v4, s[36:39], s87 offen offset:2048 sc1
    v_mfma_f32_16x16x32_bf16 v[44:47], v[244:247], v[172:175], v[44:47]
    ds_read_b128 v[240:243], v9 offset:8192
    v_mfma_f32_16x16x32_bf16 v[48:51], v[248:251], v[172:175], v[48:51]
    ds_read_b128 v[244:247], v9 offset:9216
    s_waitcnt lgkmcnt(4)
    v_mfma_f32_16x16x32_bf16 v[52:55], v[252:255], v[172:175], v[52:55]
    ds_read_b128 v[248:251], v9 offset:10240
    s_waitcnt vmcnt(36)
    v_mfma_f32_16x16x32_bf16 v[36:39], a[80:83], v[176:179], v[36:39]
    ds_read_b128 v[252:255], v9 offset:11264
    v_mfma_f32_16x16x32_bf16 v[40:43], a[84:87], v[176:179], v[40:43]
    ds_read_b128 a[80:83], v9 offset:12288
    buffer_load_dwordx4 a[44:47], v4, s[36:39], s87 offen offset:3072 sc1
    s_waitcnt lgkmcnt(4)
    v_mfma_f32_16x16x32_bf16 v[44:47], a[88:91], v[176:179], v[44:47]
    ds_read_b128 a[84:87], v9 offset:13312
    v_mfma_f32_16x16x32_bf16 v[48:51], a[92:95], v[176:179], v[48:51]
    ds_read_b128 a[88:91], v9 offset:14336
    v_mfma_f32_16x16x32_bf16 v[52:55], v[240:243], v[176:179], v[52:55]
    s_waitcnt vmcnt(36)
    s_waitcnt lgkmcnt(3)
    v_mfma_f32_16x16x32_bf16 v[36:39], v[244:247], v[180:183], v[36:39]
    v_mfma_f32_16x16x32_bf16 v[40:43], v[248:251], v[180:183], v[40:43]
    v_mfma_f32_16x16x32_bf16 v[44:47], v[252:255], v[180:183], v[44:47]
    s_waitcnt lgkmcnt(0)
    v_mfma_f32_16x16x32_bf16 v[48:51], a[80:83], v[180:183], v[48:51]
    v_mfma_f32_16x16x32_bf16 v[52:55], a[84:87], v[180:183], v[52:55]
    s_waitcnt vmcnt(35)
    v_mfma_f32_16x16x32_bf16 v[36:39], a[88:91], v[184:187], v[36:39]
    v_mfma_f32_16x16x32_bf16 v[40:43], a[96:99], v[184:187], v[40:43]
    v_mfma_f32_16x16x32_bf16 v[44:47], a[48:51], v[184:187], v[44:47]
    v_mfma_f32_16x16x32_bf16 v[48:51], a[52:55], v[184:187], v[48:51]
    v_mfma_f32_16x16x32_bf16 v[52:55], a[56:59], v[184:187], v[52:55]
    s_waitcnt vmcnt(34)
    v_mfma_f32_16x16x32_bf16 v[36:39], a[60:63], v[188:191], v[36:39]
    v_mfma_f32_16x16x32_bf16 v[40:43], a[64:67], v[188:191], v[40:43]
    v_mfma_f32_16x16x32_bf16 v[44:47], a[68:71], v[188:191], v[44:47]
    v_mfma_f32_16x16x32_bf16 v[48:51], a[72:75], v[188:191], v[48:51]
    v_mfma_f32_16x16x32_bf16 v[52:55], a[76:79], v[188:191], v[52:55]
    s_waitcnt vmcnt(23)
    v_mfma_f32_16x16x32_bf16 v[56:59], a[112:115], v[192:195], 0
    v_mfma_f32_16x16x32_bf16 v[60:63], a[116:119], v[192:195], 0
    v_mfma_f32_16x16x32_bf16 v[64:67], a[120:123], v[192:195], 0
    v_mfma_f32_16x16x32_bf16 v[68:71], a[124:127], v[192:195], 0
    v_mfma_f32_16x16x32_bf16 v[72:75], a[128:131], v[192:195], 0
    s_waitcnt vmcnt(22)
    v_mfma_f32_16x16x32_bf16 v[56:59], a[132:135], v[196:199], v[56:59]
    v_mfma_f32_16x16x32_bf16 v[60:63], a[136:139], v[196:199], v[60:63]
    v_mfma_f32_16x16x32_bf16 v[64:67], a[140:143], v[196:199], v[64:67]
    v_mfma_f32_16x16x32_bf16 v[68:71], a[144:147], v[196:199], v[68:71]
    v_mfma_f32_16x16x32_bf16 v[72:75], a[148:151], v[196:199], v[72:75]
    s_waitcnt vmcnt(21)
    v_mfma_f32_16x16x32_bf16 v[56:59], a[152:155], v[200:203], v[56:59]
    s_cmp_lt_u32 s30, 2
    s_cbranch_scc1 L_keep1
    ds_write_b128 v11, v[36:39] offset:0
    ds_write_b128 v11, v[40:43] offset:1024
    ds_write_b128 v11, v[44:47] offset:2048
    ds_write_b128 v11, v[48:51] offset:3072
    ds_write_b128 v11, v[52:55] offset:4096
L_keep1:
    v_mfma_f32_16x16x32_bf16 v[60:63], a[156:159], v[200:203], v[60:63]
    v_mfma_f32_16x16x32_bf16 v[64:67], a[160:163], v[200:203], v[64:67]
    v_mfma_f32_16x16x32_bf16 v[68:71], a[164:167], v[200:203], v[68:71]
    v_mfma_f32_16x16x32_bf16 v[72:75], a[168:171], v[200:203], v[72:75]
    s_waitcnt vmcnt(20)
    v_mfma_f32_16x16x32_bf16 v[56:59], a[172:175], v[204:207], v[56:59]
    v_mfma_f32_16x16x32_bf16 v[60:63], a[176:179], v[204:207], v[60:63]
    v_mfma_f32_16x16x32_bf16 v[64:67], a[180:183], v[204:207], v[64:67]
    v_mfma_f32_16x16x32_bf16 v[68:71], a[184:187], v[204:207], v[68:71]
    v_mfma_f32_16x16x32_bf16 v[72:75], a[188:191], v[204:207], v[72:75]
    s_waitcnt vmcnt(19)
    v_mfma_f32_16x16x32_bf16 v[56:59], a[192:195], v[208:211], v[56:59]
    v_mfma_f32_16x16x32_bf16 v[60:63], a[196:199], v[208:211], v[60:63]
    v_mfma_f32_16x16x32_bf16 v[64:67], a[200:203], v[208:211], v[64:67]
    v_mfma_f32_16x16x32_bf16 v[68:71], a[204:207], v[208:211], v[68:71]
    v_mfma_f32_16x16x32_bf16 v[72:75], a[208:211], v[208:211], v[72:75]
    s_waitcnt vmcnt(18)
    v_mfma_f32_16x16x32_bf16 v[56:59], a[212:215], v[212:215], v[56:59]
    v_mfma_f32_16x16x32_bf16 v[60:63], a[216:219], v[212:215], v[60:63]
    v_mfma_f32_16x16x32_bf16 v[64:67], a[220:223], v[212:215], v[64:67]
    v_mfma_f32_16x16x32_bf16 v[68:71], a[224:227], v[212:215], v[68:71]
    v_mfma_f32_16x16x32_bf16 v[72:75], a[228:231], v[212:215], v[72:75]
    ds_read_b128 v[240:243], v9 offset:0
    s_waitcnt vmcnt(17)
    v_mfma_f32_16x16x32_bf16 v[56:59], a[232:235], v[216:219], v[56:59]
    ds_read_b128 v[244:247], v9 offset:1024
    v_mfma_f32_16x16x32_bf16 v[60:63], a[236:239], v[216:219], v[60:63]
    ds_read_b128 v[248:251], v9 offset:2048
    v_mfma_f32_16x16x32_bf16 v[64:67], a[240:243], v[216:219], v[64:67]
    ds_read_b128 v[252:255], v9 offset:3072
    v_mfma_f32_16x16x32_bf16 v[68:71], a[244:247], v[216:219], v[68:71]
    ds_read_b128 a[80:83], v9 offset:4096
    v_mfma_f32_16x16x32_bf16 v[72:75], a[248:251], v[216:219], v[72:75]
    ds_read_b128 a[84:87], v9 offset:5120
    s_waitcnt vmcnt(16)
    v_mfma_f32_16x16x32_bf16 v[56:59], a[252:255], v[220:223], v[56:59]
    ds_read_b128 a[88:91], v9 offset:6144
    s_waitcnt lgkmcnt(4)
    v_mfma_f32_16x16x32_bf16 v[60:63], v[240:243], v[220:223], v[60:63]
    ds_read_b128 a[92:95], v9 offset:7168
    v_mfma_f32_16x16x32_bf16 v[64:67], v[244:247], v[220:223], v[64:67]
    ds_read_b128 v[240:243], v9 offset:8192
    v_mfma_f32_16x16x32_bf16 v[68:71], v[248:251], v[220:223], v[68:71]
    ds_read_b128 v[244:247], v9 offset:9216
    s_waitcnt lgkmcnt(4)
    v_mfma_f32_16x16x32_bf16 v[72:75], v[252:255], v[220:223], v[72:75]
    ds_read_b128 v[248:251], v9 offset:10240
    s_waitcnt vmcnt(15)
    v_mfma_f32_16x16x32_bf16 v[56:59], a[80:83], v[224:227], v[56:59]
    ds_read_b128 v[252:255], v9 offset:11264
    v_mfma_f32_16x16x32_bf16 v[60:63], a[84:87], v[224:227], v[60:63]
    ds_read_b128 a[80:83], v9 offset:12288
    s_waitcnt lgkmcnt(4)
    v_mfma_f32_16x16x32_bf16 v[64:67], a[88:91], v[224:227], v[64:67]
    ds_read_b128 a[84:87], v9 offset:13312
    v_mfma_f32_16x16x32_bf16 v[68:71], a[92:95], v[224:227], v[68:71]
    ds_read_b128 a[88:91], v9 offset:14336
    v_mfma_f32_16x16x32_bf16 v[72:75], v[240:243], v[224:227], v[72:75]
    s_waitcnt vmcnt(14)
    s_waitcnt lgkmcnt(3)
    v_mfma_f32_16x16x32_bf16 v[56:59], v[244:247], v[228:231], v[56:59]
    v_mfma_f32_16x16x32_bf16 v[60:63], v[248:251], v[228:231], v[60:63]
    v_mfma_f32_16x16x32_bf16 v[64:67], v[252:255], v[228:231], v[64:67]
    s_waitcnt lgkmcnt(0)
    v_mfma_f32_16x16x32_bf16 v[68:71], a[80:83], v[228:231], v[68:71]
    v_mfma_f32_16x16x32_bf16 v[72:75], a[84:87], v[228:231], v[72:75]
    s_waitcnt vmcnt(13)
    v_mfma_f32_16x16x32_bf16 v[56:59], a[88:91], v[232:235], v[56:59]
    v_mfma_f32_16x16x32_bf16 v[60:63], a[96:99], v[232:235], v[60:63]
    v_mfma_f32_16x16x32_bf16 v[64:67], a[48:51], v[232:235], v[64:67]
    v_lshlrev_b32 v7, 4, v3
    v_add_u32 v7, 156800, v7
    v_mfma_f32_16x16x32_bf16 v[68:71], a[52:55], v[232:235], v[68:71]
    ds_read_b128 v[160:163], v7 offset:0
    v_mfma_f32_16x16x32_bf16 v[72:75], a[56:59], v[232:235], v[72:75]
    ds_read_b128 v[164:167], v7 offset:64
    s_waitcnt vmcnt(12)
    v_mfma_f32_16x16x32_bf16 v[56:59], a[60:63], v[236:239], v[56:59]
    ds_read_b128 v[168:171], v7 offset:128
    v_mfma_f32_16x16x32_bf16 v[60:63], a[64:67], v[236:239], v[60:63]
    ds_read_b128 v[172:175], v7 offset:192
    v_mfma_f32_16x16x32_bf16 v[64:67], a[68:71], v[236:239], v[64:67]
    ds_read_b128 v[176:179], v7 offset:256
    v_mfma_f32_16x16x32_bf16 v[68:71], a[72:75], v[236:239], v[68:71]
    s_mov_b32 s44, s24
    s_mov_b32 s45, s25
    v_mfma_f32_16x16x32_bf16 v[72:75], a[76:79], v[236:239], v[72:75]
    s_mov_b32 s46, 2621440
    s_mov_b32 s47, 0x00020000
    s_waitcnt vmcnt(11)
    v_mfma_f32_16x16x32_bf16 v[76:79], a[112:115], a[0:3], 0
    v_mfma_f32_16x16x32_bf16 v[80:83], a[116:119], a[0:3], 0
    v_mfma_f32_16x16x32_bf16 v[84:87], a[120:123], a[0:3], 0
    v_mfma_f32_16x16x32_bf16 v[88:91], a[124:127], a[0:3], 0
    v_mfma_f32_16x16x32_bf16 v[92:95], a[128:131], a[0:3], 0
    s_waitcnt vmcnt(10)
    v_mfma_f32_16x16x32_bf16 v[76:79], a[132:135], a[4:7], v[76:79]
    v_mfma_f32_16x16x32_bf16 v[80:83], a[136:139], a[4:7], v[80:83]
    v_mfma_f32_16x16x32_bf16 v[84:87], a[140:143], a[4:7], v[84:87]
    v_mfma_f32_16x16x32_bf16 v[88:91], a[144:147], a[4:7], v[88:91]
    ds_write_b128 v12, v[56:59] offset:0
    v_mfma_f32_16x16x32_bf16 v[92:95], a[148:151], a[4:7], v[92:95]
    s_waitcnt vmcnt(9)
    v_mfma_f32_16x16x32_bf16 v[76:79], a[152:155], a[8:11], v[76:79]
    ds_write_b128 v12, v[60:63] offset:1024
    v_mfma_f32_16x16x32_bf16 v[80:83], a[156:159], a[8:11], v[80:83]
    v_mfma_f32_16x16x32_bf16 v[84:87], a[160:163], a[8:11], v[84:87]
    ds_write_b128 v12, v[64:67] offset:2048
    v_mfma_f32_16x16x32_bf16 v[88:91], a[164:167], a[8:11], v[88:91]
    v_mfma_f32_16x16x32_bf16 v[92:95], a[168:171], a[8:11], v[92:95]
    ds_write_b128 v12, v[68:71] offset:3072
    s_waitcnt vmcnt(8)
    v_mfma_f32_16x16x32_bf16 v[76:79], a[172:175], a[12:15], v[76:79]
    v_mfma_f32_16x16x32_bf16 v[80:83], a[176:179], a[12:15], v[80:83]
    ds_write_b128 v12, v[72:75] offset:4096
    v_mfma_f32_16x16x32_bf16 v[84:87], a[180:183], a[12:15], v[84:87]
    v_mfma_f32_16x16x32_bf16 v[88:91], a[184:187], a[12:15], v[88:91]
    v_mfma_f32_16x16x32_bf16 v[92:95], a[188:191], a[12:15], v[92:95]
    s_waitcnt lgkmcnt(0)
    s_barrier
    ds_read_b128 v[96:99], v8 offset:0
    s_waitcnt vmcnt(7)
    v_mfma_f32_16x16x32_bf16 v[76:79], a[192:195], a[16:19], v[76:79]
    ds_read_b128 v[100:103], v8 offset:1024
    v_mfma_f32_16x16x32_bf16 v[80:83], a[196:199], a[16:19], v[80:83]
    ds_read_b128 v[104:107], v8 offset:2048
    v_mfma_f32_16x16x32_bf16 v[84:87], a[200:203], a[16:19], v[84:87]
    ds_read_b128 v[108:111], v8 offset:3072
    v_mfma_f32_16x16x32_bf16 v[88:91], a[204:207], a[16:19], v[88:91]
    ds_read_b128 v[112:115], v8 offset:4096
    v_mfma_f32_16x16x32_bf16 v[92:95], a[208:211], a[16:19], v[92:95]
    ds_read_b128 v[116:119], v8 offset:5120
    s_waitcnt vmcnt(6)
    v_mfma_f32_16x16x32_bf16 v[76:79], a[212:215], a[20:23], v[76:79]
    ds_read_b128 v[120:123], v8 offset:6144
    v_mfma_f32_16x16x32_bf16 v[80:83], a[216:219], a[20:23], v[80:83]
    ds_read_b128 v[124:127], v8 offset:7168
    v_mfma_f32_16x16x32_bf16 v[84:87], a[220:223], a[20:23], v[84:87]
    ds_read_b128 v[128:131], v8 offset:8192
    v_mfma_f32_16x16x32_bf16 v[88:91], a[224:227], a[20:23], v[88:91]
    ds_read_b128 v[132:135], v8 offset:9216
    v_mfma_f32_16x16x32_bf16 v[92:95], a[228:231], a[20:23], v[92:95]
    ds_read_b128 v[240:243], v9 offset:0
    s_waitcnt vmcnt(5)
    v_mfma_f32_16x16x32_bf16 v[76:79], a[232:235], a[24:27], v[76:79]
    ds_read_b128 v[244:247], v9 offset:1024
    v_mfma_f32_16x16x32_bf16 v[80:83], a[236:239], a[24:27], v[80:83]
    ds_read_b128 v[248:251], v9 offset:2048
    v_mfma_f32_16x16x32_bf16 v[84:87], a[240:243], a[24:27], v[84:87]
    ds_read_b128 v[252:255], v9 offset:3072
    v_mfma_f32_16x16x32_bf16 v[88:91], a[244:247], a[24:27], v[88:91]
    ds_read_b128 a[80:83], v9 offset:4096
    v_mfma_f32_16x16x32_bf16 v[92:95], a[248:251], a[24:27], v[92:95]
    ds_read_b128 a[84:87], v9 offset:5120
    s_waitcnt vmcnt(4)
    v_mfma_f32_16x16x32_bf16 v[76:79], a[252:255], a[28:31], v[76:79]
    ds_read_b128 a[88:91], v9 offset:6144
    s_waitcnt lgkmcnt(4)
    v_mfma_f32_16x16x32_bf16 v[80:83], v[240:243], a[28:31], v[80:83]
    ds_read_b128 a[92:95], v9 offset:7168
    v_mfma_f32_16x16x32_bf16 v[84:87], v[244:247], a[28:31], v[84:87]
    ds_read_b128 v[240:243], v9 offset:8192
    v_mfma_f32_16x16x32_bf16 v[88:91], v[248:251], a[28:31], v[88:91]
    ds_read_b128 v[244:247], v9 offset:9216
    s_waitcnt lgkmcnt(4)
    v_mfma_f32_16x16x32_bf16 v[92:95], v[252:255], a[28:31], v[92:95]
    ds_read_b128 v[248:251], v9 offset:10240
    s_waitcnt vmcnt(3)
    v_mfma_f32_16x16x32_bf16 v[76:79], a[80:83], a[32:35], v[76:79]
    ds_read_b128 v[252:255], v9 offset:11264
    v_mfma_f32_16x16x32_bf16 v[80:83], a[84:87], a[32:35], v[80:83]
    ds_read_b128 a[80:83], v9 offset:12288
    s_waitcnt lgkmcnt(4)
    v_mfma_f32_16x16x32_bf16 v[84:87], a[88:91], a[32:35], v[84:87]
    ds_read_b128 a[84:87], v9 offset:13312
    v_mfma_f32_16x16x32_bf16 v[88:91], a[92:95], a[32:35], v[88:91]
    ds_read_b128 a[88:91], v9 offset:14336
    v_mfma_f32_16x16x32_bf16 v[92:95], v[240:243], a[32:35], v[92:95]
    s_waitcnt vmcnt(2)
    s_waitcnt lgkmcnt(3)
    v_mfma_f32_16x16x32_bf16 v[76:79], v[244:247], a[36:39], v[76:79]
    v_mfma_f32_16x16x32_bf16 v[80:83], v[248:251], a[36:39], v[80:83]
    v_mfma_f32_16x16x32_bf16 v[84:87], v[252:255], a[36:39], v[84:87]
    s_waitcnt lgkmcnt(0)
    v_mfma_f32_16x16x32_bf16 v[88:91], a[80:83], a[36:39], v[88:91]
    v_mfma_f32_16x16x32_bf16 v[92:95], a[84:87], a[36:39], v[92:95]
    s_waitcnt vmcnt(1)
    v_mfma_f32_16x16x32_bf16 v[76:79], a[88:91], a[40:43], v[76:79]
    v_mfma_f32_16x16x32_bf16 v[80:83], a[96:99], a[40:43], v[80:83]
    v_mfma_f32_16x16x32_bf16 v[84:87], a[48:51], a[40:43], v[84:87]
    v_accvgpr_read_b32 v180, a102
    v_accvgpr_read_b32 v181, a103
    v_mfma_f32_16x16x32_bf16 v[88:91], a[52:55], a[40:43], v[88:91]
    v_accvgpr_read_b32 v182, a104
    v_accvgpr_read_b32 v183, a105
    v_mfma_f32_16x16x32_bf16 v[92:95], a[56:59], a[40:43], v[92:95]
    v_accvgpr_read_b32 v184, a106
    v_accvgpr_read_b32 v185, a107
    s_waitcnt vmcnt(0)
    v_mfma_f32_16x16x32_bf16 v[76:79], a[60:63], a[44:47], v[76:79]
    v_accvgpr_read_b32 v186, a108
    v_accvgpr_read_b32 v187, a109
    v_mfma_f32_16x16x32_bf16 v[80:83], a[64:67], a[44:47], v[80:83]
    v_accvgpr_read_b32 v188, a110
    v_accvgpr_read_b32 v189, a111
    v_mfma_f32_16x16x32_bf16 v[84:87], a[68:71], a[44:47], v[84:87]
    v_mfma_f32_16x16x32_bf16 v[88:91], a[72:75], a[44:47], v[88:91]
    v_mfma_f32_16x16x32_bf16 v[92:95], a[76:79], a[44:47], v[92:95]
    s_waitcnt lgkmcnt(0)
    s_cmp_ge_u32 s30, 2
    s_cbranch_scc1 L_keep3
    s_nop 2
    ds_write_b128 v13, v[76:79] offset:0
    ds_write_b128 v13, v[80:83] offset:1024
    ds_write_b128 v13, v[84:87] offset:2048
    ds_write_b128 v13, v[88:91] offset:3072
    ds_write_b128 v13, v[92:95] offset:4096
L_keep3:
    v_pk_add_f32 v[96:97], v[96:97], v[116:117]
    v_pk_add_f32 v[98:99], v[98:99], v[118:119]
    v_pk_add_f32 v[100:101], v[100:101], v[120:121]
    v_pk_add_f32 v[102:103], v[102:103], v[122:123]
    v_pk_add_f32 v[104:105], v[104:105], v[124:125]
    v_pk_add_f32 v[106:107], v[106:107], v[126:127]
    v_pk_add_f32 v[108:109], v[108:109], v[128:129]
    v_pk_add_f32 v[110:111], v[110:111], v[130:131]
    v_pk_add_f32 v[112:113], v[112:113], v[132:133]
    v_pk_add_f32 v[114:115], v[114:115], v[134:135]
    s_waitcnt lgkmcnt(0)
    s_barrier
    ds_read_b128 v[136:139], v8 offset:10240
    ds_read_b128 v[140:143], v8 offset:11264
    ds_read_b128 v[144:147], v8 offset:12288
    ds_read_b128 v[148:151], v8 offset:13312
    ds_read_b128 v[152:155], v8 offset:14336
    s_cmp_ge_u32 s30, 2
    s_cbranch_scc1 L_own3
    v_pk_add_f32 v[96:97], v[96:97], v[36:37]
    v_pk_add_f32 v[98:99], v[98:99], v[38:39]
    v_pk_add_f32 v[100:101], v[100:101], v[40:41]
    v_pk_add_f32 v[102:103], v[102:103], v[42:43]
    v_pk_add_f32 v[104:105], v[104:105], v[44:45]
    v_pk_add_f32 v[106:107], v[106:107], v[46:47]
    v_pk_add_f32 v[108:109], v[108:109], v[48:49]
    v_pk_add_f32 v[110:111], v[110:111], v[50:51]
    v_pk_add_f32 v[112:113], v[112:113], v[52:53]
    v_pk_add_f32 v[114:115], v[114:115], v[54:55]
    s_branch L_ownd
L_own3:
    v_pk_add_f32 v[96:97], v[96:97], v[76:77]
    v_pk_add_f32 v[98:99], v[98:99], v[78:79]
    v_pk_add_f32 v[100:101], v[100:101], v[80:81]
    v_pk_add_f32 v[102:103], v[102:103], v[82:83]
    v_pk_add_f32 v[104:105], v[104:105], v[84:85]
    v_pk_add_f32 v[106:107], v[106:107], v[86:87]
    v_pk_add_f32 v[108:109], v[108:109], v[88:89]
    v_pk_add_f32 v[110:111], v[110:111], v[90:91]
    v_pk_add_f32 v[112:113], v[112:113], v[92:93]
    v_pk_add_f32 v[114:115], v[114:115], v[94:95]
L_ownd:
    v_lshlrev_b32 v16, 16, v180
    v_and_b32 v17, s91, v180
    v_lshlrev_b32 v18, 16, v181
    v_and_b32 v19, s91, v181
    v_lshlrev_b32 v20, 16, v182
    v_and_b32 v21, s91, v182
    v_lshlrev_b32 v22, 16, v183
    v_and_b32 v23, s91, v183
    v_lshlrev_b32 v24, 16, v184
    v_and_b32 v25, s91, v184
    v_lshlrev_b32 v26, 16, v185
    v_and_b32 v27, s91, v185
    v_lshlrev_b32 v28, 16, v186
    v_and_b32 v29, s91, v186
    v_lshlrev_b32 v30, 16, v187
    v_and_b32 v31, s91, v187
    v_lshlrev_b32 v32, 16, v188
    v_and_b32 v33, s91, v188
    v_lshlrev_b32 v34, 16, v189
    v_and_b32 v35, s91, v189
    s_waitcnt lgkmcnt(4)
    v_pk_add_f32 v[96:97], v[96:97], v[136:137]
    v_pk_add_f32 v[98:99], v[98:99], v[138:139]
    v_pk_fma_f32 v[16:17], v[160:161], v[96:97], v[16:17]
    v_pk_fma_f32 v[18:19], v[162:163], v[98:99], v[18:19]
    v_cvt_pk_bf16_f32 v40, v16, v17
    v_cvt_pk_bf16_f32 v41, v18, v19
    s_waitcnt lgkmcnt(3)
    v_pk_add_f32 v[100:101], v[100:101], v[140:141]
    v_pk_add_f32 v[102:103], v[102:103], v[142:143]
    v_pk_fma_f32 v[20:21], v[164:165], v[100:101], v[20:21]
    v_pk_fma_f32 v[22:23], v[166:167], v[102:103], v[22:23]
    v_cvt_pk_bf16_f32 v42, v20, v21
    v_cvt_pk_bf16_f32 v43, v22, v23
    s_nop 1
    v_permlane16_swap_b32 v40, v42
    v_permlane16_swap_b32 v41, v43
    buffer_store_dwordx4 v[40:43], v5, s[44:47], s67 offen offset:0
    s_waitcnt lgkmcnt(2)
    v_pk_add_f32 v[104:105], v[104:105], v[144:145]
    v_pk_add_f32 v[106:107], v[106:107], v[146:147]
    v_pk_fma_f32 v[24:25], v[168:169], v[104:105], v[24:25]
    v_pk_fma_f32 v[26:27], v[170:171], v[106:107], v[26:27]
    v_cvt_pk_bf16_f32 v44, v24, v25
    v_cvt_pk_bf16_f32 v45, v26, v27
    s_waitcnt lgkmcnt(1)
    v_pk_add_f32 v[108:109], v[108:109], v[148:149]
    v_pk_add_f32 v[110:111], v[110:111], v[150:151]
    v_pk_fma_f32 v[28:29], v[172:173], v[108:109], v[28:29]
    v_pk_fma_f32 v[30:31], v[174:175], v[110:111], v[30:31]
    v_cvt_pk_bf16_f32 v46, v28, v29
    v_cvt_pk_bf16_f32 v47, v30, v31
    s_nop 1
    v_permlane16_swap_b32 v44, v46
    v_permlane16_swap_b32 v45, v47
    buffer_store_dwordx4 v[44:47], v5, s[44:47], s67 offen offset:64
    s_waitcnt lgkmcnt(0)
    v_pk_add_f32 v[112:113], v[112:113], v[152:153]
    v_pk_add_f32 v[114:115], v[114:115], v[154:155]
    v_pk_fma_f32 v[32:33], v[176:177], v[112:113], v[32:33]
    v_pk_fma_f32 v[34:35], v[178:179], v[114:115], v[34:35]
    v_cvt_pk_bf16_f32 v48, v32, v33
    v_cvt_pk_bf16_f32 v49, v34, v35
    v_mov_b32 v50, v48
    v_mov_b32 v51, v49
    s_nop 1
    v_permlane16_swap_b32 v48, v50
    v_permlane16_swap_b32 v49, v51
    s_mov_b32 exec_lo, 65535
    s_mov_b32 exec_hi, 65535
    buffer_store_dwordx4 v[48:51], v5, s[44:47], s67 offen offset:128
    s_mov_b64 exec, -1
    s_branch L_fin
L_slow:
    s_ff1_i32_b32 s78, s79
    s_bitset0_b32 s79, s78
    s_lshl_b32 s52, s78, 2
    s_add_u32 s52, s52, s30
    s_mul_i32 s52, s52, 1280
    v_add_u32 v76, s52, v4
    v_and_b32 v74, 31, v1
    v_lshl_add_u32 v77, v74, 3, s52
    v_add_u32 v76, 153600, v76
    v_add_u32 v77, 154624, v77
    ds_read_b128 v[80:83], v76
    ds_read_b64 v[84:85], v77
    v_lshrrev_b32 v75, 5, v1
    v_cmp_eq_u32 vcc, 20, v74
    v_mov_b32 v76, 0x3f803f80
    v_lshlrev_b32 v92, 3, v1
    v_cndmask_b32 v76, 0, v76, vcc
    v_mul_u32_u24 v93, 320, v75
    v_lshl_add_u32 v93, v74, 4, v93
    v_mov_b32 v94, 0xff800000
    v_mov_b32 v78, 0xdddd
    v_mov_b32 v58, v76
    v_accvgpr_write_b32 a208, 0
    v_mov_b32 v59, v76
    v_accvgpr_write_b32 a209, 0
    v_mov_b32 v60, v76
    v_accvgpr_write_b32 a210, 0
    v_mov_b32 v61, v76
    v_accvgpr_write_b32 a211, 0
    v_mov_b32 v62, v76
    v_accvgpr_write_b32 a212, 0
    v_mov_b32 v63, v76
    v_accvgpr_write_b32 a213, 0
    v_mov_b32 v64, v76
    v_accvgpr_write_b32 a214, 0
    v_mov_b32 v65, v76
    v_accvgpr_write_b32 a215, 0
    v_mov_b32 v66, v76
    v_accvgpr_write_b32 a216, 0
    v_mov_b32 v67, v76
    v_accvgpr_write_b32 a217, 0
    v_mov_b32 v68, v76
    v_accvgpr_write_b32 a218, 0
    v_mov_b32 v69, v76
    v_accvgpr_write_b32 a219, 0
    v_mov_b32 v70, v76
    v_accvgpr_write_b32 a220, 0
    v_mov_b32 v71, v76
    v_accvgpr_write_b32 a221, 0
    v_mov_b32 v72, v76
    v_accvgpr_write_b32 a222, 0
    v_mov_b32 v73, v76
    v_accvgpr_write_b32 a223, 0
    s_mov_b32 s52, 196608
L_slow1:
    buffer_load_dwordx4 v[48:51], v4, s[36:39], s52 offen sc1
    buffer_load_dwordx4 v[52:55], v4, s[36:39], s52 offen offset:1024 sc1
    buffer_load_dwordx2 v[56:57], v92, s[36:39], s52 offen offset:2048 sc1
    s_waitcnt vmcnt(0) lgkmcnt(0)
    v_mfma_f32_32x32x4_2b_bf16 v[16:47], v[56:57], v[84:85], 0
    s_nop 15
    s_nop 1
    v_mfma_f32_32x32x16_bf16 v[16:31], v[48:51], v[80:83], v[16:31]
    v_mfma_f32_32x32x16_bf16 v[32:47], v[52:55], v[80:83], v[32:47]
    s_nop 11
    v_max3_f32 v94, v16, v17, v94
    v_max3_f32 v94, v18, v19, v94
    v_max3_f32 v94, v20, v21, v94
    v_max3_f32 v94, v22, v23, v94
    v_max3_f32 v94, v24, v25, v94
    v_max3_f32 v94, v26, v27, v94
    v_max3_f32 v94, v28, v29, v94
    v_max3_f32 v94, v30, v31, v94
    v_max3_f32 v94, v32, v33, v94
    v_max3_f32 v94, v34, v35, v94
    v_max3_f32 v94, v36, v37, v94
    v_max3_f32 v94, v38, v39, v94
    v_max3_f32 v94, v40, v41, v94
    v_max3_f32 v94, v42, v43, v94
    v_max3_f32 v94, v44, v45, v94
    v_max3_f32 v94, v46, v47, v94
    s_add_u32 s52, s52, 5120
    s_cmp_lt_u32 s52, 360448
    s_cbranch_scc1 L_slow1
    v_mov_b32 v74, v94
    s_nop 1
    v_permlane32_swap_b32 v94, v74
    s_nop 0
    v_max_f32 v94, v94, v74
    s_mov_b32 s52, 196608
L_slow2:
    s_add_u32 s53, s52, 2560
    buffer_load_dwordx4 v[48:51], v4, s[36:39], s52 offen sc1
    buffer_load_dwordx4 v[52:55], v4, s[36:39], s52 offen offset:1024 sc1
    buffer_load_dwordx2 v[56:57], v92, s[36:39], s52 offen offset:2048 sc1
    s_mov_b32 exec_lo, 1048575
    s_mov_b32 exec_hi, 1048575
    buffer_load_dwordx4 v[58:61], v93, s[36:39], s53 offen offset:0 sc1
    buffer_load_dwordx4 v[62:65], v93, s[36:39], s53 offen offset:640 sc1
    buffer_load_dwordx4 v[66:69], v93, s[36:39], s53 offen offset:1280 sc1
    buffer_load_dwordx4 v[70:73], v93, s[36:39], s53 offen offset:1920 sc1
    s_mov_b64 exec, -1
    s_waitcnt vmcnt(0) lgkmcnt(0)
    v_mfma_f32_32x32x4_2b_bf16 v[16:47], v[56:57], v[84:85], 0
    s_nop 15
    s_nop 1
    v_mfma_f32_32x32x16_bf16 v[16:31], v[48:51], v[80:83], v[16:31]
    v_mfma_f32_32x32x16_bf16 v[32:47], v[52:55], v[80:83], v[32:47]
    s_nop 11
    v_sub_f32 v16, v16, v94
    v_sub_f32 v17, v17, v94
    v_sub_f32 v18, v18, v94
    v_sub_f32 v19, v19, v94
    v_sub_f32 v20, v20, v94
    v_sub_f32 v21, v21, v94
    v_sub_f32 v22, v22, v94
    v_sub_f32 v23, v23, v94
    v_sub_f32 v24, v24, v94
    v_sub_f32 v25, v25, v94
    v_sub_f32 v26, v26, v94
    v_sub_f32 v27, v27, v94
    v_sub_f32 v28, v28, v94
    v_sub_f32 v29, v29, v94
    v_sub_f32 v30, v30, v94
    v_sub_f32 v31, v31, v94
    v_sub_f32 v32, v32, v94
    v_sub_f32 v33, v33, v94
    v_sub_f32 v34, v34, v94
    v_sub_f32 v35, v35, v94
    v_sub_f32 v36, v36, v94
    v_sub_f32 v37, v37, v94
    v_sub_f32 v38, v38, v94
    v_sub_f32 v39, v39, v94
    v_sub_f32 v40, v40, v94
    v_sub_f32 v41, v41, v94
    v_sub_f32 v42, v42, v94
    v_sub_f32 v43, v43, v94
    v_sub_f32 v44, v44, v94
    v_sub_f32 v45, v45, v94
    v_sub_f32 v46, v46, v94
    v_sub_f32 v47, v47, v94
    v_exp_f32 v16, v16
    v_exp_f32 v17, v17
    v_exp_f32 v18, v18
    v_exp_f32 v19, v19
    v_exp_f32 v20, v20
    v_exp_f32 v21, v21
    v_exp_f32 v22, v22
    v_exp_f32 v23, v23
    v_exp_f32 v24, v24
    v_exp_f32 v25, v25
    v_exp_f32 v26, v26
    v_exp_f32 v27, v27
    v_exp_f32 v28, v28
    v_exp_f32 v29, v29
    v_exp_f32 v30, v30
    v_exp_f32 v31, v31
    v_exp_f32 v32, v32
    v_exp_f32 v33, v33
    v_exp_f32 v34, v34
    v_exp_f32 v35, v35
    v_exp_f32 v36, v36
    v_exp_f32 v37, v37
    v_exp_f32 v38, v38
    v_exp_f32 v39, v39
    v_exp_f32 v40, v40
    v_exp_f32 v41, v41
    v_exp_f32 v42, v42
    v_exp_f32 v43, v43
    v_exp_f32 v44, v44
    v_exp_f32 v45, v45
    v_exp_f32 v46, v46
    v_exp_f32 v47, v47
    s_nop 1
    v_smfmac_f32_32x32x32_bf16 a[208:223], v[58:61], v[16:23], v78
    v_smfmac_f32_32x32x32_bf16 a[208:223], v[62:65], v[24:31], v78
    v_smfmac_f32_32x32x32_bf16 a[208:223], v[66:69], v[32:39], v78
    v_smfmac_f32_32x32x32_bf16 a[208:223], v[70:73], v[40:47], v78
    s_add_u32 s52, s52, 5120
    s_cmp_lt_u32 s52, 360448
    s_cbranch_scc1 L_slow2
    s_nop 11
    v_accvgpr_read_b32 v16, a208
    v_accvgpr_read_b32 v17, a209
    v_accvgpr_read_b32 v18, a210
    v_accvgpr_read_b32 v19, a211
    v_accvgpr_read_b32 v20, a212
    v_accvgpr_read_b32 v21, a213
    v_accvgpr_read_b32 v22, a214
    v_accvgpr_read_b32 v23, a215
    v_accvgpr_read_b32 v24, a216
    v_accvgpr_read_b32 v25, a217
    v_accvgpr_read_b32 v26, a218
    v_accvgpr_read_b32 v27, a219
    v_mov_b32 v29, v24
    v_mov_b32 v28, v24
    v_mov_b32 v30, 0
    s_mov_b32 s52, 0x35800000
    v_permlane32_swap_b32 v29, v28
    s_mul_i32 s52, s78, 40960
    v_rcp_f32 v28, v28
    s_add_u32 s53, s52, s69
    s_add_u32 s52, s52, s68
    s_nop 0
    v_pk_mul_f32 v[16:17], v[16:17], v[28:29] op_sel_hi:[1,0]
    v_pk_mul_f32 v[18:19], v[18:19], v[28:29] op_sel_hi:[1,0]
    v_pk_mul_f32 v[20:21], v[20:21], v[28:29] op_sel_hi:[1,0]
    v_pk_mul_f32 v[22:23], v[22:23], v[28:29] op_sel_hi:[1,0]
    v_pk_mul_f32 v[24:25], v[24:25], v[28:29] op_sel_hi:[1,0]
    v_pk_mul_f32 v[26:27], v[26:27], v[28:29] op_sel_hi:[1,0]
    v_cvt_pk_bf16_f32 v16, v16, v17
    v_cvt_pk_bf16_f32 v17, v18, v19
    v_cvt_pk_bf16_f32 v18, v20, v21
    v_cvt_pk_bf16_f32 v19, v22, v23
    v_cvt_pk_bf16_f32 v20, v24, v25
    v_cvt_pk_bf16_f32 v21, v26, v27
    s_cmp_eq_u32 s92, 0
    s_cbranch_scc1 L_adaLN_cond__grouped_kv_mqa__dense_activation_silu__prompt_kernel_wt_87
    buffer_store_dwordx4 v[16:19], v12, s[36:39], s52 offen
    s_mov_b32 exec_hi, 0
    buffer_store_dwordx2 v[20:21], v12, s[36:39], s53 offen
    s_branch L_adaLN_cond__grouped_kv_mqa__dense_activation_silu__prompt_kernel_wd_88
L_adaLN_cond__grouped_kv_mqa__dense_activation_silu__prompt_kernel_wt_87:
    buffer_store_dwordx4 v[16:19], v12, s[36:39], s52 offen sc1
    s_mov_b32 exec_hi, 0
    buffer_store_dwordx2 v[20:21], v12, s[36:39], s53 offen sc1
L_adaLN_cond__grouped_kv_mqa__dense_activation_silu__prompt_kernel_wd_88:
    s_mov_b32 exec_hi, -1
L_adaLN_cond__grouped_kv_mqa__dense_activation_silu__prompt_kernel_unsafe_86:
    s_waitcnt vmcnt(0)
    s_cmp_lg_u32 s78, 0
    s_cbranch_scc1 L_slowchk
    s_lshl_b32 s53, s28, 5
    s_lshl_b32 s52, s29, 2
    s_add_u32 s53, s53, s52
    s_add_u32 s53, s53, s30
    s_lshl_b32 s53, s53, 3
    s_add_u32 s53, s53, 20480
    v_mov_b32 v92, s32
    v_mov_b32 v93, s33
    v_mov_b32 v94, 0
    s_mov_b64 exec, 1
    s_cmp_eq_u32 s92, 0
    s_cbranch_scc1 L_adaLN_cond__grouped_kv_mqa__dense_activation_silu__prompt_kernel_wt_89
    buffer_store_dwordx2 v[92:93], v94, s[36:39], s53 offen
    s_branch L_adaLN_cond__grouped_kv_mqa__dense_activation_silu__prompt_kernel_wd_90
L_adaLN_cond__grouped_kv_mqa__dense_activation_silu__prompt_kernel_wt_89:
    buffer_store_dwordx2 v[92:93], v94, s[36:39], s53 offen sc1
L_adaLN_cond__grouped_kv_mqa__dense_activation_silu__prompt_kernel_wd_90:
    s_mov_b64 exec, -1
    s_branch L_slowchk
L_fin:
L_end:
    s_endpgm
L_code_end:
.set CODE_LAST, L_code_end - adaLN_cond__grouped_kv_mqa__dense_activation_silu__prompt_kernel - 256
.section .rodata,"a"
.p2align 6
.amdhsa_kernel adaLN_cond__grouped_kv_mqa__dense_activation_silu__prompt_kernel
  .amdhsa_next_free_vgpr 512
  .amdhsa_next_free_sgpr 100
  .amdhsa_accum_offset 256
  .amdhsa_group_segment_fixed_size 0
  .amdhsa_kernarg_size 104
  .amdhsa_user_sgpr_count 2
  .amdhsa_user_sgpr_kernarg_segment_ptr 1
  .amdhsa_system_sgpr_workgroup_id_x 1
.end_amdhsa_kernel
```
